```python
import torch

def _softmax(x, axis=-1):
    return torch.softmax(x, dim=axis)
def _gelu(x):
    return torch.nn.functional.gelu(x, approximate="tanh")
def _silu(x):
    return torch.nn.functional.silu(x)
def _sigmoid(x):
    return torch.sigmoid(x)
def _layernorm(x, axis=-1, eps=1e-5):
    m = x.mean(dim=axis, keepdim=True)
    v = x.var(dim=axis, keepdim=True, unbiased=False)
    return (x - m) / torch.sqrt(v + eps)
def _scatter_add(tgt, idx, src, axis=0):
    return tgt.clone().index_add_(axis, idx, src)
def _segment_sum(src, seg, n):
    out = torch.zeros((n,) + src.shape[1:], dtype=src.dtype)
    return out.index_add_(0, seg, src)
def _pad(x, pw):
    flat = tuple(v for pair in reversed(pw) for v in pair)
    return torch.nn.functional.pad(x, flat)

kernel_name = 'concat_heads__gqa_block_cached__mha_block_cached__near_ridge'

def setup_inputs():

    _w = (lambda a: (lambda t: t.to(torch.bfloat16) if t.is_floating_point() else t)(torch.as_tensor(a)))
    def _A_setup():
        B, Sq, D = 8, 96, 640
        Hq, Hkv, Sk, Dh = 32, 32, 1024, 128
        assert Hq % Hkv == 0, (Hq, Hkv)
        return {
            "x": _w((lambda *s: torch.randn(*s, dtype=torch.bfloat16) * 0.8)(B, Sq, D)),
            "k_cache": _w((lambda *s: torch.randn(*s, dtype=torch.bfloat16) * 0.8)(B, Hkv, Sk, Dh)),
            "v_cache": _w((lambda *s: torch.randn(*s, dtype=torch.bfloat16) * 0.05)(B, Hkv, Sk, Dh)),
            "wq": _w((lambda *s: torch.randn(*s, dtype=torch.bfloat16) * 0.8)(D, Hq * Dh) * (D ** -0.5)),
            "wo": _w((lambda *s: torch.randn(*s, dtype=torch.bfloat16) * 0.05)(Hq * Dh, D) * ((Hq * Dh) ** -0.5)),
        }
    _A_in = _A_setup()

    def _B_setup():
        B, Sq, D = 8, 96, 640
        H, Sk, Dh = 32, 1024, 128
        return {
            "x": _w((lambda *s: torch.randn(*s, dtype=torch.bfloat16) * 0.8)(B, Sq, D)),
            "k_cache": _w((lambda *s: torch.randn(*s, dtype=torch.bfloat16) * 0.8)(B, H, Sk, Dh)),
            "v_cache": _w((lambda *s: torch.randn(*s, dtype=torch.bfloat16) * 0.05)(B, H, Sk, Dh)),
            "wq": _w((lambda *s: torch.randn(*s, dtype=torch.bfloat16) * 0.8)(D, H * Dh) * (D ** -0.5)),
            "wo": _w((lambda *s: torch.randn(*s, dtype=torch.bfloat16) * 0.05)(H * Dh, D) * ((H * Dh) ** -0.5)),
        }
    _B_in = _B_setup()

    return {
        "A_x": _A_in["x"],
        "A_k_cache": _A_in["k_cache"],
        "A_v_cache": _A_in["v_cache"],
        "A_wq": _A_in["wq"],
        "A_wo": _A_in["wo"],
        "B_x": _B_in["x"],
        "B_k_cache": _B_in["k_cache"],
        "B_v_cache": _B_in["v_cache"],
        "B_wq": _B_in["wq"],
        "B_wo": _B_in["wo"],
    }

def reference(A_x, A_k_cache, A_v_cache, A_wq, A_wo, B_x, B_k_cache, B_v_cache, B_wq, B_wo):
    def _A_ref(x, k_cache, v_cache, wq, wo):
        B, Sq, D = x.shape
        Hq, Dh = 32, 128
        Hkv = k_cache.shape[1]
        rep = Hq // Hkv
        q = (lambda x, *d: x.permute(*d))((x @ wq).reshape(B, Sq, Hq, Dh), 0, 2, 1, 3)
        k = (lambda x, n, axis: torch.repeat_interleave(x, n, dim=axis))(k_cache, rep, axis=1)
        v = (lambda x, n, axis: torch.repeat_interleave(x, n, dim=axis))(v_cache, rep, axis=1)
        scores = torch.einsum("bhqd,bhkd->bhqk", q, k) * (Dh ** -0.5)
        p = _softmax(scores, axis=-1)
        o = torch.einsum("bhqk,bhkd->bhqd", p, v)
        return (lambda x, *d: x.permute(*d))(o, 0, 2, 1, 3).reshape(B, Sq, Hq * Dh) @ wo

    def _B_ref(x, k_cache, v_cache, wq, wo):
        B, Sq, D = x.shape
        H, Dh = 32, 128
        q = (lambda x, *d: x.permute(*d))((x @ wq).reshape(B, Sq, H, Dh), 0, 2, 1, 3)
        scores = torch.einsum("bhqd,bhkd->bhqk", q, k_cache) * (Dh ** -0.5)
        p = _softmax(scores, axis=-1)
        o = torch.einsum("bhqk,bhkd->bhqd", p, v_cache)
        return (lambda x, *d: x.permute(*d))(o, 0, 2, 1, 3).reshape(B, Sq, H * Dh) @ wo

    a = _A_ref(A_x, A_k_cache, A_v_cache, A_wq, A_wo)
    b = _B_ref(B_x, B_k_cache, B_v_cache, B_wq, B_wo)
    return torch.concatenate([a, b], axis=-1)
```

```asm
; @launch grid=(256,1,1) block=(256,1,1) lds=163840
.amdgcn_target "amdgcn-amd-amdhsa--gfx950"
.text
.globl concat_heads__gqa_block_cached__mha_block_cached__near_ridge_kernel
.p2align 8
.type concat_heads__gqa_block_cached__mha_block_cached__near_ridge_kernel,@function
concat_heads__gqa_block_cached__mha_block_cached__near_ridge_kernel:
    s_cmp_ge_u32 s2, 256
    s_cbranch_scc1 K1_END
    s_load_dwordx8 s[40:47], s[0:1], 0
    s_load_dwordx8 s[48:55], s[0:1], 40
    s_load_dwordx2 s[20:21], s[0:1], 96
    s_and_b32 s3, s2, 7
    s_lshr_b32 s33, s2, 3
    s_lshr_b32 s25, s3, 2
    s_and_b32 s3, s3, 3
    s_lshl_b32 s3, s3, 3
    s_and_b32 s26, s33, 7
    s_add_u32 s26, s26, s3
    s_lshr_b32 s27, s33, 3
    v_lshrrev_b32 v20, 6, v0
    v_and_b32 v21, 63, v0
    s_nop 0
    v_readfirstlane_b32 s24, v20
    v_lshlrev_b32 v0, 4, v21
    v_lshrrev_b32 v22, 4, v21
    v_and_b32 v23, 15, v21
    v_xor_b32 v24, v23, v22
    v_lshlrev_b32 v24, 4, v24
    v_lshlrev_b32 v25, 8, v22
    v_add_u32 v3, v24, v25
    v_xor_b32 v4, 64, v3
    v_xor_b32 v5, 0x80, v3
    v_xor_b32 v6, 0xc0, v3
    v_lshlrev_b32 v24, 2, v22
    v_xor_b32 v24, v23, v24
    v_lshlrev_b32 v24, 4, v24
    v_add_u32 v7, v24, v25
    v_lshlrev_b32 v25, 13, v22
    v_add_u32 v240, v24, v25
    v_and_b32 v24, 7, v21
    v_xor_b32 v24, v24, v22
    v_lshlrev_b32 v24, 4, v24
    v_lshrrev_b32 v25, 3, v21
    v_mul_u32_u24 v25, 0x500, v25
    v_add_u32 v241, v24, v25
    v_xor_b32 v242, 64, v241
    s_lshl_b32 s32, s24, 13
    s_lshl_b32 s31, s24, 15
    s_lshl_b32 s35, s24, 17
    s_lshl_b32 s37, s24, 12
    s_mul_i32 s38, s24, 6144
    s_add_u32 s38, s38, 16384
    s_lshr_b32 s33, s24, 1
    s_mul_i32 s36, s33, 491520
    s_and_b32 s34, s24, 1
    s_mul_i32 s3, s34, 61440
    s_add_u32 s36, s36, s3
    s_mov_b32 s39, 0x4e800000
    s_mul_i32 s57, s33, 106496
    s_lshl_b32 s3, s34, 12
    s_add_u32 s57, s57, s3
    s_add_u32 s57, s57, 24576
    s_mul_i32 s59, s33, 24576
    s_sub_u32 s59, 32768, s59
    v_lshrrev_b32 v26, 5, v21
    v_and_b32 v27, 31, v21
    v_bfe_u32 v28, v21, 2, 2
    v_and_b32 v29, 16, v21
    v_lshlrev_b32 v29, 1, v29
    v_and_b32 v30, 1, v21
    v_lshlrev_b32 v30, 4, v30
    v_add_u32 v29, v29, v30
    v_and_b32 v30, 2, v21
    v_lshlrev_b32 v30, 2, v30
    v_add_u32 v29, v29, v30
    v_xor_b32 v30, v26, v23
    v_lshlrev_b32 v30, 4, v30
    v_lshlrev_b32 v31, 8, v27
    v_add_u32 v30, v30, v31
    v_add_u32 v1, s31, v30
    v_lshlrev_b32 v30, 2, v26
    v_add_u32 v30, v30, v28
    v_lshlrev_b32 v30, 8, v30
    v_xor_b32 v31, s24, v28
    v_lshlrev_b32 v31, 6, v31
    v_add3_u32 v30, v30, v31, v29
    v_add_u32 v30, s31, v30
    v_add_u32 v2, 0x2000, v30
    v_lshlrev_b32 v30, 3, v26
    v_add_u32 v30, v30, v28
    v_lshlrev_b32 v30, 8, v30
    s_lshl_b32 s3, s34, 1
    v_xor_b32 v31, s3, v28
    v_lshlrev_b32 v31, 6, v31
    v_add3_u32 v243, v30, v31, v29
    v_xor_b32 v244, 64, v243
    v_add_u32 v245, 81920, v243
    v_add_u32 v246, 81920, v244
    s_mul_i32 s3, s33, 12288
    s_add_u32 s3, s3, 16384
    v_bfe_u32 v30, v21, 1, 3
    v_xor_b32 v30, v30, v26
    v_lshlrev_b32 v30, 4, v30
    v_lshlrev_b32 v31, 7, v27
    v_add3_u32 v247, v30, v31, s3
    v_xor_b32 v248, 32, v247
    v_xor_b32 v249, 64, v247
    v_xor_b32 v250, 96, v247
    v_add_u32 v251, 81920, v247
    v_add_u32 v252, 81920, v248
    v_add_u32 v253, 81920, v249
    v_add_u32 v254, 81920, v250
    v_lshlrev_b32 v255, 5, v27
    v_add_u32 v255, 155648, v255
    s_waitcnt lgkmcnt(0)
    s_cmp_eq_u32 s25, 0
    s_cselect_b64 s[40:41], s[40:41], s[48:49]
    s_cselect_b64 s[42:43], s[42:43], s[50:51]
    s_cselect_b64 s[44:45], s[44:45], s[52:53]
    s_cselect_b64 s[46:47], s[46:47], s[54:55]
    s_lshl_b32 s3, s27, 5
    s_add_u32 s3, s3, s26
    s_lshl_b32 s3, s3, 18
    s_add_u32 s4, s42, s3
    s_addc_u32 s5, s43, 0
    s_and_b32 s5, s5, 0xffff
    s_sub_u32 s6, 0x4000000, s3
    s_mov_b32 s7, 0x20000
    s_add_u32 s8, s44, s3
    s_addc_u32 s9, s45, 0
    s_and_b32 s9, s9, 0xffff
    s_sub_u32 s10, 0x4000000, s3
    s_mov_b32 s11, 0x20000
    s_lshl_b32 s3, s26, 8
    s_add_u32 s12, s46, s3
    s_addc_u32 s13, s47, 0
    s_and_b32 s13, s13, 0xffff
    s_sub_u32 s14, 5242880, s3
    s_mov_b32 s15, 0x20000
    s_mul_i32 s3, s27, 122880
    s_add_u32 s16, s40, s3
    s_addc_u32 s17, s41, 0
    s_and_b32 s17, s17, 0xffff
    s_sub_u32 s18, 983040, s3
    s_mov_b32 s19, 0x20000
    s_mul_i32 s3, s25, 40
    s_add_u32 s3, s3, 32
    s_load_dwordx2 s[48:49], s[0:1], s3
    s_load_dwordx2 s[50:51], s[0:1], 80
    s_add_u32 s92, s20, 12582912
    s_addc_u32 s93, s21, 0
    s_load_dword s53, s[92:93], 196608
    s_and_b32 s93, s93, 0xffff
    s_mov_b32 s94, 196736
    s_mov_b32 s95, 0x20000
    s_mul_i32 s3, s25, 6291456
    s_add_u32 s20, s20, s3
    s_addc_u32 s21, s21, 0
    s_and_b32 s21, s21, 0xffff
    s_mov_b32 s22, 6291456
    s_mov_b32 s23, 0x20000
    s_mul_i32 s56, s27, 768
    s_lshl_b32 s3, s26, 3
    s_add_u32 s56, s56, s3
    s_lshl_b32 s3, s24, 1
    s_add_u32 s56, s56, s3
    s_lshl_b32 s56, s56, 10
    s_mov_b32 s28, 0
    s_mov_b32 s58, 0
    s_add_u32 s33, s28, 0
    s_lshr_b32 s34, s33, 3
    s_lshl_b32 s34, s34, 25
    s_add_u32 s33, s33, s58
    s_and_b32 s33, s33, 7
    s_lshl_b32 s33, s33, 15
    s_add_u32 s40, s33, s34
    s_add_u32 s40, s40, s32
    s_add_u32 s41, s40, 4096
    s_add_u32 s33, s28, 1
    s_lshr_b32 s34, s33, 3
    s_lshl_b32 s34, s34, 25
    s_add_u32 s33, s33, s58
    s_and_b32 s33, s33, 7
    s_lshl_b32 s33, s33, 15
    s_add_u32 s42, s33, s34
    s_add_u32 s42, s42, s32
    s_add_u32 s43, s42, 4096
    s_mul_i32 s44, s27, 5
    s_add_u32 s44, s44, 1
    s_lshr_b32 s44, s44, 1
    s_and_b32 s33, s26, 7
    s_add_u32 s44, s44, s33
    s_sub_u32 s33, s44, 10
    s_cmp_ge_u32 s44, 10
    s_cselect_b32 s44, s33, s44
    s_lshl_b32 s45, s44, 19
    s_add_u32 s45, s45, s35
    s_lshl_b32 s46, s44, 7
    s_add_u32 s46, s46, s36
    s_add_u32 s33, s27, s26
    s_bitcmp0_b32 s33, 0
    s_cbranch_scc1 QA
    s_add_u32 m0, s37, 0
    s_add_u32 s33, s45, 0
    buffer_load_dwordx4 v240, s[12:15], s33 offen lds
    s_add_u32 m0, s37, 1024
    s_add_u32 s33, s45, 32768
    buffer_load_dwordx4 v240, s[12:15], s33 offen lds
    s_add_u32 m0, s37, 2048
    s_add_u32 s33, s45, 65536
    buffer_load_dwordx4 v240, s[12:15], s33 offen lds
    s_add_u32 m0, s37, 3072
    s_add_u32 s33, s45, 98304
    buffer_load_dwordx4 v240, s[12:15], s33 offen lds
    s_add_u32 m0, s38, 0
    s_add_u32 s33, s46, 0
    buffer_load_dwordx4 v241, s[16:19], s33 offen lds
    s_add_u32 m0, s38, 1024
    s_add_u32 s33, s46, 10240
    buffer_load_dwordx4 v242, s[16:19], s33 offen lds
    s_add_u32 m0, s38, 2048
    s_add_u32 s33, s46, 20480
    buffer_load_dwordx4 v241, s[16:19], s33 offen lds
    s_add_u32 m0, s38, 3072
    s_add_u32 s33, s46, 30720
    buffer_load_dwordx4 v242, s[16:19], s33 offen lds
    s_add_u32 m0, s38, 4096
    s_add_u32 s33, s46, 40960
    buffer_load_dwordx4 v241, s[16:19], s33 offen lds
    s_add_u32 m0, s38, 5120
    s_add_u32 s33, s46, 51200
    buffer_load_dwordx4 v242, s[16:19], s33 offen lds
    s_add_u32 s44, s44, 1
    s_cmp_eq_u32 s44, 10
    s_cselect_b32 s44, 0, s44
    s_lshl_b32 s45, s44, 19
    s_add_u32 s45, s45, s35
    s_lshl_b32 s46, s44, 7
    s_add_u32 s46, s46, s36
    s_add_u32 m0, s37, 40960
    s_add_u32 s33, s45, 0
    buffer_load_dwordx4 v240, s[12:15], s33 offen lds
    s_add_u32 m0, s37, 41984
    s_add_u32 s33, s45, 32768
    buffer_load_dwordx4 v240, s[12:15], s33 offen lds
    s_add_u32 m0, s37, 43008
    s_add_u32 s33, s45, 65536
    buffer_load_dwordx4 v240, s[12:15], s33 offen lds
    s_add_u32 m0, s37, 44032
    s_add_u32 s33, s45, 98304
    buffer_load_dwordx4 v240, s[12:15], s33 offen lds
    s_add_u32 m0, s38, 40960
    s_add_u32 s33, s46, 0
    buffer_load_dwordx4 v241, s[16:19], s33 offen lds
    s_add_u32 m0, s38, 41984
    s_add_u32 s33, s46, 10240
    buffer_load_dwordx4 v242, s[16:19], s33 offen lds
    s_add_u32 m0, s38, 43008
    s_add_u32 s33, s46, 20480
    buffer_load_dwordx4 v241, s[16:19], s33 offen lds
    s_add_u32 m0, s38, 44032
    s_add_u32 s33, s46, 30720
    buffer_load_dwordx4 v242, s[16:19], s33 offen lds
    s_add_u32 m0, s38, 45056
    s_add_u32 s33, s46, 40960
    buffer_load_dwordx4 v241, s[16:19], s33 offen lds
    s_add_u32 m0, s38, 46080
    s_add_u32 s33, s46, 51200
    buffer_load_dwordx4 v242, s[16:19], s33 offen lds
    s_add_u32 s44, s44, 1
    s_cmp_eq_u32 s44, 10
    s_cselect_b32 s44, 0, s44
    s_lshl_b32 s45, s44, 19
    s_add_u32 s45, s45, s35
    s_lshl_b32 s46, s44, 7
    s_add_u32 s46, s46, s36
    s_waitcnt vmcnt(10) lgkmcnt(0)
    s_barrier
    ds_read_b64_tr_b16 v[144:145], v243 offset:0
    ds_read_b64_tr_b16 v[146:147], v243 offset:1024
    ds_read_b64_tr_b16 v[148:149], v244 offset:0
    ds_read_b64_tr_b16 v[150:151], v244 offset:1024
    ds_read_b128 v[176:179], v247 offset:0
    ds_read_b128 v[180:183], v247 offset:4096
    ds_read_b128 v[184:187], v247 offset:8192
    ds_read_b64_tr_b16 v[152:153], v243 offset:4096
    ds_read_b64_tr_b16 v[154:155], v243 offset:5120
    ds_read_b64_tr_b16 v[156:157], v244 offset:4096
    ds_read_b64_tr_b16 v[158:159], v244 offset:5120
    ds_read_b128 v[188:191], v248 offset:0
    ds_read_b128 v[192:195], v248 offset:4096
    ds_read_b128 v[196:199], v248 offset:8192
    s_waitcnt lgkmcnt(7)
    v_mfma_f32_32x32x16_bf16 v[48:63], v[144:147], v[176:179], 0
    ds_read_b64_tr_b16 v[160:161], v243 offset:8192
    ds_read_b64_tr_b16 v[162:163], v243 offset:9216
    s_add_u32 m0, s37, 81920
    s_add_u32 s33, s45, 0
    buffer_load_dwordx4 v240, s[12:15], s33 offen lds
    v_mfma_f32_32x32x16_bf16 v[64:79], v[144:147], v[180:183], 0
    ds_read_b64_tr_b16 v[164:165], v244 offset:8192
    ds_read_b64_tr_b16 v[166:167], v244 offset:9216
    s_add_u32 m0, s37, 82944
    s_add_u32 s33, s45, 32768
    buffer_load_dwordx4 v240, s[12:15], s33 offen lds
    v_mfma_f32_32x32x16_bf16 v[80:95], v[144:147], v[184:187], 0
    ds_read_b128 v[200:203], v249 offset:0
    ds_read_b128 v[204:207], v249 offset:4096
    s_add_u32 m0, s37, 83968
    s_add_u32 s33, s45, 65536
    buffer_load_dwordx4 v240, s[12:15], s33 offen lds
    v_mfma_f32_32x32x16_bf16 v[96:111], v[148:151], v[176:179], 0
    ds_read_b128 v[208:211], v249 offset:8192
    s_waitcnt lgkmcnt(7)
    s_add_u32 m0, s37, 84992
    s_add_u32 s33, s45, 98304
    buffer_load_dwordx4 v240, s[12:15], s33 offen lds
    v_mfma_f32_32x32x16_bf16 v[112:127], v[148:151], v[180:183], 0
    ds_read_b64_tr_b16 v[168:169], v243 offset:12288
    ds_read_b64_tr_b16 v[170:171], v243 offset:13312
    s_add_u32 m0, s38, 81920
    s_add_u32 s33, s46, 0
    buffer_load_dwordx4 v241, s[16:19], s33 offen lds
    v_mfma_f32_32x32x16_bf16 v[128:143], v[148:151], v[184:187], 0
    ds_read_b64_tr_b16 v[172:173], v244 offset:12288
    ds_read_b64_tr_b16 v[174:175], v244 offset:13312
    s_add_u32 m0, s38, 82944
    s_add_u32 s33, s46, 10240
    buffer_load_dwordx4 v242, s[16:19], s33 offen lds
    v_mfma_f32_32x32x16_bf16 v[48:63], v[152:155], v[188:191], v[48:63]
    ds_read_b128 v[212:215], v250 offset:0
    ds_read_b128 v[216:219], v250 offset:4096
    s_add_u32 m0, s38, 83968
    s_add_u32 s33, s46, 20480
    buffer_load_dwordx4 v241, s[16:19], s33 offen lds
    v_mfma_f32_32x32x16_bf16 v[64:79], v[152:155], v[192:195], v[64:79]
    ds_read_b128 v[220:223], v250 offset:8192
    s_add_u32 m0, s38, 84992
    s_add_u32 s33, s46, 30720
    buffer_load_dwordx4 v242, s[16:19], s33 offen lds
    v_mfma_f32_32x32x16_bf16 v[80:95], v[152:155], v[196:199], v[80:95]
    s_add_u32 m0, s38, 86016
    s_add_u32 s33, s46, 40960
    buffer_load_dwordx4 v241, s[16:19], s33 offen lds
    v_mfma_f32_32x32x16_bf16 v[96:111], v[156:159], v[188:191], v[96:111]
    s_add_u32 m0, s38, 87040
    s_add_u32 s33, s46, 51200
    buffer_load_dwordx4 v242, s[16:19], s33 offen lds
    s_add_u32 s44, s44, 1
    s_cmp_eq_u32 s44, 10
    s_cselect_b32 s44, 0, s44
    s_lshl_b32 s45, s44, 19
    s_add_u32 s45, s45, s35
    s_lshl_b32 s46, s44, 7
    s_add_u32 s46, s46, s36
    v_mfma_f32_32x32x16_bf16 v[112:127], v[156:159], v[192:195], v[112:127]
    v_mfma_f32_32x32x16_bf16 v[128:143], v[156:159], v[196:199], v[128:143]
    s_waitcnt vmcnt(10) lgkmcnt(0)
    s_barrier
    v_mfma_f32_32x32x16_bf16 v[48:63], v[160:163], v[200:203], v[48:63]
    ds_read_b64_tr_b16 v[144:145], v243 offset:40960
    ds_read_b64_tr_b16 v[146:147], v243 offset:41984
    s_add_u32 m0, s37, 122880
    s_add_u32 s33, s45, 0
    buffer_load_dwordx4 v240, s[12:15], s33 offen lds
    v_mfma_f32_32x32x16_bf16 v[64:79], v[160:163], v[204:207], v[64:79]
    ds_read_b64_tr_b16 v[148:149], v244 offset:40960
    ds_read_b64_tr_b16 v[150:151], v244 offset:41984
    s_add_u32 m0, s37, 123904
    s_add_u32 s33, s45, 32768
    buffer_load_dwordx4 v240, s[12:15], s33 offen lds
    v_mfma_f32_32x32x16_bf16 v[80:95], v[160:163], v[208:211], v[80:95]
    ds_read_b128 v[176:179], v247 offset:40960
    ds_read_b128 v[180:183], v247 offset:45056
    s_add_u32 m0, s37, 124928
    s_add_u32 s33, s45, 65536
    buffer_load_dwordx4 v240, s[12:15], s33 offen lds
    v_mfma_f32_32x32x16_bf16 v[96:111], v[164:167], v[200:203], v[96:111]
    ds_read_b128 v[184:187], v247 offset:49152
    s_add_u32 m0, s37, 125952
    s_add_u32 s33, s45, 98304
    buffer_load_dwordx4 v240, s[12:15], s33 offen lds
    v_mfma_f32_32x32x16_bf16 v[112:127], v[164:167], v[204:207], v[112:127]
    ds_read_b64_tr_b16 v[152:153], v243 offset:45056
    ds_read_b64_tr_b16 v[154:155], v243 offset:46080
    s_add_u32 m0, s38, 122880
    s_add_u32 s33, s46, 0
    buffer_load_dwordx4 v241, s[16:19], s33 offen lds
    v_mfma_f32_32x32x16_bf16 v[128:143], v[164:167], v[208:211], v[128:143]
    ds_read_b64_tr_b16 v[156:157], v244 offset:45056
    ds_read_b64_tr_b16 v[158:159], v244 offset:46080
    s_add_u32 m0, s38, 123904
    s_add_u32 s33, s46, 10240
    buffer_load_dwordx4 v242, s[16:19], s33 offen lds
    v_mfma_f32_32x32x16_bf16 v[48:63], v[168:171], v[212:215], v[48:63]
    ds_read_b128 v[188:191], v248 offset:40960
    ds_read_b128 v[192:195], v248 offset:45056
    s_add_u32 m0, s38, 124928
    s_add_u32 s33, s46, 20480
    buffer_load_dwordx4 v241, s[16:19], s33 offen lds
    v_mfma_f32_32x32x16_bf16 v[64:79], v[168:171], v[216:219], v[64:79]
    ds_read_b128 v[196:199], v248 offset:49152
    s_add_u32 m0, s38, 125952
    s_add_u32 s33, s46, 30720
    buffer_load_dwordx4 v242, s[16:19], s33 offen lds
    v_mfma_f32_32x32x16_bf16 v[80:95], v[168:171], v[220:223], v[80:95]
    s_add_u32 m0, s38, 126976
    s_add_u32 s33, s46, 40960
    buffer_load_dwordx4 v241, s[16:19], s33 offen lds
    v_mfma_f32_32x32x16_bf16 v[96:111], v[172:175], v[212:215], v[96:111]
    s_add_u32 m0, s38, 128000
    s_add_u32 s33, s46, 51200
    buffer_load_dwordx4 v242, s[16:19], s33 offen lds
    s_add_u32 s44, s44, 1
    s_cmp_eq_u32 s44, 10
    s_cselect_b32 s44, 0, s44
    s_lshl_b32 s45, s44, 19
    s_add_u32 s45, s45, s35
    s_lshl_b32 s46, s44, 7
    s_add_u32 s46, s46, s36
    v_mfma_f32_32x32x16_bf16 v[112:127], v[172:175], v[216:219], v[112:127]
    v_mfma_f32_32x32x16_bf16 v[128:143], v[172:175], v[220:223], v[128:143]
    s_waitcnt lgkmcnt(7)
    v_mfma_f32_32x32x16_bf16 v[48:63], v[144:147], v[176:179], v[48:63]
    ds_read_b64_tr_b16 v[160:161], v243 offset:49152
    ds_read_b64_tr_b16 v[162:163], v243 offset:50176
    s_add_u32 m0, s37, 0
    s_add_u32 s33, s45, 0
    buffer_load_dwordx4 v240, s[12:15], s33 offen lds
    v_mfma_f32_32x32x16_bf16 v[64:79], v[144:147], v[180:183], v[64:79]
    ds_read_b64_tr_b16 v[164:165], v244 offset:49152
    ds_read_b64_tr_b16 v[166:167], v244 offset:50176
    v_mfma_f32_32x32x16_bf16 v[80:95], v[144:147], v[184:187], v[80:95]
    ds_read_b128 v[200:203], v249 offset:40960
    ds_read_b128 v[204:207], v249 offset:45056
    s_add_u32 m0, s37, 1024
    s_add_u32 s33, s45, 32768
    buffer_load_dwordx4 v240, s[12:15], s33 offen lds
    v_mfma_f32_32x32x16_bf16 v[96:111], v[148:151], v[176:179], v[96:111]
    ds_read_b128 v[208:211], v249 offset:49152
    s_waitcnt lgkmcnt(7)
    v_mfma_f32_32x32x16_bf16 v[112:127], v[148:151], v[180:183], v[112:127]
    ds_read_b64_tr_b16 v[168:169], v243 offset:53248
    ds_read_b64_tr_b16 v[170:171], v243 offset:54272
    s_add_u32 m0, s37, 2048
    s_add_u32 s33, s45, 65536
    buffer_load_dwordx4 v240, s[12:15], s33 offen lds
    v_mfma_f32_32x32x16_bf16 v[128:143], v[148:151], v[184:187], v[128:143]
    ds_read_b64_tr_b16 v[172:173], v244 offset:53248
    ds_read_b64_tr_b16 v[174:175], v244 offset:54272
    v_mfma_f32_32x32x16_bf16 v[48:63], v[152:155], v[188:191], v[48:63]
    ds_read_b128 v[212:215], v250 offset:40960
    ds_read_b128 v[216:219], v250 offset:45056
    s_add_u32 m0, s37, 3072
    s_add_u32 s33, s45, 98304
    buffer_load_dwordx4 v240, s[12:15], s33 offen lds
    v_mfma_f32_32x32x16_bf16 v[64:79], v[152:155], v[192:195], v[64:79]
    ds_read_b128 v[220:223], v250 offset:49152
    v_mfma_f32_32x32x16_bf16 v[80:95], v[152:155], v[196:199], v[80:95]
    s_add_u32 m0, s38, 0
    s_add_u32 s33, s46, 0
    buffer_load_dwordx4 v241, s[16:19], s33 offen lds
    v_mfma_f32_32x32x16_bf16 v[96:111], v[156:159], v[188:191], v[96:111]
    v_mfma_f32_32x32x16_bf16 v[112:127], v[156:159], v[192:195], v[112:127]
    v_mfma_f32_32x32x16_bf16 v[128:143], v[156:159], v[196:199], v[128:143]
    s_waitcnt vmcnt(15) lgkmcnt(0)
    s_barrier
    v_mfma_f32_32x32x16_bf16 v[48:63], v[160:163], v[200:203], v[48:63]
    ds_read_b64_tr_b16 v[144:145], v245 offset:0
    ds_read_b64_tr_b16 v[146:147], v245 offset:1024
    s_add_u32 m0, s38, 1024
    s_add_u32 s33, s46, 10240
    buffer_load_dwordx4 v242, s[16:19], s33 offen lds
    v_mfma_f32_32x32x16_bf16 v[64:79], v[160:163], v[204:207], v[64:79]
    ds_read_b64_tr_b16 v[148:149], v246 offset:0
    ds_read_b64_tr_b16 v[150:151], v246 offset:1024
    v_mfma_f32_32x32x16_bf16 v[80:95], v[160:163], v[208:211], v[80:95]
    ds_read_b128 v[176:179], v251 offset:0
    ds_read_b128 v[180:183], v251 offset:4096
    s_add_u32 m0, s38, 2048
    s_add_u32 s33, s46, 20480
    buffer_load_dwordx4 v241, s[16:19], s33 offen lds
    v_mfma_f32_32x32x16_bf16 v[96:111], v[164:167], v[200:203], v[96:111]
    ds_read_b128 v[184:187], v251 offset:8192
    v_mfma_f32_32x32x16_bf16 v[112:127], v[164:167], v[204:207], v[112:127]
    ds_read_b64_tr_b16 v[152:153], v245 offset:4096
    ds_read_b64_tr_b16 v[154:155], v245 offset:5120
    s_add_u32 m0, s38, 3072
    s_add_u32 s33, s46, 30720
    buffer_load_dwordx4 v242, s[16:19], s33 offen lds
    v_mfma_f32_32x32x16_bf16 v[128:143], v[164:167], v[208:211], v[128:143]
    ds_read_b64_tr_b16 v[156:157], v246 offset:4096
    ds_read_b64_tr_b16 v[158:159], v246 offset:5120
    v_mfma_f32_32x32x16_bf16 v[48:63], v[168:171], v[212:215], v[48:63]
    ds_read_b128 v[188:191], v252 offset:0
    ds_read_b128 v[192:195], v252 offset:4096
    s_add_u32 m0, s38, 4096
    s_add_u32 s33, s46, 40960
    buffer_load_dwordx4 v241, s[16:19], s33 offen lds
    v_mfma_f32_32x32x16_bf16 v[64:79], v[168:171], v[216:219], v[64:79]
    ds_read_b128 v[196:199], v252 offset:8192
    v_mfma_f32_32x32x16_bf16 v[80:95], v[168:171], v[220:223], v[80:95]
    s_add_u32 m0, s38, 5120
    s_add_u32 s33, s46, 51200
    buffer_load_dwordx4 v242, s[16:19], s33 offen lds
    s_add_u32 s44, s44, 1
    s_cmp_eq_u32 s44, 10
    s_cselect_b32 s44, 0, s44
    s_lshl_b32 s45, s44, 19
    s_add_u32 s45, s45, s35
    s_lshl_b32 s46, s44, 7
    s_add_u32 s46, s46, s36
    v_mfma_f32_32x32x16_bf16 v[96:111], v[172:175], v[212:215], v[96:111]
    v_mfma_f32_32x32x16_bf16 v[112:127], v[172:175], v[216:219], v[112:127]
    v_mfma_f32_32x32x16_bf16 v[128:143], v[172:175], v[220:223], v[128:143]
    s_waitcnt lgkmcnt(7)
    v_mfma_f32_32x32x16_bf16 v[48:63], v[144:147], v[176:179], v[48:63]
    ds_read_b64_tr_b16 v[160:161], v245 offset:8192
    ds_read_b64_tr_b16 v[162:163], v245 offset:9216
    s_add_u32 m0, s37, 40960
    s_add_u32 s33, s45, 0
    buffer_load_dwordx4 v240, s[12:15], s33 offen lds
    v_mfma_f32_32x32x16_bf16 v[64:79], v[144:147], v[180:183], v[64:79]
    ds_read_b64_tr_b16 v[164:165], v246 offset:8192
    ds_read_b64_tr_b16 v[166:167], v246 offset:9216
    v_mfma_f32_32x32x16_bf16 v[80:95], v[144:147], v[184:187], v[80:95]
    ds_read_b128 v[200:203], v253 offset:0
    ds_read_b128 v[204:207], v253 offset:4096
    s_add_u32 m0, s37, 41984
    s_add_u32 s33, s45, 32768
    buffer_load_dwordx4 v240, s[12:15], s33 offen lds
    v_mfma_f32_32x32x16_bf16 v[96:111], v[148:151], v[176:179], v[96:111]
    ds_read_b128 v[208:211], v253 offset:8192
    s_waitcnt lgkmcnt(7)
    v_mfma_f32_32x32x16_bf16 v[112:127], v[148:151], v[180:183], v[112:127]
    ds_read_b64_tr_b16 v[168:169], v245 offset:12288
    ds_read_b64_tr_b16 v[170:171], v245 offset:13312
    s_add_u32 m0, s37, 43008
    s_add_u32 s33, s45, 65536
    buffer_load_dwordx4 v240, s[12:15], s33 offen lds
    v_mfma_f32_32x32x16_bf16 v[128:143], v[148:151], v[184:187], v[128:143]
    ds_read_b64_tr_b16 v[172:173], v246 offset:12288
    ds_read_b64_tr_b16 v[174:175], v246 offset:13312
    v_mfma_f32_32x32x16_bf16 v[48:63], v[152:155], v[188:191], v[48:63]
    ds_read_b128 v[212:215], v254 offset:0
    ds_read_b128 v[216:219], v254 offset:4096
    s_add_u32 m0, s37, 44032
    s_add_u32 s33, s45, 98304
    buffer_load_dwordx4 v240, s[12:15], s33 offen lds
    v_mfma_f32_32x32x16_bf16 v[64:79], v[152:155], v[192:195], v[64:79]
    ds_read_b128 v[220:223], v254 offset:8192
    v_mfma_f32_32x32x16_bf16 v[80:95], v[152:155], v[196:199], v[80:95]
    s_add_u32 m0, s38, 40960
    s_add_u32 s33, s46, 0
    buffer_load_dwordx4 v241, s[16:19], s33 offen lds
    v_mfma_f32_32x32x16_bf16 v[96:111], v[156:159], v[188:191], v[96:111]
    v_mfma_f32_32x32x16_bf16 v[112:127], v[156:159], v[192:195], v[112:127]
    v_mfma_f32_32x32x16_bf16 v[128:143], v[156:159], v[196:199], v[128:143]
    s_waitcnt vmcnt(15) lgkmcnt(0)
    s_barrier
    v_mfma_f32_32x32x16_bf16 v[48:63], v[160:163], v[200:203], v[48:63]
    ds_read_b64_tr_b16 v[144:145], v245 offset:40960
    ds_read_b64_tr_b16 v[146:147], v245 offset:41984
    s_add_u32 m0, s38, 41984
    s_add_u32 s33, s46, 10240
    buffer_load_dwordx4 v242, s[16:19], s33 offen lds
    v_mfma_f32_32x32x16_bf16 v[64:79], v[160:163], v[204:207], v[64:79]
    ds_read_b64_tr_b16 v[148:149], v246 offset:40960
    ds_read_b64_tr_b16 v[150:151], v246 offset:41984
    v_mfma_f32_32x32x16_bf16 v[80:95], v[160:163], v[208:211], v[80:95]
    ds_read_b128 v[176:179], v251 offset:40960
    ds_read_b128 v[180:183], v251 offset:45056
    s_add_u32 m0, s38, 43008
    s_add_u32 s33, s46, 20480
    buffer_load_dwordx4 v241, s[16:19], s33 offen lds
    v_mfma_f32_32x32x16_bf16 v[96:111], v[164:167], v[200:203], v[96:111]
    ds_read_b128 v[184:187], v251 offset:49152
    v_mfma_f32_32x32x16_bf16 v[112:127], v[164:167], v[204:207], v[112:127]
    ds_read_b64_tr_b16 v[152:153], v245 offset:45056
    ds_read_b64_tr_b16 v[154:155], v245 offset:46080
    s_add_u32 m0, s38, 44032
    s_add_u32 s33, s46, 30720
    buffer_load_dwordx4 v242, s[16:19], s33 offen lds
    v_mfma_f32_32x32x16_bf16 v[128:143], v[164:167], v[208:211], v[128:143]
    ds_read_b64_tr_b16 v[156:157], v246 offset:45056
    ds_read_b64_tr_b16 v[158:159], v246 offset:46080
    v_mfma_f32_32x32x16_bf16 v[48:63], v[168:171], v[212:215], v[48:63]
    ds_read_b128 v[188:191], v252 offset:40960
    ds_read_b128 v[192:195], v252 offset:45056
    s_add_u32 m0, s38, 45056
    s_add_u32 s33, s46, 40960
    buffer_load_dwordx4 v241, s[16:19], s33 offen lds
    v_mfma_f32_32x32x16_bf16 v[64:79], v[168:171], v[216:219], v[64:79]
    ds_read_b128 v[196:199], v252 offset:49152
    v_mfma_f32_32x32x16_bf16 v[80:95], v[168:171], v[220:223], v[80:95]
    s_add_u32 m0, s38, 46080
    s_add_u32 s33, s46, 51200
    buffer_load_dwordx4 v242, s[16:19], s33 offen lds
    s_add_u32 s44, s44, 1
    s_cmp_eq_u32 s44, 10
    s_cselect_b32 s44, 0, s44
    s_lshl_b32 s45, s44, 19
    s_add_u32 s45, s45, s35
    s_lshl_b32 s46, s44, 7
    s_add_u32 s46, s46, s36
    v_mfma_f32_32x32x16_bf16 v[96:111], v[172:175], v[212:215], v[96:111]
    v_mfma_f32_32x32x16_bf16 v[112:127], v[172:175], v[216:219], v[112:127]
    v_mfma_f32_32x32x16_bf16 v[128:143], v[172:175], v[220:223], v[128:143]
    s_waitcnt lgkmcnt(7)
    v_mfma_f32_32x32x16_bf16 v[48:63], v[144:147], v[176:179], v[48:63]
    ds_read_b64_tr_b16 v[160:161], v245 offset:49152
    ds_read_b64_tr_b16 v[162:163], v245 offset:50176
    s_add_u32 m0, s37, 81920
    s_add_u32 s33, s45, 0
    buffer_load_dwordx4 v240, s[12:15], s33 offen lds
    v_mfma_f32_32x32x16_bf16 v[64:79], v[144:147], v[180:183], v[64:79]
    ds_read_b64_tr_b16 v[164:165], v246 offset:49152
    ds_read_b64_tr_b16 v[166:167], v246 offset:50176
    v_mfma_f32_32x32x16_bf16 v[80:95], v[144:147], v[184:187], v[80:95]
    ds_read_b128 v[200:203], v253 offset:40960
    ds_read_b128 v[204:207], v253 offset:45056
    s_add_u32 m0, s37, 82944
    s_add_u32 s33, s45, 32768
    buffer_load_dwordx4 v240, s[12:15], s33 offen lds
    v_mfma_f32_32x32x16_bf16 v[96:111], v[148:151], v[176:179], v[96:111]
    ds_read_b128 v[208:211], v253 offset:49152
    s_waitcnt lgkmcnt(7)
    v_mfma_f32_32x32x16_bf16 v[112:127], v[148:151], v[180:183], v[112:127]
    ds_read_b64_tr_b16 v[168:169], v245 offset:53248
    ds_read_b64_tr_b16 v[170:171], v245 offset:54272
    s_add_u32 m0, s37, 83968
    s_add_u32 s33, s45, 65536
    buffer_load_dwordx4 v240, s[12:15], s33 offen lds
    v_mfma_f32_32x32x16_bf16 v[128:143], v[148:151], v[184:187], v[128:143]
    ds_read_b64_tr_b16 v[172:173], v246 offset:53248
    ds_read_b64_tr_b16 v[174:175], v246 offset:54272
    v_mfma_f32_32x32x16_bf16 v[48:63], v[152:155], v[188:191], v[48:63]
    ds_read_b128 v[212:215], v254 offset:40960
    ds_read_b128 v[216:219], v254 offset:45056
    s_add_u32 m0, s37, 84992
    s_add_u32 s33, s45, 98304
    buffer_load_dwordx4 v240, s[12:15], s33 offen lds
    v_mfma_f32_32x32x16_bf16 v[64:79], v[152:155], v[192:195], v[64:79]
    ds_read_b128 v[220:223], v254 offset:49152
    v_mfma_f32_32x32x16_bf16 v[80:95], v[152:155], v[196:199], v[80:95]
    s_add_u32 m0, s38, 81920
    s_add_u32 s33, s46, 0
    buffer_load_dwordx4 v241, s[16:19], s33 offen lds
    v_mfma_f32_32x32x16_bf16 v[96:111], v[156:159], v[188:191], v[96:111]
    v_mfma_f32_32x32x16_bf16 v[112:127], v[156:159], v[192:195], v[112:127]
    v_mfma_f32_32x32x16_bf16 v[128:143], v[156:159], v[196:199], v[128:143]
    s_waitcnt vmcnt(15) lgkmcnt(0)
    s_barrier
    v_mfma_f32_32x32x16_bf16 v[48:63], v[160:163], v[200:203], v[48:63]
    ds_read_b64_tr_b16 v[144:145], v243 offset:0
    ds_read_b64_tr_b16 v[146:147], v243 offset:1024
    s_add_u32 m0, s38, 82944
    s_add_u32 s33, s46, 10240
    buffer_load_dwordx4 v242, s[16:19], s33 offen lds
    v_mfma_f32_32x32x16_bf16 v[64:79], v[160:163], v[204:207], v[64:79]
    ds_read_b64_tr_b16 v[148:149], v244 offset:0
    ds_read_b64_tr_b16 v[150:151], v244 offset:1024
    v_mfma_f32_32x32x16_bf16 v[80:95], v[160:163], v[208:211], v[80:95]
    ds_read_b128 v[176:179], v247 offset:0
    ds_read_b128 v[180:183], v247 offset:4096
    s_add_u32 m0, s38, 83968
    s_add_u32 s33, s46, 20480
    buffer_load_dwordx4 v241, s[16:19], s33 offen lds
    v_mfma_f32_32x32x16_bf16 v[96:111], v[164:167], v[200:203], v[96:111]
    ds_read_b128 v[184:187], v247 offset:8192
    v_mfma_f32_32x32x16_bf16 v[112:127], v[164:167], v[204:207], v[112:127]
    ds_read_b64_tr_b16 v[152:153], v243 offset:4096
    ds_read_b64_tr_b16 v[154:155], v243 offset:5120
    s_add_u32 m0, s38, 84992
    s_add_u32 s33, s46, 30720
    buffer_load_dwordx4 v242, s[16:19], s33 offen lds
    v_mfma_f32_32x32x16_bf16 v[128:143], v[164:167], v[208:211], v[128:143]
    ds_read_b64_tr_b16 v[156:157], v244 offset:4096
    ds_read_b64_tr_b16 v[158:159], v244 offset:5120
    v_mfma_f32_32x32x16_bf16 v[48:63], v[168:171], v[212:215], v[48:63]
    ds_read_b128 v[188:191], v248 offset:0
    ds_read_b128 v[192:195], v248 offset:4096
    s_add_u32 m0, s38, 86016
    s_add_u32 s33, s46, 40960
    buffer_load_dwordx4 v241, s[16:19], s33 offen lds
    v_mfma_f32_32x32x16_bf16 v[64:79], v[168:171], v[216:219], v[64:79]
    ds_read_b128 v[196:199], v248 offset:8192
    v_mfma_f32_32x32x16_bf16 v[80:95], v[168:171], v[220:223], v[80:95]
    s_add_u32 m0, s38, 87040
    s_add_u32 s33, s46, 51200
    buffer_load_dwordx4 v242, s[16:19], s33 offen lds
    s_add_u32 s44, s44, 1
    s_cmp_eq_u32 s44, 10
    s_cselect_b32 s44, 0, s44
    s_lshl_b32 s45, s44, 19
    s_add_u32 s45, s45, s35
    s_lshl_b32 s46, s44, 7
    s_add_u32 s46, s46, s36
    v_mfma_f32_32x32x16_bf16 v[96:111], v[172:175], v[212:215], v[96:111]
    v_mfma_f32_32x32x16_bf16 v[112:127], v[172:175], v[216:219], v[112:127]
    v_mfma_f32_32x32x16_bf16 v[128:143], v[172:175], v[220:223], v[128:143]
    s_waitcnt lgkmcnt(7)
    v_mfma_f32_32x32x16_bf16 v[48:63], v[144:147], v[176:179], v[48:63]
    ds_read_b64_tr_b16 v[160:161], v243 offset:8192
    ds_read_b64_tr_b16 v[162:163], v243 offset:9216
    s_add_u32 m0, s37, 122880
    s_add_u32 s33, s45, 0
    buffer_load_dwordx4 v240, s[12:15], s33 offen lds
    v_mfma_f32_32x32x16_bf16 v[64:79], v[144:147], v[180:183], v[64:79]
    ds_read_b64_tr_b16 v[164:165], v244 offset:8192
    ds_read_b64_tr_b16 v[166:167], v244 offset:9216
    v_mfma_f32_32x32x16_bf16 v[80:95], v[144:147], v[184:187], v[80:95]
    ds_read_b128 v[200:203], v249 offset:0
    ds_read_b128 v[204:207], v249 offset:4096
    s_add_u32 m0, s37, 123904
    s_add_u32 s33, s45, 32768
    buffer_load_dwordx4 v240, s[12:15], s33 offen lds
    v_mfma_f32_32x32x16_bf16 v[96:111], v[148:151], v[176:179], v[96:111]
    ds_read_b128 v[208:211], v249 offset:8192
    s_waitcnt lgkmcnt(7)
    v_mfma_f32_32x32x16_bf16 v[112:127], v[148:151], v[180:183], v[112:127]
    ds_read_b64_tr_b16 v[168:169], v243 offset:12288
    ds_read_b64_tr_b16 v[170:171], v243 offset:13312
    s_add_u32 m0, s37, 124928
    s_add_u32 s33, s45, 65536
    buffer_load_dwordx4 v240, s[12:15], s33 offen lds
    v_mfma_f32_32x32x16_bf16 v[128:143], v[148:151], v[184:187], v[128:143]
    ds_read_b64_tr_b16 v[172:173], v244 offset:12288
    ds_read_b64_tr_b16 v[174:175], v244 offset:13312
    v_mfma_f32_32x32x16_bf16 v[48:63], v[152:155], v[188:191], v[48:63]
    ds_read_b128 v[212:215], v250 offset:0
    ds_read_b128 v[216:219], v250 offset:4096
    s_add_u32 m0, s37, 125952
    s_add_u32 s33, s45, 98304
    buffer_load_dwordx4 v240, s[12:15], s33 offen lds
    v_mfma_f32_32x32x16_bf16 v[64:79], v[152:155], v[192:195], v[64:79]
    ds_read_b128 v[220:223], v250 offset:8192
    v_mfma_f32_32x32x16_bf16 v[80:95], v[152:155], v[196:199], v[80:95]
    s_add_u32 m0, s38, 122880
    s_add_u32 s33, s46, 0
    buffer_load_dwordx4 v241, s[16:19], s33 offen lds
    v_mfma_f32_32x32x16_bf16 v[96:111], v[156:159], v[188:191], v[96:111]
    v_mfma_f32_32x32x16_bf16 v[112:127], v[156:159], v[192:195], v[112:127]
    v_mfma_f32_32x32x16_bf16 v[128:143], v[156:159], v[196:199], v[128:143]
    s_waitcnt vmcnt(15) lgkmcnt(0)
    s_barrier
    v_mfma_f32_32x32x16_bf16 v[48:63], v[160:163], v[200:203], v[48:63]
    ds_read_b64_tr_b16 v[144:145], v243 offset:40960
    ds_read_b64_tr_b16 v[146:147], v243 offset:41984
    s_add_u32 m0, s38, 123904
    s_add_u32 s33, s46, 10240
    buffer_load_dwordx4 v242, s[16:19], s33 offen lds
    v_mfma_f32_32x32x16_bf16 v[64:79], v[160:163], v[204:207], v[64:79]
    ds_read_b64_tr_b16 v[148:149], v244 offset:40960
    ds_read_b64_tr_b16 v[150:151], v244 offset:41984
    v_mfma_f32_32x32x16_bf16 v[80:95], v[160:163], v[208:211], v[80:95]
    ds_read_b128 v[176:179], v247 offset:40960
    ds_read_b128 v[180:183], v247 offset:45056
    s_add_u32 m0, s38, 124928
    s_add_u32 s33, s46, 20480
    buffer_load_dwordx4 v241, s[16:19], s33 offen lds
    v_mfma_f32_32x32x16_bf16 v[96:111], v[164:167], v[200:203], v[96:111]
    ds_read_b128 v[184:187], v247 offset:49152
    v_mfma_f32_32x32x16_bf16 v[112:127], v[164:167], v[204:207], v[112:127]
    ds_read_b64_tr_b16 v[152:153], v243 offset:45056
    ds_read_b64_tr_b16 v[154:155], v243 offset:46080
    s_add_u32 m0, s38, 125952
    s_add_u32 s33, s46, 30720
    buffer_load_dwordx4 v242, s[16:19], s33 offen lds
    v_mfma_f32_32x32x16_bf16 v[128:143], v[164:167], v[208:211], v[128:143]
    ds_read_b64_tr_b16 v[156:157], v244 offset:45056
    ds_read_b64_tr_b16 v[158:159], v244 offset:46080
    v_mfma_f32_32x32x16_bf16 v[48:63], v[168:171], v[212:215], v[48:63]
    ds_read_b128 v[188:191], v248 offset:40960
    ds_read_b128 v[192:195], v248 offset:45056
    s_add_u32 m0, s38, 126976
    s_add_u32 s33, s46, 40960
    buffer_load_dwordx4 v241, s[16:19], s33 offen lds
    v_mfma_f32_32x32x16_bf16 v[64:79], v[168:171], v[216:219], v[64:79]
    ds_read_b128 v[196:199], v248 offset:49152
    v_mfma_f32_32x32x16_bf16 v[80:95], v[168:171], v[220:223], v[80:95]
    s_add_u32 m0, s38, 128000
    s_add_u32 s33, s46, 51200
    buffer_load_dwordx4 v242, s[16:19], s33 offen lds
    s_add_u32 s44, s44, 1
    s_cmp_eq_u32 s44, 10
    s_cselect_b32 s44, 0, s44
    s_lshl_b32 s45, s44, 19
    s_add_u32 s45, s45, s35
    s_lshl_b32 s46, s44, 7
    s_add_u32 s46, s46, s36
    v_mfma_f32_32x32x16_bf16 v[96:111], v[172:175], v[212:215], v[96:111]
    v_mfma_f32_32x32x16_bf16 v[112:127], v[172:175], v[216:219], v[112:127]
    v_mfma_f32_32x32x16_bf16 v[128:143], v[172:175], v[220:223], v[128:143]
    s_waitcnt lgkmcnt(7)
    v_mfma_f32_32x32x16_bf16 v[48:63], v[144:147], v[176:179], v[48:63]
    ds_read_b64_tr_b16 v[160:161], v243 offset:49152
    ds_read_b64_tr_b16 v[162:163], v243 offset:50176
    s_add_u32 m0, s37, 0
    s_add_u32 s33, s45, 0
    buffer_load_dwordx4 v240, s[12:15], s33 offen lds
    v_mfma_f32_32x32x16_bf16 v[64:79], v[144:147], v[180:183], v[64:79]
    ds_read_b64_tr_b16 v[164:165], v244 offset:49152
    ds_read_b64_tr_b16 v[166:167], v244 offset:50176
    v_mfma_f32_32x32x16_bf16 v[80:95], v[144:147], v[184:187], v[80:95]
    ds_read_b128 v[200:203], v249 offset:40960
    ds_read_b128 v[204:207], v249 offset:45056
    s_add_u32 m0, s37, 1024
    s_add_u32 s33, s45, 32768
    buffer_load_dwordx4 v240, s[12:15], s33 offen lds
    v_mfma_f32_32x32x16_bf16 v[96:111], v[148:151], v[176:179], v[96:111]
    ds_read_b128 v[208:211], v249 offset:49152
    s_waitcnt lgkmcnt(7)
    v_mfma_f32_32x32x16_bf16 v[112:127], v[148:151], v[180:183], v[112:127]
    ds_read_b64_tr_b16 v[168:169], v243 offset:53248
    ds_read_b64_tr_b16 v[170:171], v243 offset:54272
    s_add_u32 m0, s37, 2048
    s_add_u32 s33, s45, 65536
    buffer_load_dwordx4 v240, s[12:15], s33 offen lds
    v_mfma_f32_32x32x16_bf16 v[128:143], v[148:151], v[184:187], v[128:143]
    ds_read_b64_tr_b16 v[172:173], v244 offset:53248
    ds_read_b64_tr_b16 v[174:175], v244 offset:54272
    v_mfma_f32_32x32x16_bf16 v[48:63], v[152:155], v[188:191], v[48:63]
    ds_read_b128 v[212:215], v250 offset:40960
    ds_read_b128 v[216:219], v250 offset:45056
    s_add_u32 m0, s37, 3072
    s_add_u32 s33, s45, 98304
    buffer_load_dwordx4 v240, s[12:15], s33 offen lds
    v_mfma_f32_32x32x16_bf16 v[64:79], v[152:155], v[192:195], v[64:79]
    ds_read_b128 v[220:223], v250 offset:49152
    v_mfma_f32_32x32x16_bf16 v[80:95], v[152:155], v[196:199], v[80:95]
    s_add_u32 m0, s38, 0
    s_add_u32 s33, s46, 0
    buffer_load_dwordx4 v241, s[16:19], s33 offen lds
    v_mfma_f32_32x32x16_bf16 v[96:111], v[156:159], v[188:191], v[96:111]
    v_mfma_f32_32x32x16_bf16 v[112:127], v[156:159], v[192:195], v[112:127]
    v_mfma_f32_32x32x16_bf16 v[128:143], v[156:159], v[196:199], v[128:143]
    s_waitcnt vmcnt(15) lgkmcnt(0)
    s_barrier
    v_mfma_f32_32x32x16_bf16 v[48:63], v[160:163], v[200:203], v[48:63]
    ds_read_b64_tr_b16 v[144:145], v245 offset:0
    ds_read_b64_tr_b16 v[146:147], v245 offset:1024
    s_add_u32 m0, s38, 1024
    s_add_u32 s33, s46, 10240
    buffer_load_dwordx4 v242, s[16:19], s33 offen lds
    v_mfma_f32_32x32x16_bf16 v[64:79], v[160:163], v[204:207], v[64:79]
    ds_read_b64_tr_b16 v[148:149], v246 offset:0
    ds_read_b64_tr_b16 v[150:151], v246 offset:1024
    v_mfma_f32_32x32x16_bf16 v[80:95], v[160:163], v[208:211], v[80:95]
    ds_read_b128 v[176:179], v251 offset:0
    ds_read_b128 v[180:183], v251 offset:4096
    s_add_u32 m0, s38, 2048
    s_add_u32 s33, s46, 20480
    buffer_load_dwordx4 v241, s[16:19], s33 offen lds
    v_mfma_f32_32x32x16_bf16 v[96:111], v[164:167], v[200:203], v[96:111]
    ds_read_b128 v[184:187], v251 offset:8192
    v_mfma_f32_32x32x16_bf16 v[112:127], v[164:167], v[204:207], v[112:127]
    ds_read_b64_tr_b16 v[152:153], v245 offset:4096
    ds_read_b64_tr_b16 v[154:155], v245 offset:5120
    s_add_u32 m0, s38, 3072
    s_add_u32 s33, s46, 30720
    buffer_load_dwordx4 v242, s[16:19], s33 offen lds
    v_mfma_f32_32x32x16_bf16 v[128:143], v[164:167], v[208:211], v[128:143]
    ds_read_b64_tr_b16 v[156:157], v246 offset:4096
    ds_read_b64_tr_b16 v[158:159], v246 offset:5120
    v_mfma_f32_32x32x16_bf16 v[48:63], v[168:171], v[212:215], v[48:63]
    ds_read_b128 v[188:191], v252 offset:0
    ds_read_b128 v[192:195], v252 offset:4096
    s_add_u32 m0, s38, 4096
    s_add_u32 s33, s46, 40960
    buffer_load_dwordx4 v241, s[16:19], s33 offen lds
    v_mfma_f32_32x32x16_bf16 v[64:79], v[168:171], v[216:219], v[64:79]
    ds_read_b128 v[196:199], v252 offset:8192
    v_mfma_f32_32x32x16_bf16 v[80:95], v[168:171], v[220:223], v[80:95]
    s_add_u32 m0, s38, 5120
    s_add_u32 s33, s46, 51200
    buffer_load_dwordx4 v242, s[16:19], s33 offen lds
    s_add_u32 s44, s44, 1
    s_cmp_eq_u32 s44, 10
    s_cselect_b32 s44, 0, s44
    s_lshl_b32 s45, s44, 19
    s_add_u32 s45, s45, s35
    s_lshl_b32 s46, s44, 7
    s_add_u32 s46, s46, s36
    v_mfma_f32_32x32x16_bf16 v[96:111], v[172:175], v[212:215], v[96:111]
    v_mfma_f32_32x32x16_bf16 v[112:127], v[172:175], v[216:219], v[112:127]
    v_mfma_f32_32x32x16_bf16 v[128:143], v[172:175], v[220:223], v[128:143]
    s_waitcnt lgkmcnt(7)
    v_mfma_f32_32x32x16_bf16 v[48:63], v[144:147], v[176:179], v[48:63]
    ds_read_b64_tr_b16 v[160:161], v245 offset:8192
    ds_read_b64_tr_b16 v[162:163], v245 offset:9216
    s_add_u32 m0, s37, 40960
    s_add_u32 s33, s45, 0
    buffer_load_dwordx4 v240, s[12:15], s33 offen lds
    v_mfma_f32_32x32x16_bf16 v[64:79], v[144:147], v[180:183], v[64:79]
    ds_read_b64_tr_b16 v[164:165], v246 offset:8192
    ds_read_b64_tr_b16 v[166:167], v246 offset:9216
    v_mfma_f32_32x32x16_bf16 v[80:95], v[144:147], v[184:187], v[80:95]
    ds_read_b128 v[200:203], v253 offset:0
    ds_read_b128 v[204:207], v253 offset:4096
    s_add_u32 m0, s37, 41984
    s_add_u32 s33, s45, 32768
    buffer_load_dwordx4 v240, s[12:15], s33 offen lds
    v_mfma_f32_32x32x16_bf16 v[96:111], v[148:151], v[176:179], v[96:111]
    ds_read_b128 v[208:211], v253 offset:8192
    s_waitcnt lgkmcnt(7)
    v_mfma_f32_32x32x16_bf16 v[112:127], v[148:151], v[180:183], v[112:127]
    ds_read_b64_tr_b16 v[168:169], v245 offset:12288
    ds_read_b64_tr_b16 v[170:171], v245 offset:13312
    s_add_u32 m0, s37, 43008
    s_add_u32 s33, s45, 65536
    buffer_load_dwordx4 v240, s[12:15], s33 offen lds
    v_mfma_f32_32x32x16_bf16 v[128:143], v[148:151], v[184:187], v[128:143]
    ds_read_b64_tr_b16 v[172:173], v246 offset:12288
    ds_read_b64_tr_b16 v[174:175], v246 offset:13312
    v_mfma_f32_32x32x16_bf16 v[48:63], v[152:155], v[188:191], v[48:63]
    ds_read_b128 v[212:215], v254 offset:0
    ds_read_b128 v[216:219], v254 offset:4096
    s_add_u32 m0, s37, 44032
    s_add_u32 s33, s45, 98304
    buffer_load_dwordx4 v240, s[12:15], s33 offen lds
    v_mfma_f32_32x32x16_bf16 v[64:79], v[152:155], v[192:195], v[64:79]
    ds_read_b128 v[220:223], v254 offset:8192
    v_mfma_f32_32x32x16_bf16 v[80:95], v[152:155], v[196:199], v[80:95]
    s_add_u32 m0, s38, 40960
    s_add_u32 s33, s46, 0
    buffer_load_dwordx4 v241, s[16:19], s33 offen lds
    v_mfma_f32_32x32x16_bf16 v[96:111], v[156:159], v[188:191], v[96:111]
    v_mfma_f32_32x32x16_bf16 v[112:127], v[156:159], v[192:195], v[112:127]
    v_mfma_f32_32x32x16_bf16 v[128:143], v[156:159], v[196:199], v[128:143]
    s_waitcnt vmcnt(15) lgkmcnt(0)
    s_barrier
    v_mfma_f32_32x32x16_bf16 v[48:63], v[160:163], v[200:203], v[48:63]
    ds_read_b64_tr_b16 v[144:145], v245 offset:40960
    ds_read_b64_tr_b16 v[146:147], v245 offset:41984
    s_add_u32 m0, s38, 41984
    s_add_u32 s33, s46, 10240
    buffer_load_dwordx4 v242, s[16:19], s33 offen lds
    v_mfma_f32_32x32x16_bf16 v[64:79], v[160:163], v[204:207], v[64:79]
    ds_read_b64_tr_b16 v[148:149], v246 offset:40960
    ds_read_b64_tr_b16 v[150:151], v246 offset:41984
    v_mfma_f32_32x32x16_bf16 v[80:95], v[160:163], v[208:211], v[80:95]
    ds_read_b128 v[176:179], v251 offset:40960
    ds_read_b128 v[180:183], v251 offset:45056
    s_add_u32 m0, s38, 43008
    s_add_u32 s33, s46, 20480
    buffer_load_dwordx4 v241, s[16:19], s33 offen lds
    v_mfma_f32_32x32x16_bf16 v[96:111], v[164:167], v[200:203], v[96:111]
    ds_read_b128 v[184:187], v251 offset:49152
    v_mfma_f32_32x32x16_bf16 v[112:127], v[164:167], v[204:207], v[112:127]
    ds_read_b64_tr_b16 v[152:153], v245 offset:45056
    ds_read_b64_tr_b16 v[154:155], v245 offset:46080
    s_add_u32 m0, s38, 44032
    s_add_u32 s33, s46, 30720
    buffer_load_dwordx4 v242, s[16:19], s33 offen lds
    v_mfma_f32_32x32x16_bf16 v[128:143], v[164:167], v[208:211], v[128:143]
    ds_read_b64_tr_b16 v[156:157], v246 offset:45056
    ds_read_b64_tr_b16 v[158:159], v246 offset:46080
    v_mfma_f32_32x32x16_bf16 v[48:63], v[168:171], v[212:215], v[48:63]
    ds_read_b128 v[188:191], v252 offset:40960
    ds_read_b128 v[192:195], v252 offset:45056
    s_add_u32 m0, s38, 45056
    s_add_u32 s33, s46, 40960
    buffer_load_dwordx4 v241, s[16:19], s33 offen lds
    v_mfma_f32_32x32x16_bf16 v[64:79], v[168:171], v[216:219], v[64:79]
    ds_read_b128 v[196:199], v252 offset:49152
    v_mfma_f32_32x32x16_bf16 v[80:95], v[168:171], v[220:223], v[80:95]
    s_add_u32 m0, s38, 46080
    s_add_u32 s33, s46, 51200
    buffer_load_dwordx4 v242, s[16:19], s33 offen lds
    s_add_u32 s44, s44, 1
    s_cmp_eq_u32 s44, 10
    s_cselect_b32 s44, 0, s44
    s_lshl_b32 s45, s44, 19
    s_add_u32 s45, s45, s35
    s_lshl_b32 s46, s44, 7
    s_add_u32 s46, s46, s36
    v_mfma_f32_32x32x16_bf16 v[96:111], v[172:175], v[212:215], v[96:111]
    v_mfma_f32_32x32x16_bf16 v[112:127], v[172:175], v[216:219], v[112:127]
    v_mfma_f32_32x32x16_bf16 v[128:143], v[172:175], v[220:223], v[128:143]
    s_waitcnt lgkmcnt(7)
    v_mfma_f32_32x32x16_bf16 v[48:63], v[144:147], v[176:179], v[48:63]
    ds_read_b64_tr_b16 v[160:161], v245 offset:49152
    ds_read_b64_tr_b16 v[162:163], v245 offset:50176
    buffer_load_dwordx4 a[0:3], v3, s[4:7], s40 offen offset:0 nt
    v_mfma_f32_32x32x16_bf16 v[64:79], v[144:147], v[180:183], v[64:79]
    ds_read_b64_tr_b16 v[164:165], v246 offset:49152
    ds_read_b64_tr_b16 v[166:167], v246 offset:50176
    v_mfma_f32_32x32x16_bf16 v[80:95], v[144:147], v[184:187], v[80:95]
    ds_read_b128 v[200:203], v253 offset:40960
    ds_read_b128 v[204:207], v253 offset:45056
    buffer_load_dwordx4 a[4:7], v4, s[4:7], s40 offen offset:1024 nt
    v_mfma_f32_32x32x16_bf16 v[96:111], v[148:151], v[176:179], v[96:111]
    ds_read_b128 v[208:211], v253 offset:49152
    s_waitcnt lgkmcnt(7)
    v_mfma_f32_32x32x16_bf16 v[112:127], v[148:151], v[180:183], v[112:127]
    ds_read_b64_tr_b16 v[168:169], v245 offset:53248
    ds_read_b64_tr_b16 v[170:171], v245 offset:54272
    buffer_load_dwordx4 a[8:11], v5, s[4:7], s40 offen offset:2048 nt
    v_mfma_f32_32x32x16_bf16 v[128:143], v[148:151], v[184:187], v[128:143]
    ds_read_b64_tr_b16 v[172:173], v246 offset:53248
    ds_read_b64_tr_b16 v[174:175], v246 offset:54272
    v_mfma_f32_32x32x16_bf16 v[48:63], v[152:155], v[188:191], v[48:63]
    ds_read_b128 v[212:215], v254 offset:40960
    ds_read_b128 v[216:219], v254 offset:45056
    buffer_load_dwordx4 a[12:15], v6, s[4:7], s40 offen offset:3072 nt
    v_mfma_f32_32x32x16_bf16 v[64:79], v[152:155], v[192:195], v[64:79]
    ds_read_b128 v[220:223], v254 offset:49152
    v_mfma_f32_32x32x16_bf16 v[80:95], v[152:155], v[196:199], v[80:95]
    buffer_load_dwordx4 a[16:19], v3, s[4:7], s41 offen offset:0 nt
    v_mfma_f32_32x32x16_bf16 v[96:111], v[156:159], v[188:191], v[96:111]
    v_mfma_f32_32x32x16_bf16 v[112:127], v[156:159], v[192:195], v[112:127]
    v_mfma_f32_32x32x16_bf16 v[128:143], v[156:159], v[196:199], v[128:143]
    s_waitcnt vmcnt(15) lgkmcnt(0)
    s_barrier
    v_mfma_f32_32x32x16_bf16 v[48:63], v[160:163], v[200:203], v[48:63]
    ds_read_b64_tr_b16 v[144:145], v243 offset:0
    ds_read_b64_tr_b16 v[146:147], v243 offset:1024
    buffer_load_dwordx4 a[20:23], v4, s[4:7], s41 offen offset:1024 nt
    v_mfma_f32_32x32x16_bf16 v[64:79], v[160:163], v[204:207], v[64:79]
    ds_read_b64_tr_b16 v[148:149], v244 offset:0
    ds_read_b64_tr_b16 v[150:151], v244 offset:1024
    v_mfma_f32_32x32x16_bf16 v[80:95], v[160:163], v[208:211], v[80:95]
    ds_read_b128 v[176:179], v247 offset:0
    ds_read_b128 v[180:183], v247 offset:4096
    buffer_load_dwordx4 a[24:27], v5, s[4:7], s41 offen offset:2048 nt
    v_mfma_f32_32x32x16_bf16 v[96:111], v[164:167], v[200:203], v[96:111]
    ds_read_b128 v[184:187], v247 offset:8192
    v_mfma_f32_32x32x16_bf16 v[112:127], v[164:167], v[204:207], v[112:127]
    ds_read_b64_tr_b16 v[152:153], v243 offset:4096
    ds_read_b64_tr_b16 v[154:155], v243 offset:5120
    buffer_load_dwordx4 a[28:31], v6, s[4:7], s41 offen offset:3072 nt
    v_mfma_f32_32x32x16_bf16 v[128:143], v[164:167], v[208:211], v[128:143]
    ds_read_b64_tr_b16 v[156:157], v244 offset:4096
    ds_read_b64_tr_b16 v[158:159], v244 offset:5120
    v_mfma_f32_32x32x16_bf16 v[48:63], v[168:171], v[212:215], v[48:63]
    ds_read_b128 v[188:191], v248 offset:0
    ds_read_b128 v[192:195], v248 offset:4096
    buffer_load_dwordx4 a[32:35], v7, s[8:11], s40 offen offset:0 nt
    v_mfma_f32_32x32x16_bf16 v[64:79], v[168:171], v[216:219], v[64:79]
    ds_read_b128 v[196:199], v248 offset:8192
    v_mfma_f32_32x32x16_bf16 v[80:95], v[168:171], v[220:223], v[80:95]
    buffer_load_dwordx4 a[36:39], v7, s[8:11], s40 offen offset:1024 nt
    v_mfma_f32_32x32x16_bf16 v[96:111], v[172:175], v[212:215], v[96:111]
    v_mfma_f32_32x32x16_bf16 v[112:127], v[172:175], v[216:219], v[112:127]
    v_mfma_f32_32x32x16_bf16 v[128:143], v[172:175], v[220:223], v[128:143]
    s_waitcnt lgkmcnt(7)
    v_mfma_f32_32x32x16_bf16 v[48:63], v[144:147], v[176:179], v[48:63]
    ds_read_b64_tr_b16 v[160:161], v243 offset:8192
    ds_read_b64_tr_b16 v[162:163], v243 offset:9216
    buffer_load_dwordx4 a[40:43], v7, s[8:11], s40 offen offset:2048 nt
    v_mfma_f32_32x32x16_bf16 v[64:79], v[144:147], v[180:183], v[64:79]
    ds_read_b64_tr_b16 v[164:165], v244 offset:8192
    ds_read_b64_tr_b16 v[166:167], v244 offset:9216
    buffer_load_dwordx4 a[44:47], v7, s[8:11], s40 offen offset:3072 nt
    v_mfma_f32_32x32x16_bf16 v[80:95], v[144:147], v[184:187], v[80:95]
    ds_read_b128 v[200:203], v249 offset:0
    ds_read_b128 v[204:207], v249 offset:4096
    v_mfma_f32_32x32x16_bf16 v[96:111], v[148:151], v[176:179], v[96:111]
    ds_read_b128 v[208:211], v249 offset:8192
    s_waitcnt lgkmcnt(7)
    buffer_load_dwordx4 a[48:51], v7, s[8:11], s41 offen offset:0 nt
    v_mfma_f32_32x32x16_bf16 v[112:127], v[148:151], v[180:183], v[112:127]
    ds_read_b64_tr_b16 v[168:169], v243 offset:12288
    ds_read_b64_tr_b16 v[170:171], v243 offset:13312
    v_mfma_f32_32x32x16_bf16 v[128:143], v[148:151], v[184:187], v[128:143]
    ds_read_b64_tr_b16 v[172:173], v244 offset:12288
    ds_read_b64_tr_b16 v[174:175], v244 offset:13312
    buffer_load_dwordx4 a[52:55], v7, s[8:11], s41 offen offset:1024 nt
    v_mfma_f32_32x32x16_bf16 v[48:63], v[152:155], v[188:191], v[48:63]
    ds_read_b128 v[212:215], v250 offset:0
    ds_read_b128 v[216:219], v250 offset:4096
    v_mfma_f32_32x32x16_bf16 v[64:79], v[152:155], v[192:195], v[64:79]
    ds_read_b128 v[220:223], v250 offset:8192
    buffer_load_dwordx4 a[56:59], v7, s[8:11], s41 offen offset:2048 nt
    v_mfma_f32_32x32x16_bf16 v[80:95], v[152:155], v[196:199], v[80:95]
    v_mfma_f32_32x32x16_bf16 v[96:111], v[156:159], v[188:191], v[96:111]
    buffer_load_dwordx4 a[60:63], v7, s[8:11], s41 offen offset:3072 nt
    v_mfma_f32_32x32x16_bf16 v[112:127], v[156:159], v[192:195], v[112:127]
    v_mfma_f32_32x32x16_bf16 v[128:143], v[156:159], v[196:199], v[128:143]
    s_waitcnt vmcnt(16) lgkmcnt(0)
    s_barrier
    v_mfma_f32_32x32x16_bf16 v[48:63], v[160:163], v[200:203], v[48:63]
    ds_read_b64_tr_b16 v[144:145], v243 offset:40960
    ds_read_b64_tr_b16 v[146:147], v243 offset:41984
    buffer_load_dwordx4 a[64:67], v3, s[4:7], s42 offen offset:0 nt
    v_mfma_f32_32x32x16_bf16 v[64:79], v[160:163], v[204:207], v[64:79]
    ds_read_b64_tr_b16 v[148:149], v244 offset:40960
    ds_read_b64_tr_b16 v[150:151], v244 offset:41984
    v_mfma_f32_32x32x16_bf16 v[80:95], v[160:163], v[208:211], v[80:95]
    ds_read_b128 v[176:179], v247 offset:40960
    ds_read_b128 v[180:183], v247 offset:45056
    buffer_load_dwordx4 a[68:71], v4, s[4:7], s42 offen offset:1024 nt
    v_mfma_f32_32x32x16_bf16 v[96:111], v[164:167], v[200:203], v[96:111]
    ds_read_b128 v[184:187], v247 offset:49152
    v_mfma_f32_32x32x16_bf16 v[112:127], v[164:167], v[204:207], v[112:127]
    ds_read_b64_tr_b16 v[152:153], v243 offset:45056
    ds_read_b64_tr_b16 v[154:155], v243 offset:46080
    buffer_load_dwordx4 a[72:75], v5, s[4:7], s42 offen offset:2048 nt
    v_mfma_f32_32x32x16_bf16 v[128:143], v[164:167], v[208:211], v[128:143]
    ds_read_b64_tr_b16 v[156:157], v244 offset:45056
    ds_read_b64_tr_b16 v[158:159], v244 offset:46080
    v_mfma_f32_32x32x16_bf16 v[48:63], v[168:171], v[212:215], v[48:63]
    ds_read_b128 v[188:191], v248 offset:40960
    ds_read_b128 v[192:195], v248 offset:45056
    buffer_load_dwordx4 a[76:79], v6, s[4:7], s42 offen offset:3072 nt
    v_mfma_f32_32x32x16_bf16 v[64:79], v[168:171], v[216:219], v[64:79]
    ds_read_b128 v[196:199], v248 offset:49152
    v_mfma_f32_32x32x16_bf16 v[80:95], v[168:171], v[220:223], v[80:95]
    buffer_load_dwordx4 a[80:83], v3, s[4:7], s43 offen offset:0 nt
    v_mfma_f32_32x32x16_bf16 v[96:111], v[172:175], v[212:215], v[96:111]
    v_mfma_f32_32x32x16_bf16 v[112:127], v[172:175], v[216:219], v[112:127]
    v_mfma_f32_32x32x16_bf16 v[128:143], v[172:175], v[220:223], v[128:143]
    s_waitcnt lgkmcnt(7)
    v_mfma_f32_32x32x16_bf16 v[48:63], v[144:147], v[176:179], v[48:63]
    ds_read_b64_tr_b16 v[160:161], v243 offset:49152
    ds_read_b64_tr_b16 v[162:163], v243 offset:50176
    buffer_load_dwordx4 a[84:87], v4, s[4:7], s43 offen offset:1024 nt
    v_mfma_f32_32x32x16_bf16 v[64:79], v[144:147], v[180:183], v[64:79]
    ds_read_b64_tr_b16 v[164:165], v244 offset:49152
    ds_read_b64_tr_b16 v[166:167], v244 offset:50176
    v_mfma_f32_32x32x16_bf16 v[80:95], v[144:147], v[184:187], v[80:95]
    ds_read_b128 v[200:203], v249 offset:40960
    ds_read_b128 v[204:207], v249 offset:45056
    buffer_load_dwordx4 a[88:91], v5, s[4:7], s43 offen offset:2048 nt
    v_mfma_f32_32x32x16_bf16 v[96:111], v[148:151], v[176:179], v[96:111]
    ds_read_b128 v[208:211], v249 offset:49152
    s_waitcnt lgkmcnt(7)
    v_mfma_f32_32x32x16_bf16 v[112:127], v[148:151], v[180:183], v[112:127]
    ds_read_b64_tr_b16 v[168:169], v243 offset:53248
    ds_read_b64_tr_b16 v[170:171], v243 offset:54272
    buffer_load_dwordx4 a[92:95], v6, s[4:7], s43 offen offset:3072 nt
    v_mfma_f32_32x32x16_bf16 v[128:143], v[148:151], v[184:187], v[128:143]
    ds_read_b64_tr_b16 v[172:173], v244 offset:53248
    ds_read_b64_tr_b16 v[174:175], v244 offset:54272
    v_mfma_f32_32x32x16_bf16 v[48:63], v[152:155], v[188:191], v[48:63]
    ds_read_b128 v[212:215], v250 offset:40960
    ds_read_b128 v[216:219], v250 offset:45056
    buffer_load_dwordx4 a[96:99], v7, s[8:11], s42 offen offset:0 nt
    v_mfma_f32_32x32x16_bf16 v[64:79], v[152:155], v[192:195], v[64:79]
    ds_read_b128 v[220:223], v250 offset:49152
    v_mfma_f32_32x32x16_bf16 v[80:95], v[152:155], v[196:199], v[80:95]
    buffer_load_dwordx4 a[100:103], v7, s[8:11], s42 offen offset:1024 nt
    v_mfma_f32_32x32x16_bf16 v[96:111], v[156:159], v[188:191], v[96:111]
    v_mfma_f32_32x32x16_bf16 v[112:127], v[156:159], v[192:195], v[112:127]
    v_add_u32 v15, s31, v0
    v_mfma_f32_32x32x16_bf16 v[128:143], v[156:159], v[196:199], v[128:143]
    s_waitcnt lgkmcnt(0)
    s_barrier
    v_mfma_f32_32x32x16_bf16 v[48:63], v[160:163], v[200:203], v[48:63]
    s_waitcnt vmcnt(18)
    ds_write_b128 v15, a[0:3] offset:0
    buffer_load_dwordx4 a[104:107], v7, s[8:11], s42 offen offset:2048 nt
    v_mfma_f32_32x32x16_bf16 v[64:79], v[160:163], v[204:207], v[64:79]
    ds_write_b128 v15, a[4:7] offset:1024
    buffer_load_dwordx4 a[108:111], v7, s[8:11], s42 offen offset:3072 nt
    v_mfma_f32_32x32x16_bf16 v[80:95], v[160:163], v[208:211], v[80:95]
    ds_write_b128 v15, a[8:11] offset:2048
    v_mfma_f32_32x32x16_bf16 v[96:111], v[164:167], v[200:203], v[96:111]
    ds_write_b128 v15, a[12:15] offset:3072
    buffer_load_dwordx4 a[112:115], v7, s[8:11], s43 offen offset:0 nt
    v_mfma_f32_32x32x16_bf16 v[112:127], v[164:167], v[204:207], v[112:127]
    ds_write_b128 v15, a[16:19] offset:4096
    v_mfma_f32_32x32x16_bf16 v[128:143], v[164:167], v[208:211], v[128:143]
    ds_write_b128 v15, a[20:23] offset:5120
    buffer_load_dwordx4 a[116:119], v7, s[8:11], s43 offen offset:1024 nt
    v_mfma_f32_32x32x16_bf16 v[48:63], v[168:171], v[212:215], v[48:63]
    ds_write_b128 v15, a[24:27] offset:6144
    v_mfma_f32_32x32x16_bf16 v[64:79], v[168:171], v[216:219], v[64:79]
    ds_write_b128 v15, a[28:31] offset:7168
    buffer_load_dwordx4 a[120:123], v7, s[8:11], s43 offen offset:2048 nt
    v_mfma_f32_32x32x16_bf16 v[80:95], v[168:171], v[220:223], v[80:95]
    s_add_u32 s33, s28, 2
    s_lshr_b32 s34, s33, 3
    s_lshl_b32 s34, s34, 25
    s_add_u32 s33, s33, s58
    s_and_b32 s33, s33, 7
    s_lshl_b32 s33, s33, 15
    s_add_u32 s29, s33, s34
    v_mfma_f32_32x32x16_bf16 v[96:111], v[172:175], v[212:215], v[96:111]
    s_add_u32 s29, s29, s32
    s_add_u32 s30, s29, 4096
    v_mov_b32 v16, 0x3e0293ee
    v_mov_b32 v17, 0x3e0293ee
    buffer_load_dwordx4 a[124:127], v7, s[8:11], s43 offen offset:3072 nt
    v_mfma_f32_32x32x16_bf16 v[112:127], v[172:175], v[216:219], v[112:127]
    v_add_u32 v18, s57, v0
    v_add_u32 v19, s59, v18
    v_add_u32 v20, s59, v19
    v_mfma_f32_32x32x16_bf16 v[128:143], v[172:175], v[220:223], v[128:143]
    ds_read_b128 v[144:147], v1
    v_xor_b32 v13, 32, v1
    ds_read_b128 v[148:151], v13
    v_xor_b32 v12, 64, v1
    ds_read_b128 v[152:155], v12
    v_xor_b32 v13, 96, v1
    ds_read_b128 v[156:159], v13
    v_xor_b32 v12, 128, v1
    ds_read_b128 v[160:163], v12
    v_xor_b32 v13, 160, v1
    ds_read_b128 v[164:167], v13
    v_xor_b32 v12, 192, v1
    ds_read_b128 v[168:171], v12
    v_xor_b32 v13, 224, v1
    ds_read_b128 v[172:175], v13
    v_xor_b32 v1, 0x4000, v1
    v_pk_mul_f32 v[48:49], v[48:49], v[16:17]
    v_pk_mul_f32 v[50:51], v[50:51], v[16:17]
    v_pk_mul_f32 v[52:53], v[52:53], v[16:17]
    v_pk_mul_f32 v[54:55], v[54:55], v[16:17]
    v_pk_mul_f32 v[56:57], v[56:57], v[16:17]
    v_pk_mul_f32 v[58:59], v[58:59], v[16:17]
    v_pk_mul_f32 v[60:61], v[60:61], v[16:17]
    v_pk_mul_f32 v[62:63], v[62:63], v[16:17]
    s_waitcnt lgkmcnt(0)
    s_add_u32 m0, s31, 0
    s_nop 0
    buffer_load_dwordx4 v3, s[4:7], s29 offen offset:0 nt lds
    v_cvt_pk_bf16_f32 v176, v48, v49
    v_cvt_pk_bf16_f32 v177, v50, v51
    v_cvt_pk_bf16_f32 v178, v52, v53
    v_cvt_pk_bf16_f32 v179, v54, v55
    v_cvt_pk_bf16_f32 v180, v56, v57
    v_cvt_pk_bf16_f32 v181, v58, v59
    v_cvt_pk_bf16_f32 v182, v60, v61
    v_cvt_pk_bf16_f32 v183, v62, v63
    buffer_load_dwordx4 v4, s[4:7], s29 offen offset:1024 nt lds
    ds_write_b128 v18, v[176:179] offset:0
    ds_write_b128 v18, v[180:183] offset:1024
    v_pk_mul_f32 v[64:65], v[64:65], v[16:17]
    v_pk_mul_f32 v[66:67], v[66:67], v[16:17]
    v_pk_mul_f32 v[68:69], v[68:69], v[16:17]
    v_pk_mul_f32 v[70:71], v[70:71], v[16:17]
    v_pk_mul_f32 v[72:73], v[72:73], v[16:17]
    v_pk_mul_f32 v[74:75], v[74:75], v[16:17]
    v_pk_mul_f32 v[76:77], v[76:77], v[16:17]
    v_pk_mul_f32 v[78:79], v[78:79], v[16:17]
    buffer_load_dwordx4 v5, s[4:7], s29 offen offset:2048 nt lds
    v_cvt_pk_bf16_f32 v184, v64, v65
    v_cvt_pk_bf16_f32 v185, v66, v67
    v_cvt_pk_bf16_f32 v186, v68, v69
    v_cvt_pk_bf16_f32 v187, v70, v71
    v_cvt_pk_bf16_f32 v188, v72, v73
    v_cvt_pk_bf16_f32 v189, v74, v75
    v_cvt_pk_bf16_f32 v190, v76, v77
    v_cvt_pk_bf16_f32 v191, v78, v79
    buffer_load_dwordx4 v6, s[4:7], s29 offen offset:3072 nt lds
    ds_write_b128 v19, v[184:187] offset:0
    ds_write_b128 v19, v[188:191] offset:1024
    v_pk_mul_f32 v[80:81], v[80:81], v[16:17]
    v_pk_mul_f32 v[82:83], v[82:83], v[16:17]
    v_pk_mul_f32 v[84:85], v[84:85], v[16:17]
    v_pk_mul_f32 v[86:87], v[86:87], v[16:17]
    v_pk_mul_f32 v[88:89], v[88:89], v[16:17]
    v_pk_mul_f32 v[90:91], v[90:91], v[16:17]
    v_pk_mul_f32 v[92:93], v[92:93], v[16:17]
    v_pk_mul_f32 v[94:95], v[94:95], v[16:17]
    s_add_u32 m0, s31, 4096
    s_nop 0
    buffer_load_dwordx4 v3, s[4:7], s30 offen offset:0 nt lds
    v_cvt_pk_bf16_f32 v192, v80, v81
    v_cvt_pk_bf16_f32 v193, v82, v83
    v_cvt_pk_bf16_f32 v194, v84, v85
    v_cvt_pk_bf16_f32 v195, v86, v87
    v_cvt_pk_bf16_f32 v196, v88, v89
    v_cvt_pk_bf16_f32 v197, v90, v91
    v_cvt_pk_bf16_f32 v198, v92, v93
    v_cvt_pk_bf16_f32 v199, v94, v95
    buffer_load_dwordx4 v4, s[4:7], s30 offen offset:1024 nt lds
    ds_write_b128 v20, v[192:195] offset:0
    ds_write_b128 v20, v[196:199] offset:1024
    v_pk_mul_f32 v[96:97], v[96:97], v[16:17]
    v_pk_mul_f32 v[98:99], v[98:99], v[16:17]
    v_pk_mul_f32 v[100:101], v[100:101], v[16:17]
    v_pk_mul_f32 v[102:103], v[102:103], v[16:17]
    v_pk_mul_f32 v[104:105], v[104:105], v[16:17]
    v_pk_mul_f32 v[106:107], v[106:107], v[16:17]
    v_pk_mul_f32 v[108:109], v[108:109], v[16:17]
    v_pk_mul_f32 v[110:111], v[110:111], v[16:17]
    buffer_load_dwordx4 v5, s[4:7], s30 offen offset:2048 nt lds
    v_cvt_pk_bf16_f32 v200, v96, v97
    v_cvt_pk_bf16_f32 v201, v98, v99
    v_cvt_pk_bf16_f32 v202, v100, v101
    v_cvt_pk_bf16_f32 v203, v102, v103
    v_cvt_pk_bf16_f32 v204, v104, v105
    v_cvt_pk_bf16_f32 v205, v106, v107
    v_cvt_pk_bf16_f32 v206, v108, v109
    v_cvt_pk_bf16_f32 v207, v110, v111
    buffer_load_dwordx4 v6, s[4:7], s30 offen offset:3072 nt lds
    ds_write_b128 v18, v[200:203] offset:2048
    ds_write_b128 v18, v[204:207] offset:3072
    v_pk_mul_f32 v[112:113], v[112:113], v[16:17]
    v_pk_mul_f32 v[114:115], v[114:115], v[16:17]
    v_pk_mul_f32 v[116:117], v[116:117], v[16:17]
    v_pk_mul_f32 v[118:119], v[118:119], v[16:17]
    v_pk_mul_f32 v[120:121], v[120:121], v[16:17]
    v_pk_mul_f32 v[122:123], v[122:123], v[16:17]
    v_pk_mul_f32 v[124:125], v[124:125], v[16:17]
    v_pk_mul_f32 v[126:127], v[126:127], v[16:17]
    v_cvt_pk_bf16_f32 v208, v112, v113
    v_cvt_pk_bf16_f32 v209, v114, v115
    v_cvt_pk_bf16_f32 v210, v116, v117
    v_cvt_pk_bf16_f32 v211, v118, v119
    v_cvt_pk_bf16_f32 v212, v120, v121
    v_cvt_pk_bf16_f32 v213, v122, v123
    v_cvt_pk_bf16_f32 v214, v124, v125
    v_cvt_pk_bf16_f32 v215, v126, v127
    ds_write_b128 v19, v[208:211] offset:2048
    ds_write_b128 v19, v[212:215] offset:3072
    v_pk_mul_f32 v[128:129], v[128:129], v[16:17]
    v_pk_mul_f32 v[130:131], v[130:131], v[16:17]
    v_pk_mul_f32 v[132:133], v[132:133], v[16:17]
    v_pk_mul_f32 v[134:135], v[134:135], v[16:17]
    v_pk_mul_f32 v[136:137], v[136:137], v[16:17]
    v_pk_mul_f32 v[138:139], v[138:139], v[16:17]
    v_pk_mul_f32 v[140:141], v[140:141], v[16:17]
    v_pk_mul_f32 v[142:143], v[142:143], v[16:17]
    v_cvt_pk_bf16_f32 v216, v128, v129
    v_cvt_pk_bf16_f32 v217, v130, v131
    v_cvt_pk_bf16_f32 v218, v132, v133
    v_cvt_pk_bf16_f32 v219, v134, v135
    v_cvt_pk_bf16_f32 v220, v136, v137
    v_cvt_pk_bf16_f32 v221, v138, v139
    v_cvt_pk_bf16_f32 v222, v140, v141
    v_cvt_pk_bf16_f32 v223, v142, v143
    ds_write_b128 v20, v[216:219] offset:2048
    ds_write_b128 v20, v[220:223] offset:3072
    s_waitcnt vmcnt(24)
    ds_write_b128 v15, a[32:35] offset:8192
    ds_write_b128 v15, a[36:39] offset:9216
    ds_write_b128 v15, a[40:43] offset:10240
    ds_write_b128 v15, a[44:47] offset:11264
    ds_write_b128 v15, a[48:51] offset:12288
    ds_write_b128 v15, a[52:55] offset:13312
    ds_write_b128 v15, a[56:59] offset:14336
    ds_write_b128 v15, a[60:63] offset:15360
    s_waitcnt lgkmcnt(8)
    s_barrier
    v_add_u32 v12, 0x10000, v0
    ds_read_b128 a[192:195], v0 offset:24576
    ds_read_b128 a[196:199], v0 offset:25600
    ds_read_b128 a[200:203], v0 offset:26624
    ds_read_b128 a[204:207], v0 offset:27648
    ds_read_b128 a[208:211], v0 offset:28672
    ds_read_b128 a[212:215], v0 offset:29696
    ds_read_b128 a[216:219], v0 offset:30720
    ds_read_b128 a[220:223], v0 offset:31744
    ds_read_b128 a[224:227], v0 offset:57344
    ds_read_b128 a[228:231], v0 offset:58368
    ds_read_b128 a[232:235], v0 offset:59392
    ds_read_b128 a[236:239], v0 offset:60416
    ds_read_b128 a[240:243], v0 offset:61440
    ds_read_b128 a[244:247], v0 offset:62464
    ds_read_b128 a[248:251], v0 offset:63488
    ds_read_b128 a[252:255], v0 offset:64512
    ds_read_b128 v[208:211], v12 offset:24576
    ds_read_b128 v[212:215], v12 offset:25600
    ds_read_b128 v[216:219], v12 offset:26624
    ds_read_b128 v[220:223], v12 offset:27648
    ds_read_b128 v[224:227], v12 offset:28672
    ds_read_b128 v[228:231], v12 offset:29696
    ds_read_b128 v[232:235], v12 offset:30720
    ds_read_b128 v[236:239], v12 offset:31744
    s_waitcnt vmcnt(16)
    ds_write_b128 v15, a[64:67] offset:16384
    ds_write_b128 v15, a[68:71] offset:17408
    ds_write_b128 v15, a[72:75] offset:18432
    ds_write_b128 v15, a[76:79] offset:19456
    ds_write_b128 v15, a[80:83] offset:20480
    ds_write_b128 v15, a[84:87] offset:21504
    ds_write_b128 v15, a[88:91] offset:22528
    ds_write_b128 v15, a[92:95] offset:23552
    s_branch QEND
QA:
    s_add_u32 m0, s37, 0
    s_add_u32 s33, s45, 0
    buffer_load_dwordx4 v240, s[12:15], s33 offen lds
    s_add_u32 m0, s37, 1024
    s_add_u32 s33, s45, 32768
    buffer_load_dwordx4 v240, s[12:15], s33 offen lds
    s_add_u32 m0, s37, 2048
    s_add_u32 s33, s45, 65536
    buffer_load_dwordx4 v240, s[12:15], s33 offen lds
    s_add_u32 m0, s37, 3072
    s_add_u32 s33, s45, 98304
    buffer_load_dwordx4 v240, s[12:15], s33 offen lds
    s_add_u32 m0, s38, 0
    s_add_u32 s33, s46, 0
    buffer_load_dwordx4 v241, s[16:19], s33 offen lds
    s_add_u32 m0, s38, 1024
    s_add_u32 s33, s46, 10240
    buffer_load_dwordx4 v242, s[16:19], s33 offen lds
    s_add_u32 m0, s38, 2048
    s_add_u32 s33, s46, 20480
    buffer_load_dwordx4 v241, s[16:19], s33 offen lds
    s_add_u32 m0, s38, 3072
    s_add_u32 s33, s46, 30720
    buffer_load_dwordx4 v242, s[16:19], s33 offen lds
    s_add_u32 m0, s38, 4096
    s_add_u32 s33, s46, 40960
    buffer_load_dwordx4 v241, s[16:19], s33 offen lds
    s_add_u32 m0, s38, 5120
    s_add_u32 s33, s46, 51200
    buffer_load_dwordx4 v242, s[16:19], s33 offen lds
    s_add_u32 s44, s44, 1
    s_cmp_eq_u32 s44, 10
    s_cselect_b32 s44, 0, s44
    s_lshl_b32 s45, s44, 19
    s_add_u32 s45, s45, s35
    s_lshl_b32 s46, s44, 7
    s_add_u32 s46, s46, s36
    s_add_u32 m0, s37, 40960
    s_add_u32 s33, s45, 0
    buffer_load_dwordx4 v240, s[12:15], s33 offen lds
    s_add_u32 m0, s37, 41984
    s_add_u32 s33, s45, 32768
    buffer_load_dwordx4 v240, s[12:15], s33 offen lds
    s_add_u32 m0, s37, 43008
    s_add_u32 s33, s45, 65536
    buffer_load_dwordx4 v240, s[12:15], s33 offen lds
    s_add_u32 m0, s37, 44032
    s_add_u32 s33, s45, 98304
    buffer_load_dwordx4 v240, s[12:15], s33 offen lds
    s_add_u32 m0, s38, 40960
    s_add_u32 s33, s46, 0
    buffer_load_dwordx4 v241, s[16:19], s33 offen lds
    s_add_u32 m0, s38, 41984
    s_add_u32 s33, s46, 10240
    buffer_load_dwordx4 v242, s[16:19], s33 offen lds
    s_add_u32 m0, s38, 43008
    s_add_u32 s33, s46, 20480
    buffer_load_dwordx4 v241, s[16:19], s33 offen lds
    s_add_u32 m0, s38, 44032
    s_add_u32 s33, s46, 30720
    buffer_load_dwordx4 v242, s[16:19], s33 offen lds
    s_add_u32 m0, s38, 45056
    s_add_u32 s33, s46, 40960
    buffer_load_dwordx4 v241, s[16:19], s33 offen lds
    s_add_u32 m0, s38, 46080
    s_add_u32 s33, s46, 51200
    buffer_load_dwordx4 v242, s[16:19], s33 offen lds
    s_add_u32 s44, s44, 1
    s_cmp_eq_u32 s44, 10
    s_cselect_b32 s44, 0, s44
    s_lshl_b32 s45, s44, 19
    s_add_u32 s45, s45, s35
    s_lshl_b32 s46, s44, 7
    s_add_u32 s46, s46, s36
    s_waitcnt vmcnt(10) lgkmcnt(0)
    s_barrier
    ds_read_b64_tr_b16 v[144:145], v243 offset:0
    ds_read_b64_tr_b16 v[146:147], v243 offset:1024
    ds_read_b64_tr_b16 v[148:149], v244 offset:0
    ds_read_b64_tr_b16 v[150:151], v244 offset:1024
    ds_read_b128 v[176:179], v247 offset:0
    ds_read_b128 v[180:183], v247 offset:4096
    ds_read_b128 v[184:187], v247 offset:8192
    ds_read_b64_tr_b16 v[152:153], v243 offset:4096
    ds_read_b64_tr_b16 v[154:155], v243 offset:5120
    ds_read_b64_tr_b16 v[156:157], v244 offset:4096
    ds_read_b64_tr_b16 v[158:159], v244 offset:5120
    ds_read_b128 v[188:191], v248 offset:0
    ds_read_b128 v[192:195], v248 offset:4096
    ds_read_b128 v[196:199], v248 offset:8192
    s_waitcnt lgkmcnt(7)
    v_mfma_f32_32x32x16_bf16 v[48:63], v[144:147], v[176:179], 0
    ds_read_b64_tr_b16 v[160:161], v243 offset:8192
    ds_read_b64_tr_b16 v[162:163], v243 offset:9216
    s_add_u32 m0, s37, 81920
    s_add_u32 s33, s45, 0
    buffer_load_dwordx4 v240, s[12:15], s33 offen lds
    v_mfma_f32_32x32x16_bf16 v[64:79], v[144:147], v[180:183], 0
    ds_read_b64_tr_b16 v[164:165], v244 offset:8192
    ds_read_b64_tr_b16 v[166:167], v244 offset:9216
    s_add_u32 m0, s37, 82944
    s_add_u32 s33, s45, 32768
    buffer_load_dwordx4 v240, s[12:15], s33 offen lds
    v_mfma_f32_32x32x16_bf16 v[80:95], v[144:147], v[184:187], 0
    ds_read_b128 v[200:203], v249 offset:0
    ds_read_b128 v[204:207], v249 offset:4096
    s_add_u32 m0, s37, 83968
    s_add_u32 s33, s45, 65536
    buffer_load_dwordx4 v240, s[12:15], s33 offen lds
    v_mfma_f32_32x32x16_bf16 v[96:111], v[148:151], v[176:179], 0
    ds_read_b128 v[208:211], v249 offset:8192
    s_waitcnt lgkmcnt(7)
    s_add_u32 m0, s37, 84992
    s_add_u32 s33, s45, 98304
    buffer_load_dwordx4 v240, s[12:15], s33 offen lds
    v_mfma_f32_32x32x16_bf16 v[112:127], v[148:151], v[180:183], 0
    ds_read_b64_tr_b16 v[168:169], v243 offset:12288
    ds_read_b64_tr_b16 v[170:171], v243 offset:13312
    s_add_u32 m0, s38, 81920
    s_add_u32 s33, s46, 0
    buffer_load_dwordx4 v241, s[16:19], s33 offen lds
    v_mfma_f32_32x32x16_bf16 v[128:143], v[148:151], v[184:187], 0
    ds_read_b64_tr_b16 v[172:173], v244 offset:12288
    ds_read_b64_tr_b16 v[174:175], v244 offset:13312
    s_add_u32 m0, s38, 82944
    s_add_u32 s33, s46, 10240
    buffer_load_dwordx4 v242, s[16:19], s33 offen lds
    v_mfma_f32_32x32x16_bf16 v[48:63], v[152:155], v[188:191], v[48:63]
    ds_read_b128 v[212:215], v250 offset:0
    ds_read_b128 v[216:219], v250 offset:4096
    s_add_u32 m0, s38, 83968
    s_add_u32 s33, s46, 20480
    buffer_load_dwordx4 v241, s[16:19], s33 offen lds
    v_mfma_f32_32x32x16_bf16 v[64:79], v[152:155], v[192:195], v[64:79]
    ds_read_b128 v[220:223], v250 offset:8192
    s_add_u32 m0, s38, 84992
    s_add_u32 s33, s46, 30720
    buffer_load_dwordx4 v242, s[16:19], s33 offen lds
    v_mfma_f32_32x32x16_bf16 v[80:95], v[152:155], v[196:199], v[80:95]
    s_add_u32 m0, s38, 86016
    s_add_u32 s33, s46, 40960
    buffer_load_dwordx4 v241, s[16:19], s33 offen lds
    v_mfma_f32_32x32x16_bf16 v[96:111], v[156:159], v[188:191], v[96:111]
    s_add_u32 m0, s38, 87040
    s_add_u32 s33, s46, 51200
    buffer_load_dwordx4 v242, s[16:19], s33 offen lds
    s_add_u32 s44, s44, 1
    s_cmp_eq_u32 s44, 10
    s_cselect_b32 s44, 0, s44
    s_lshl_b32 s45, s44, 19
    s_add_u32 s45, s45, s35
    s_lshl_b32 s46, s44, 7
    s_add_u32 s46, s46, s36
    v_mfma_f32_32x32x16_bf16 v[112:127], v[156:159], v[192:195], v[112:127]
    v_mfma_f32_32x32x16_bf16 v[128:143], v[156:159], v[196:199], v[128:143]
    s_waitcnt vmcnt(10) lgkmcnt(0)
    s_barrier
    v_mfma_f32_32x32x16_bf16 v[48:63], v[160:163], v[200:203], v[48:63]
    ds_read_b64_tr_b16 v[144:145], v243 offset:40960
    ds_read_b64_tr_b16 v[146:147], v243 offset:41984
    s_add_u32 m0, s37, 122880
    s_add_u32 s33, s45, 0
    buffer_load_dwordx4 v240, s[12:15], s33 offen lds
    v_mfma_f32_32x32x16_bf16 v[64:79], v[160:163], v[204:207], v[64:79]
    ds_read_b64_tr_b16 v[148:149], v244 offset:40960
    ds_read_b64_tr_b16 v[150:151], v244 offset:41984
    s_add_u32 m0, s37, 123904
    s_add_u32 s33, s45, 32768
    buffer_load_dwordx4 v240, s[12:15], s33 offen lds
    v_mfma_f32_32x32x16_bf16 v[80:95], v[160:163], v[208:211], v[80:95]
    ds_read_b128 v[176:179], v247 offset:40960
    ds_read_b128 v[180:183], v247 offset:45056
    s_add_u32 m0, s37, 124928
    s_add_u32 s33, s45, 65536
    buffer_load_dwordx4 v240, s[12:15], s33 offen lds
    v_mfma_f32_32x32x16_bf16 v[96:111], v[164:167], v[200:203], v[96:111]
    ds_read_b128 v[184:187], v247 offset:49152
    s_add_u32 m0, s37, 125952
    s_add_u32 s33, s45, 98304
    buffer_load_dwordx4 v240, s[12:15], s33 offen lds
    v_mfma_f32_32x32x16_bf16 v[112:127], v[164:167], v[204:207], v[112:127]
    ds_read_b64_tr_b16 v[152:153], v243 offset:45056
    ds_read_b64_tr_b16 v[154:155], v243 offset:46080
    s_add_u32 m0, s38, 122880
    s_add_u32 s33, s46, 0
    buffer_load_dwordx4 v241, s[16:19], s33 offen lds
    v_mfma_f32_32x32x16_bf16 v[128:143], v[164:167], v[208:211], v[128:143]
    ds_read_b64_tr_b16 v[156:157], v244 offset:45056
    ds_read_b64_tr_b16 v[158:159], v244 offset:46080
    s_add_u32 m0, s38, 123904
    s_add_u32 s33, s46, 10240
    buffer_load_dwordx4 v242, s[16:19], s33 offen lds
    v_mfma_f32_32x32x16_bf16 v[48:63], v[168:171], v[212:215], v[48:63]
    ds_read_b128 v[188:191], v248 offset:40960
    ds_read_b128 v[192:195], v248 offset:45056
    s_add_u32 m0, s38, 124928
    s_add_u32 s33, s46, 20480
    buffer_load_dwordx4 v241, s[16:19], s33 offen lds
    v_mfma_f32_32x32x16_bf16 v[64:79], v[168:171], v[216:219], v[64:79]
    ds_read_b128 v[196:199], v248 offset:49152
    s_add_u32 m0, s38, 125952
    s_add_u32 s33, s46, 30720
    buffer_load_dwordx4 v242, s[16:19], s33 offen lds
    v_mfma_f32_32x32x16_bf16 v[80:95], v[168:171], v[220:223], v[80:95]
    s_add_u32 m0, s38, 126976
    s_add_u32 s33, s46, 40960
    buffer_load_dwordx4 v241, s[16:19], s33 offen lds
    v_mfma_f32_32x32x16_bf16 v[96:111], v[172:175], v[212:215], v[96:111]
    s_add_u32 m0, s38, 128000
    s_add_u32 s33, s46, 51200
    buffer_load_dwordx4 v242, s[16:19], s33 offen lds
    s_add_u32 s44, s44, 1
    s_cmp_eq_u32 s44, 10
    s_cselect_b32 s44, 0, s44
    s_lshl_b32 s45, s44, 19
    s_add_u32 s45, s45, s35
    s_lshl_b32 s46, s44, 7
    s_add_u32 s46, s46, s36
    v_mfma_f32_32x32x16_bf16 v[112:127], v[172:175], v[216:219], v[112:127]
    v_mfma_f32_32x32x16_bf16 v[128:143], v[172:175], v[220:223], v[128:143]
    s_waitcnt lgkmcnt(7)
    v_mfma_f32_32x32x16_bf16 v[48:63], v[144:147], v[176:179], v[48:63]
    ds_read_b64_tr_b16 v[160:161], v243 offset:49152
    ds_read_b64_tr_b16 v[162:163], v243 offset:50176
    buffer_load_dwordx4 a[0:3], v3, s[4:7], s40 offen offset:0 nt
    v_mfma_f32_32x32x16_bf16 v[64:79], v[144:147], v[180:183], v[64:79]
    ds_read_b64_tr_b16 v[164:165], v244 offset:49152
    ds_read_b64_tr_b16 v[166:167], v244 offset:50176
    buffer_load_dwordx4 a[4:7], v4, s[4:7], s40 offen offset:1024 nt
    v_mfma_f32_32x32x16_bf16 v[80:95], v[144:147], v[184:187], v[80:95]
    ds_read_b128 v[200:203], v249 offset:40960
    ds_read_b128 v[204:207], v249 offset:45056
    buffer_load_dwordx4 a[8:11], v5, s[4:7], s40 offen offset:2048 nt
    v_mfma_f32_32x32x16_bf16 v[96:111], v[148:151], v[176:179], v[96:111]
    ds_read_b128 v[208:211], v249 offset:49152
    s_waitcnt lgkmcnt(7)
    v_mfma_f32_32x32x16_bf16 v[112:127], v[148:151], v[180:183], v[112:127]
    ds_read_b64_tr_b16 v[168:169], v243 offset:53248
    ds_read_b64_tr_b16 v[170:171], v243 offset:54272
    buffer_load_dwordx4 a[12:15], v6, s[4:7], s40 offen offset:3072 nt
    v_mfma_f32_32x32x16_bf16 v[128:143], v[148:151], v[184:187], v[128:143]
    ds_read_b64_tr_b16 v[172:173], v244 offset:53248
    ds_read_b64_tr_b16 v[174:175], v244 offset:54272
    buffer_load_dwordx4 a[16:19], v3, s[4:7], s41 offen offset:0 nt
    v_mfma_f32_32x32x16_bf16 v[48:63], v[152:155], v[188:191], v[48:63]
    ds_read_b128 v[212:215], v250 offset:40960
    ds_read_b128 v[216:219], v250 offset:45056
    buffer_load_dwordx4 a[20:23], v4, s[4:7], s41 offen offset:1024 nt
    v_mfma_f32_32x32x16_bf16 v[64:79], v[152:155], v[192:195], v[64:79]
    ds_read_b128 v[220:223], v250 offset:49152
    v_mfma_f32_32x32x16_bf16 v[80:95], v[152:155], v[196:199], v[80:95]
    buffer_load_dwordx4 a[24:27], v5, s[4:7], s41 offen offset:2048 nt
    v_mfma_f32_32x32x16_bf16 v[96:111], v[156:159], v[188:191], v[96:111]
    buffer_load_dwordx4 a[28:31], v6, s[4:7], s41 offen offset:3072 nt
    v_mfma_f32_32x32x16_bf16 v[112:127], v[156:159], v[192:195], v[112:127]
    v_mfma_f32_32x32x16_bf16 v[128:143], v[156:159], v[196:199], v[128:143]
    s_waitcnt vmcnt(18) lgkmcnt(0)
    s_barrier
    v_mfma_f32_32x32x16_bf16 v[48:63], v[160:163], v[200:203], v[48:63]
    ds_read_b64_tr_b16 v[144:145], v245 offset:0
    ds_read_b64_tr_b16 v[146:147], v245 offset:1024
    buffer_load_dwordx4 a[32:35], v7, s[8:11], s40 offen offset:0 nt
    v_mfma_f32_32x32x16_bf16 v[64:79], v[160:163], v[204:207], v[64:79]
    ds_read_b64_tr_b16 v[148:149], v246 offset:0
    ds_read_b64_tr_b16 v[150:151], v246 offset:1024
    buffer_load_dwordx4 a[36:39], v7, s[8:11], s40 offen offset:1024 nt
    v_mfma_f32_32x32x16_bf16 v[80:95], v[160:163], v[208:211], v[80:95]
    ds_read_b128 v[176:179], v251 offset:0
    ds_read_b128 v[180:183], v251 offset:4096
    buffer_load_dwordx4 a[40:43], v7, s[8:11], s40 offen offset:2048 nt
    v_mfma_f32_32x32x16_bf16 v[96:111], v[164:167], v[200:203], v[96:111]
    ds_read_b128 v[184:187], v251 offset:8192
    v_mfma_f32_32x32x16_bf16 v[112:127], v[164:167], v[204:207], v[112:127]
    ds_read_b64_tr_b16 v[152:153], v245 offset:4096
    ds_read_b64_tr_b16 v[154:155], v245 offset:5120
    buffer_load_dwordx4 a[44:47], v7, s[8:11], s40 offen offset:3072 nt
    v_mfma_f32_32x32x16_bf16 v[128:143], v[164:167], v[208:211], v[128:143]
    ds_read_b64_tr_b16 v[156:157], v246 offset:4096
    ds_read_b64_tr_b16 v[158:159], v246 offset:5120
    buffer_load_dwordx4 a[48:51], v7, s[8:11], s41 offen offset:0 nt
    v_mfma_f32_32x32x16_bf16 v[48:63], v[168:171], v[212:215], v[48:63]
    ds_read_b128 v[188:191], v252 offset:0
    ds_read_b128 v[192:195], v252 offset:4096
    buffer_load_dwordx4 a[52:55], v7, s[8:11], s41 offen offset:1024 nt
    v_mfma_f32_32x32x16_bf16 v[64:79], v[168:171], v[216:219], v[64:79]
    ds_read_b128 v[196:199], v252 offset:8192
    v_mfma_f32_32x32x16_bf16 v[80:95], v[168:171], v[220:223], v[80:95]
    buffer_load_dwordx4 a[56:59], v7, s[8:11], s41 offen offset:2048 nt
    v_mfma_f32_32x32x16_bf16 v[96:111], v[172:175], v[212:215], v[96:111]
    buffer_load_dwordx4 a[60:63], v7, s[8:11], s41 offen offset:3072 nt
    v_mfma_f32_32x32x16_bf16 v[112:127], v[172:175], v[216:219], v[112:127]
    v_mfma_f32_32x32x16_bf16 v[128:143], v[172:175], v[220:223], v[128:143]
    s_waitcnt lgkmcnt(7)
    v_mfma_f32_32x32x16_bf16 v[48:63], v[144:147], v[176:179], v[48:63]
    ds_read_b64_tr_b16 v[160:161], v245 offset:8192
    ds_read_b64_tr_b16 v[162:163], v245 offset:9216
    buffer_load_dwordx4 a[64:67], v3, s[4:7], s42 offen offset:0 nt
    v_mfma_f32_32x32x16_bf16 v[64:79], v[144:147], v[180:183], v[64:79]
    ds_read_b64_tr_b16 v[164:165], v246 offset:8192
    ds_read_b64_tr_b16 v[166:167], v246 offset:9216
    buffer_load_dwordx4 a[68:71], v4, s[4:7], s42 offen offset:1024 nt
    v_mfma_f32_32x32x16_bf16 v[80:95], v[144:147], v[184:187], v[80:95]
    ds_read_b128 v[200:203], v253 offset:0
    ds_read_b128 v[204:207], v253 offset:4096
    buffer_load_dwordx4 a[72:75], v5, s[4:7], s42 offen offset:2048 nt
    v_mfma_f32_32x32x16_bf16 v[96:111], v[148:151], v[176:179], v[96:111]
    ds_read_b128 v[208:211], v253 offset:8192
    s_waitcnt lgkmcnt(7)
    v_mfma_f32_32x32x16_bf16 v[112:127], v[148:151], v[180:183], v[112:127]
    ds_read_b64_tr_b16 v[168:169], v245 offset:12288
    ds_read_b64_tr_b16 v[170:171], v245 offset:13312
    buffer_load_dwordx4 a[76:79], v6, s[4:7], s42 offen offset:3072 nt
    v_mfma_f32_32x32x16_bf16 v[128:143], v[148:151], v[184:187], v[128:143]
    ds_read_b64_tr_b16 v[172:173], v246 offset:12288
    ds_read_b64_tr_b16 v[174:175], v246 offset:13312
    buffer_load_dwordx4 a[80:83], v3, s[4:7], s43 offen offset:0 nt
    v_mfma_f32_32x32x16_bf16 v[48:63], v[152:155], v[188:191], v[48:63]
    ds_read_b128 v[212:215], v254 offset:0
    ds_read_b128 v[216:219], v254 offset:4096
    buffer_load_dwordx4 a[84:87], v4, s[4:7], s43 offen offset:1024 nt
    v_mfma_f32_32x32x16_bf16 v[64:79], v[152:155], v[192:195], v[64:79]
    ds_read_b128 v[220:223], v254 offset:8192
    v_mfma_f32_32x32x16_bf16 v[80:95], v[152:155], v[196:199], v[80:95]
    buffer_load_dwordx4 a[88:91], v5, s[4:7], s43 offen offset:2048 nt
    v_mfma_f32_32x32x16_bf16 v[96:111], v[156:159], v[188:191], v[96:111]
    buffer_load_dwordx4 a[92:95], v6, s[4:7], s43 offen offset:3072 nt
    v_mfma_f32_32x32x16_bf16 v[112:127], v[156:159], v[192:195], v[112:127]
    v_mfma_f32_32x32x16_bf16 v[128:143], v[156:159], v[196:199], v[128:143]
    s_waitcnt vmcnt(24) lgkmcnt(0)
    s_barrier
    v_mfma_f32_32x32x16_bf16 v[48:63], v[160:163], v[200:203], v[48:63]
    ds_read_b64_tr_b16 v[144:145], v245 offset:40960
    ds_read_b64_tr_b16 v[146:147], v245 offset:41984
    buffer_load_dwordx4 a[96:99], v7, s[8:11], s42 offen offset:0 nt
    v_mfma_f32_32x32x16_bf16 v[64:79], v[160:163], v[204:207], v[64:79]
    ds_read_b64_tr_b16 v[148:149], v246 offset:40960
    ds_read_b64_tr_b16 v[150:151], v246 offset:41984
    buffer_load_dwordx4 a[100:103], v7, s[8:11], s42 offen offset:1024 nt
    v_mfma_f32_32x32x16_bf16 v[80:95], v[160:163], v[208:211], v[80:95]
    ds_read_b128 v[176:179], v251 offset:40960
    ds_read_b128 v[180:183], v251 offset:45056
    buffer_load_dwordx4 a[104:107], v7, s[8:11], s42 offen offset:2048 nt
    v_mfma_f32_32x32x16_bf16 v[96:111], v[164:167], v[200:203], v[96:111]
    ds_read_b128 v[184:187], v251 offset:49152
    v_mfma_f32_32x32x16_bf16 v[112:127], v[164:167], v[204:207], v[112:127]
    ds_read_b64_tr_b16 v[152:153], v245 offset:45056
    ds_read_b64_tr_b16 v[154:155], v245 offset:46080
    buffer_load_dwordx4 a[108:111], v7, s[8:11], s42 offen offset:3072 nt
    v_mfma_f32_32x32x16_bf16 v[128:143], v[164:167], v[208:211], v[128:143]
    ds_read_b64_tr_b16 v[156:157], v246 offset:45056
    ds_read_b64_tr_b16 v[158:159], v246 offset:46080
    buffer_load_dwordx4 a[112:115], v7, s[8:11], s43 offen offset:0 nt
    v_mfma_f32_32x32x16_bf16 v[48:63], v[168:171], v[212:215], v[48:63]
    ds_read_b128 v[188:191], v252 offset:40960
    ds_read_b128 v[192:195], v252 offset:45056
    buffer_load_dwordx4 a[116:119], v7, s[8:11], s43 offen offset:1024 nt
    v_mfma_f32_32x32x16_bf16 v[64:79], v[168:171], v[216:219], v[64:79]
    ds_read_b128 v[196:199], v252 offset:49152
    v_mfma_f32_32x32x16_bf16 v[80:95], v[168:171], v[220:223], v[80:95]
    buffer_load_dwordx4 a[120:123], v7, s[8:11], s43 offen offset:2048 nt
    v_mfma_f32_32x32x16_bf16 v[96:111], v[172:175], v[212:215], v[96:111]
    buffer_load_dwordx4 a[124:127], v7, s[8:11], s43 offen offset:3072 nt
    v_mfma_f32_32x32x16_bf16 v[112:127], v[172:175], v[216:219], v[112:127]
    v_mfma_f32_32x32x16_bf16 v[128:143], v[172:175], v[220:223], v[128:143]
    s_waitcnt lgkmcnt(7)
    v_mfma_f32_32x32x16_bf16 v[48:63], v[144:147], v[176:179], v[48:63]
    ds_read_b64_tr_b16 v[160:161], v245 offset:49152
    ds_read_b64_tr_b16 v[162:163], v245 offset:50176
    s_add_u32 m0, s37, 0
    s_add_u32 s33, s45, 0
    buffer_load_dwordx4 v240, s[12:15], s33 offen lds
    v_mfma_f32_32x32x16_bf16 v[64:79], v[144:147], v[180:183], v[64:79]
    ds_read_b64_tr_b16 v[164:165], v246 offset:49152
    ds_read_b64_tr_b16 v[166:167], v246 offset:50176
    s_add_u32 m0, s37, 1024
    s_add_u32 s33, s45, 32768
    buffer_load_dwordx4 v240, s[12:15], s33 offen lds
    v_mfma_f32_32x32x16_bf16 v[80:95], v[144:147], v[184:187], v[80:95]
    ds_read_b128 v[200:203], v253 offset:40960
    ds_read_b128 v[204:207], v253 offset:45056
    s_add_u32 m0, s37, 2048
    s_add_u32 s33, s45, 65536
    buffer_load_dwordx4 v240, s[12:15], s33 offen lds
    v_mfma_f32_32x32x16_bf16 v[96:111], v[148:151], v[176:179], v[96:111]
    ds_read_b128 v[208:211], v253 offset:49152
    s_waitcnt lgkmcnt(7)
    s_add_u32 m0, s37, 3072
    s_add_u32 s33, s45, 98304
    buffer_load_dwordx4 v240, s[12:15], s33 offen lds
    v_mfma_f32_32x32x16_bf16 v[112:127], v[148:151], v[180:183], v[112:127]
    ds_read_b64_tr_b16 v[168:169], v245 offset:53248
    ds_read_b64_tr_b16 v[170:171], v245 offset:54272
    s_add_u32 m0, s38, 0
    s_add_u32 s33, s46, 0
    buffer_load_dwordx4 v241, s[16:19], s33 offen lds
    v_mfma_f32_32x32x16_bf16 v[128:143], v[148:151], v[184:187], v[128:143]
    ds_read_b64_tr_b16 v[172:173], v246 offset:53248
    ds_read_b64_tr_b16 v[174:175], v246 offset:54272
    s_add_u32 m0, s38, 1024
    s_add_u32 s33, s46, 10240
    buffer_load_dwordx4 v242, s[16:19], s33 offen lds
    v_mfma_f32_32x32x16_bf16 v[48:63], v[152:155], v[188:191], v[48:63]
    ds_read_b128 v[212:215], v254 offset:40960
    ds_read_b128 v[216:219], v254 offset:45056
    s_add_u32 m0, s38, 2048
    s_add_u32 s33, s46, 20480
    buffer_load_dwordx4 v241, s[16:19], s33 offen lds
    v_mfma_f32_32x32x16_bf16 v[64:79], v[152:155], v[192:195], v[64:79]
    ds_read_b128 v[220:223], v254 offset:49152
    s_add_u32 m0, s38, 3072
    s_add_u32 s33, s46, 30720
    buffer_load_dwordx4 v242, s[16:19], s33 offen lds
    v_mfma_f32_32x32x16_bf16 v[80:95], v[152:155], v[196:199], v[80:95]
    s_add_u32 m0, s38, 4096
    s_add_u32 s33, s46, 40960
    buffer_load_dwordx4 v241, s[16:19], s33 offen lds
    v_mfma_f32_32x32x16_bf16 v[96:111], v[156:159], v[188:191], v[96:111]
    s_add_u32 m0, s38, 5120
    s_add_u32 s33, s46, 51200
    buffer_load_dwordx4 v242, s[16:19], s33 offen lds
    s_add_u32 s44, s44, 1
    s_cmp_eq_u32 s44, 10
    s_cselect_b32 s44, 0, s44
    s_lshl_b32 s45, s44, 19
    s_add_u32 s45, s45, s35
    s_lshl_b32 s46, s44, 7
    s_add_u32 s46, s46, s36
    v_mfma_f32_32x32x16_bf16 v[112:127], v[156:159], v[192:195], v[112:127]
    v_mfma_f32_32x32x16_bf16 v[128:143], v[156:159], v[196:199], v[128:143]
    s_waitcnt vmcnt(0) lgkmcnt(0)
    s_barrier
    v_mfma_f32_32x32x16_bf16 v[48:63], v[160:163], v[200:203], v[48:63]
    ds_read_b64_tr_b16 v[144:145], v243 offset:0
    ds_read_b64_tr_b16 v[146:147], v243 offset:1024
    s_add_u32 m0, s37, 40960
    s_add_u32 s33, s45, 0
    buffer_load_dwordx4 v240, s[12:15], s33 offen lds
    v_mfma_f32_32x32x16_bf16 v[64:79], v[160:163], v[204:207], v[64:79]
    ds_read_b64_tr_b16 v[148:149], v244 offset:0
    ds_read_b64_tr_b16 v[150:151], v244 offset:1024
    s_add_u32 m0, s37, 41984
    s_add_u32 s33, s45, 32768
    buffer_load_dwordx4 v240, s[12:15], s33 offen lds
    v_mfma_f32_32x32x16_bf16 v[80:95], v[160:163], v[208:211], v[80:95]
    ds_read_b128 v[176:179], v247 offset:0
    ds_read_b128 v[180:183], v247 offset:4096
    s_add_u32 m0, s37, 43008
    s_add_u32 s33, s45, 65536
    buffer_load_dwordx4 v240, s[12:15], s33 offen lds
    v_mfma_f32_32x32x16_bf16 v[96:111], v[164:167], v[200:203], v[96:111]
    ds_read_b128 v[184:187], v247 offset:8192
    s_add_u32 m0, s37, 44032
    s_add_u32 s33, s45, 98304
    buffer_load_dwordx4 v240, s[12:15], s33 offen lds
    v_mfma_f32_32x32x16_bf16 v[112:127], v[164:167], v[204:207], v[112:127]
    ds_read_b64_tr_b16 v[152:153], v243 offset:4096
    ds_read_b64_tr_b16 v[154:155], v243 offset:5120
    s_add_u32 m0, s38, 40960
    s_add_u32 s33, s46, 0
    buffer_load_dwordx4 v241, s[16:19], s33 offen lds
    v_mfma_f32_32x32x16_bf16 v[128:143], v[164:167], v[208:211], v[128:143]
    ds_read_b64_tr_b16 v[156:157], v244 offset:4096
    ds_read_b64_tr_b16 v[158:159], v244 offset:5120
    s_add_u32 m0, s38, 41984
    s_add_u32 s33, s46, 10240
    buffer_load_dwordx4 v242, s[16:19], s33 offen lds
    v_mfma_f32_32x32x16_bf16 v[48:63], v[168:171], v[212:215], v[48:63]
    ds_read_b128 v[188:191], v248 offset:0
    ds_read_b128 v[192:195], v248 offset:4096
    s_add_u32 m0, s38, 43008
    s_add_u32 s33, s46, 20480
    buffer_load_dwordx4 v241, s[16:19], s33 offen lds
    v_mfma_f32_32x32x16_bf16 v[64:79], v[168:171], v[216:219], v[64:79]
    ds_read_b128 v[196:199], v248 offset:8192
    s_add_u32 m0, s38, 44032
    s_add_u32 s33, s46, 30720
    buffer_load_dwordx4 v242, s[16:19], s33 offen lds
    v_mfma_f32_32x32x16_bf16 v[80:95], v[168:171], v[220:223], v[80:95]
    s_add_u32 m0, s38, 45056
    s_add_u32 s33, s46, 40960
    buffer_load_dwordx4 v241, s[16:19], s33 offen lds
    v_mfma_f32_32x32x16_bf16 v[96:111], v[172:175], v[212:215], v[96:111]
    s_add_u32 m0, s38, 46080
    s_add_u32 s33, s46, 51200
    buffer_load_dwordx4 v242, s[16:19], s33 offen lds
    s_add_u32 s44, s44, 1
    s_cmp_eq_u32 s44, 10
    s_cselect_b32 s44, 0, s44
    s_lshl_b32 s45, s44, 19
    s_add_u32 s45, s45, s35
    s_lshl_b32 s46, s44, 7
    s_add_u32 s46, s46, s36
    v_mfma_f32_32x32x16_bf16 v[112:127], v[172:175], v[216:219], v[112:127]
    v_mfma_f32_32x32x16_bf16 v[128:143], v[172:175], v[220:223], v[128:143]
    s_waitcnt lgkmcnt(7)
    v_mfma_f32_32x32x16_bf16 v[48:63], v[144:147], v[176:179], v[48:63]
    ds_read_b64_tr_b16 v[160:161], v243 offset:8192
    ds_read_b64_tr_b16 v[162:163], v243 offset:9216
    s_add_u32 m0, s37, 81920
    s_add_u32 s33, s45, 0
    buffer_load_dwordx4 v240, s[12:15], s33 offen lds
    v_mfma_f32_32x32x16_bf16 v[64:79], v[144:147], v[180:183], v[64:79]
    ds_read_b64_tr_b16 v[164:165], v244 offset:8192
    ds_read_b64_tr_b16 v[166:167], v244 offset:9216
    s_add_u32 m0, s37, 82944
    s_add_u32 s33, s45, 32768
    buffer_load_dwordx4 v240, s[12:15], s33 offen lds
    v_mfma_f32_32x32x16_bf16 v[80:95], v[144:147], v[184:187], v[80:95]
    ds_read_b128 v[200:203], v249 offset:0
    ds_read_b128 v[204:207], v249 offset:4096
    s_add_u32 m0, s37, 83968
    s_add_u32 s33, s45, 65536
    buffer_load_dwordx4 v240, s[12:15], s33 offen lds
    v_mfma_f32_32x32x16_bf16 v[96:111], v[148:151], v[176:179], v[96:111]
    ds_read_b128 v[208:211], v249 offset:8192
    s_waitcnt lgkmcnt(7)
    s_add_u32 m0, s37, 84992
    s_add_u32 s33, s45, 98304
    buffer_load_dwordx4 v240, s[12:15], s33 offen lds
    v_mfma_f32_32x32x16_bf16 v[112:127], v[148:151], v[180:183], v[112:127]
    ds_read_b64_tr_b16 v[168:169], v243 offset:12288
    ds_read_b64_tr_b16 v[170:171], v243 offset:13312
    s_add_u32 m0, s38, 81920
    s_add_u32 s33, s46, 0
    buffer_load_dwordx4 v241, s[16:19], s33 offen lds
    v_mfma_f32_32x32x16_bf16 v[128:143], v[148:151], v[184:187], v[128:143]
    ds_read_b64_tr_b16 v[172:173], v244 offset:12288
    ds_read_b64_tr_b16 v[174:175], v244 offset:13312
    s_add_u32 m0, s38, 82944
    s_add_u32 s33, s46, 10240
    buffer_load_dwordx4 v242, s[16:19], s33 offen lds
    v_mfma_f32_32x32x16_bf16 v[48:63], v[152:155], v[188:191], v[48:63]
    ds_read_b128 v[212:215], v250 offset:0
    ds_read_b128 v[216:219], v250 offset:4096
    s_add_u32 m0, s38, 83968
    s_add_u32 s33, s46, 20480
    buffer_load_dwordx4 v241, s[16:19], s33 offen lds
    v_mfma_f32_32x32x16_bf16 v[64:79], v[152:155], v[192:195], v[64:79]
    ds_read_b128 v[220:223], v250 offset:8192
    s_add_u32 m0, s38, 84992
    s_add_u32 s33, s46, 30720
    buffer_load_dwordx4 v242, s[16:19], s33 offen lds
    v_mfma_f32_32x32x16_bf16 v[80:95], v[152:155], v[196:199], v[80:95]
    s_add_u32 m0, s38, 86016
    s_add_u32 s33, s46, 40960
    buffer_load_dwordx4 v241, s[16:19], s33 offen lds
    v_mfma_f32_32x32x16_bf16 v[96:111], v[156:159], v[188:191], v[96:111]
    s_add_u32 m0, s38, 87040
    s_add_u32 s33, s46, 51200
    buffer_load_dwordx4 v242, s[16:19], s33 offen lds
    s_add_u32 s44, s44, 1
    s_cmp_eq_u32 s44, 10
    s_cselect_b32 s44, 0, s44
    s_lshl_b32 s45, s44, 19
    s_add_u32 s45, s45, s35
    s_lshl_b32 s46, s44, 7
    s_add_u32 s46, s46, s36
    v_mfma_f32_32x32x16_bf16 v[112:127], v[156:159], v[192:195], v[112:127]
    v_mfma_f32_32x32x16_bf16 v[128:143], v[156:159], v[196:199], v[128:143]
    s_waitcnt vmcnt(10) lgkmcnt(0)
    s_barrier
    v_mfma_f32_32x32x16_bf16 v[48:63], v[160:163], v[200:203], v[48:63]
    ds_read_b64_tr_b16 v[144:145], v243 offset:40960
    ds_read_b64_tr_b16 v[146:147], v243 offset:41984
    s_add_u32 m0, s37, 122880
    s_add_u32 s33, s45, 0
    buffer_load_dwordx4 v240, s[12:15], s33 offen lds
    v_mfma_f32_32x32x16_bf16 v[64:79], v[160:163], v[204:207], v[64:79]
    ds_read_b64_tr_b16 v[148:149], v244 offset:40960
    ds_read_b64_tr_b16 v[150:151], v244 offset:41984
    s_add_u32 m0, s37, 123904
    s_add_u32 s33, s45, 32768
    buffer_load_dwordx4 v240, s[12:15], s33 offen lds
    v_mfma_f32_32x32x16_bf16 v[80:95], v[160:163], v[208:211], v[80:95]
    ds_read_b128 v[176:179], v247 offset:40960
    ds_read_b128 v[180:183], v247 offset:45056
    s_add_u32 m0, s37, 124928
    s_add_u32 s33, s45, 65536
    buffer_load_dwordx4 v240, s[12:15], s33 offen lds
    v_mfma_f32_32x32x16_bf16 v[96:111], v[164:167], v[200:203], v[96:111]
    ds_read_b128 v[184:187], v247 offset:49152
    s_add_u32 m0, s37, 125952
    s_add_u32 s33, s45, 98304
    buffer_load_dwordx4 v240, s[12:15], s33 offen lds
    v_mfma_f32_32x32x16_bf16 v[112:127], v[164:167], v[204:207], v[112:127]
    ds_read_b64_tr_b16 v[152:153], v243 offset:45056
    ds_read_b64_tr_b16 v[154:155], v243 offset:46080
    s_add_u32 m0, s38, 122880
    s_add_u32 s33, s46, 0
    buffer_load_dwordx4 v241, s[16:19], s33 offen lds
    v_mfma_f32_32x32x16_bf16 v[128:143], v[164:167], v[208:211], v[128:143]
    ds_read_b64_tr_b16 v[156:157], v244 offset:45056
    ds_read_b64_tr_b16 v[158:159], v244 offset:46080
    s_add_u32 m0, s38, 123904
    s_add_u32 s33, s46, 10240
    buffer_load_dwordx4 v242, s[16:19], s33 offen lds
    v_mfma_f32_32x32x16_bf16 v[48:63], v[168:171], v[212:215], v[48:63]
    ds_read_b128 v[188:191], v248 offset:40960
    ds_read_b128 v[192:195], v248 offset:45056
    s_add_u32 m0, s38, 124928
    s_add_u32 s33, s46, 20480
    buffer_load_dwordx4 v241, s[16:19], s33 offen lds
    v_mfma_f32_32x32x16_bf16 v[64:79], v[168:171], v[216:219], v[64:79]
    ds_read_b128 v[196:199], v248 offset:49152
    s_add_u32 m0, s38, 125952
    s_add_u32 s33, s46, 30720
    buffer_load_dwordx4 v242, s[16:19], s33 offen lds
    v_mfma_f32_32x32x16_bf16 v[80:95], v[168:171], v[220:223], v[80:95]
    s_add_u32 m0, s38, 126976
    s_add_u32 s33, s46, 40960
    buffer_load_dwordx4 v241, s[16:19], s33 offen lds
    v_mfma_f32_32x32x16_bf16 v[96:111], v[172:175], v[212:215], v[96:111]
    s_add_u32 m0, s38, 128000
    s_add_u32 s33, s46, 51200
    buffer_load_dwordx4 v242, s[16:19], s33 offen lds
    s_add_u32 s44, s44, 1
    s_cmp_eq_u32 s44, 10
    s_cselect_b32 s44, 0, s44
    s_lshl_b32 s45, s44, 19
    s_add_u32 s45, s45, s35
    s_lshl_b32 s46, s44, 7
    s_add_u32 s46, s46, s36
    v_mfma_f32_32x32x16_bf16 v[112:127], v[172:175], v[216:219], v[112:127]
    v_mfma_f32_32x32x16_bf16 v[128:143], v[172:175], v[220:223], v[128:143]
    s_waitcnt lgkmcnt(7)
    v_mfma_f32_32x32x16_bf16 v[48:63], v[144:147], v[176:179], v[48:63]
    ds_read_b64_tr_b16 v[160:161], v243 offset:49152
    ds_read_b64_tr_b16 v[162:163], v243 offset:50176
    s_add_u32 m0, s37, 0
    s_add_u32 s33, s45, 0
    buffer_load_dwordx4 v240, s[12:15], s33 offen lds
    v_mfma_f32_32x32x16_bf16 v[64:79], v[144:147], v[180:183], v[64:79]
    ds_read_b64_tr_b16 v[164:165], v244 offset:49152
    ds_read_b64_tr_b16 v[166:167], v244 offset:50176
    s_add_u32 m0, s37, 1024
    s_add_u32 s33, s45, 32768
    buffer_load_dwordx4 v240, s[12:15], s33 offen lds
    v_mfma_f32_32x32x16_bf16 v[80:95], v[144:147], v[184:187], v[80:95]
    ds_read_b128 v[200:203], v249 offset:40960
    ds_read_b128 v[204:207], v249 offset:45056
    s_add_u32 m0, s37, 2048
    s_add_u32 s33, s45, 65536
    buffer_load_dwordx4 v240, s[12:15], s33 offen lds
    v_mfma_f32_32x32x16_bf16 v[96:111], v[148:151], v[176:179], v[96:111]
    ds_read_b128 v[208:211], v249 offset:49152
    s_waitcnt lgkmcnt(7)
    s_add_u32 m0, s37, 3072
    s_add_u32 s33, s45, 98304
    buffer_load_dwordx4 v240, s[12:15], s33 offen lds
    v_mfma_f32_32x32x16_bf16 v[112:127], v[148:151], v[180:183], v[112:127]
    ds_read_b64_tr_b16 v[168:169], v243 offset:53248
    ds_read_b64_tr_b16 v[170:171], v243 offset:54272
    s_add_u32 m0, s38, 0
    s_add_u32 s33, s46, 0
    buffer_load_dwordx4 v241, s[16:19], s33 offen lds
    v_mfma_f32_32x32x16_bf16 v[128:143], v[148:151], v[184:187], v[128:143]
    ds_read_b64_tr_b16 v[172:173], v244 offset:53248
    ds_read_b64_tr_b16 v[174:175], v244 offset:54272
    s_add_u32 m0, s38, 1024
    s_add_u32 s33, s46, 10240
    buffer_load_dwordx4 v242, s[16:19], s33 offen lds
    v_mfma_f32_32x32x16_bf16 v[48:63], v[152:155], v[188:191], v[48:63]
    ds_read_b128 v[212:215], v250 offset:40960
    ds_read_b128 v[216:219], v250 offset:45056
    s_add_u32 m0, s38, 2048
    s_add_u32 s33, s46, 20480
    buffer_load_dwordx4 v241, s[16:19], s33 offen lds
    v_mfma_f32_32x32x16_bf16 v[64:79], v[152:155], v[192:195], v[64:79]
    ds_read_b128 v[220:223], v250 offset:49152
    s_add_u32 m0, s38, 3072
    s_add_u32 s33, s46, 30720
    buffer_load_dwordx4 v242, s[16:19], s33 offen lds
    v_mfma_f32_32x32x16_bf16 v[80:95], v[152:155], v[196:199], v[80:95]
    s_add_u32 m0, s38, 4096
    s_add_u32 s33, s46, 40960
    buffer_load_dwordx4 v241, s[16:19], s33 offen lds
    v_mfma_f32_32x32x16_bf16 v[96:111], v[156:159], v[188:191], v[96:111]
    s_add_u32 m0, s38, 5120
    s_add_u32 s33, s46, 51200
    buffer_load_dwordx4 v242, s[16:19], s33 offen lds
    s_add_u32 s44, s44, 1
    s_cmp_eq_u32 s44, 10
    s_cselect_b32 s44, 0, s44
    s_lshl_b32 s45, s44, 19
    s_add_u32 s45, s45, s35
    s_lshl_b32 s46, s44, 7
    s_add_u32 s46, s46, s36
    v_mfma_f32_32x32x16_bf16 v[112:127], v[156:159], v[192:195], v[112:127]
    v_mfma_f32_32x32x16_bf16 v[128:143], v[156:159], v[196:199], v[128:143]
    s_waitcnt vmcnt(20) lgkmcnt(0)
    s_barrier
    v_mfma_f32_32x32x16_bf16 v[48:63], v[160:163], v[200:203], v[48:63]
    ds_read_b64_tr_b16 v[144:145], v245 offset:0
    ds_read_b64_tr_b16 v[146:147], v245 offset:1024
    s_add_u32 m0, s37, 40960
    s_add_u32 s33, s45, 0
    buffer_load_dwordx4 v240, s[12:15], s33 offen lds
    v_mfma_f32_32x32x16_bf16 v[64:79], v[160:163], v[204:207], v[64:79]
    ds_read_b64_tr_b16 v[148:149], v246 offset:0
    ds_read_b64_tr_b16 v[150:151], v246 offset:1024
    s_add_u32 m0, s37, 41984
    s_add_u32 s33, s45, 32768
    buffer_load_dwordx4 v240, s[12:15], s33 offen lds
    v_mfma_f32_32x32x16_bf16 v[80:95], v[160:163], v[208:211], v[80:95]
    ds_read_b128 v[176:179], v251 offset:0
    ds_read_b128 v[180:183], v251 offset:4096
    s_add_u32 m0, s37, 43008
    s_add_u32 s33, s45, 65536
    buffer_load_dwordx4 v240, s[12:15], s33 offen lds
    v_mfma_f32_32x32x16_bf16 v[96:111], v[164:167], v[200:203], v[96:111]
    ds_read_b128 v[184:187], v251 offset:8192
    s_add_u32 m0, s37, 44032
    s_add_u32 s33, s45, 98304
    buffer_load_dwordx4 v240, s[12:15], s33 offen lds
    v_mfma_f32_32x32x16_bf16 v[112:127], v[164:167], v[204:207], v[112:127]
    ds_read_b64_tr_b16 v[152:153], v245 offset:4096
    ds_read_b64_tr_b16 v[154:155], v245 offset:5120
    s_add_u32 m0, s38, 40960
    s_add_u32 s33, s46, 0
    buffer_load_dwordx4 v241, s[16:19], s33 offen lds
    v_mfma_f32_32x32x16_bf16 v[128:143], v[164:167], v[208:211], v[128:143]
    ds_read_b64_tr_b16 v[156:157], v246 offset:4096
    ds_read_b64_tr_b16 v[158:159], v246 offset:5120
    s_add_u32 m0, s38, 41984
    s_add_u32 s33, s46, 10240
    buffer_load_dwordx4 v242, s[16:19], s33 offen lds
    v_mfma_f32_32x32x16_bf16 v[48:63], v[168:171], v[212:215], v[48:63]
    ds_read_b128 v[188:191], v252 offset:0
    ds_read_b128 v[192:195], v252 offset:4096
    s_add_u32 m0, s38, 43008
    s_add_u32 s33, s46, 20480
    buffer_load_dwordx4 v241, s[16:19], s33 offen lds
    v_mfma_f32_32x32x16_bf16 v[64:79], v[168:171], v[216:219], v[64:79]
    ds_read_b128 v[196:199], v252 offset:8192
    s_add_u32 m0, s38, 44032
    s_add_u32 s33, s46, 30720
    buffer_load_dwordx4 v242, s[16:19], s33 offen lds
    v_mfma_f32_32x32x16_bf16 v[80:95], v[168:171], v[220:223], v[80:95]
    s_add_u32 m0, s38, 45056
    s_add_u32 s33, s46, 40960
    buffer_load_dwordx4 v241, s[16:19], s33 offen lds
    v_mfma_f32_32x32x16_bf16 v[96:111], v[172:175], v[212:215], v[96:111]
    s_add_u32 m0, s38, 46080
    s_add_u32 s33, s46, 51200
    buffer_load_dwordx4 v242, s[16:19], s33 offen lds
    s_add_u32 s44, s44, 1
    s_cmp_eq_u32 s44, 10
    s_cselect_b32 s44, 0, s44
    s_lshl_b32 s45, s44, 19
    s_add_u32 s45, s45, s35
    s_lshl_b32 s46, s44, 7
    s_add_u32 s46, s46, s36
    v_mfma_f32_32x32x16_bf16 v[112:127], v[172:175], v[216:219], v[112:127]
    v_mfma_f32_32x32x16_bf16 v[128:143], v[172:175], v[220:223], v[128:143]
    s_waitcnt lgkmcnt(7)
    v_mfma_f32_32x32x16_bf16 v[48:63], v[144:147], v[176:179], v[48:63]
    ds_read_b64_tr_b16 v[160:161], v245 offset:8192
    ds_read_b64_tr_b16 v[162:163], v245 offset:9216
    v_mfma_f32_32x32x16_bf16 v[64:79], v[144:147], v[180:183], v[64:79]
    ds_read_b64_tr_b16 v[164:165], v246 offset:8192
    ds_read_b64_tr_b16 v[166:167], v246 offset:9216
    v_mfma_f32_32x32x16_bf16 v[80:95], v[144:147], v[184:187], v[80:95]
    ds_read_b128 v[200:203], v253 offset:0
    ds_read_b128 v[204:207], v253 offset:4096
    v_mfma_f32_32x32x16_bf16 v[96:111], v[148:151], v[176:179], v[96:111]
    ds_read_b128 v[208:211], v253 offset:8192
    s_waitcnt lgkmcnt(7)
    v_mfma_f32_32x32x16_bf16 v[112:127], v[148:151], v[180:183], v[112:127]
    ds_read_b64_tr_b16 v[168:169], v245 offset:12288
    ds_read_b64_tr_b16 v[170:171], v245 offset:13312
    v_mfma_f32_32x32x16_bf16 v[128:143], v[148:151], v[184:187], v[128:143]
    ds_read_b64_tr_b16 v[172:173], v246 offset:12288
    ds_read_b64_tr_b16 v[174:175], v246 offset:13312
    v_mfma_f32_32x32x16_bf16 v[48:63], v[152:155], v[188:191], v[48:63]
    ds_read_b128 v[212:215], v254 offset:0
    ds_read_b128 v[216:219], v254 offset:4096
    v_mfma_f32_32x32x16_bf16 v[64:79], v[152:155], v[192:195], v[64:79]
    ds_read_b128 v[220:223], v254 offset:8192
    v_mfma_f32_32x32x16_bf16 v[80:95], v[152:155], v[196:199], v[80:95]
    v_mfma_f32_32x32x16_bf16 v[96:111], v[156:159], v[188:191], v[96:111]
    v_mfma_f32_32x32x16_bf16 v[112:127], v[156:159], v[192:195], v[112:127]
    v_mfma_f32_32x32x16_bf16 v[128:143], v[156:159], v[196:199], v[128:143]
    s_waitcnt vmcnt(20) lgkmcnt(0)
    s_barrier
    v_mfma_f32_32x32x16_bf16 v[48:63], v[160:163], v[200:203], v[48:63]
    ds_read_b64_tr_b16 v[144:145], v245 offset:40960
    ds_read_b64_tr_b16 v[146:147], v245 offset:41984
    v_mfma_f32_32x32x16_bf16 v[64:79], v[160:163], v[204:207], v[64:79]
    ds_read_b64_tr_b16 v[148:149], v246 offset:40960
    ds_read_b64_tr_b16 v[150:151], v246 offset:41984
    v_mfma_f32_32x32x16_bf16 v[80:95], v[160:163], v[208:211], v[80:95]
    ds_read_b128 v[176:179], v251 offset:40960
    ds_read_b128 v[180:183], v251 offset:45056
    v_mfma_f32_32x32x16_bf16 v[96:111], v[164:167], v[200:203], v[96:111]
    ds_read_b128 v[184:187], v251 offset:49152
    v_mfma_f32_32x32x16_bf16 v[112:127], v[164:167], v[204:207], v[112:127]
    ds_read_b64_tr_b16 v[152:153], v245 offset:45056
    ds_read_b64_tr_b16 v[154:155], v245 offset:46080
    v_mfma_f32_32x32x16_bf16 v[128:143], v[164:167], v[208:211], v[128:143]
    ds_read_b64_tr_b16 v[156:157], v246 offset:45056
    ds_read_b64_tr_b16 v[158:159], v246 offset:46080
    v_mfma_f32_32x32x16_bf16 v[48:63], v[168:171], v[212:215], v[48:63]
    ds_read_b128 v[188:191], v252 offset:40960
    ds_read_b128 v[192:195], v252 offset:45056
    v_mfma_f32_32x32x16_bf16 v[64:79], v[168:171], v[216:219], v[64:79]
    ds_read_b128 v[196:199], v252 offset:49152
    v_mfma_f32_32x32x16_bf16 v[80:95], v[168:171], v[220:223], v[80:95]
    v_mfma_f32_32x32x16_bf16 v[96:111], v[172:175], v[212:215], v[96:111]
    v_mfma_f32_32x32x16_bf16 v[112:127], v[172:175], v[216:219], v[112:127]
    v_mfma_f32_32x32x16_bf16 v[128:143], v[172:175], v[220:223], v[128:143]
    s_waitcnt lgkmcnt(7)
    v_mfma_f32_32x32x16_bf16 v[48:63], v[144:147], v[176:179], v[48:63]
    ds_read_b64_tr_b16 v[160:161], v245 offset:49152
    ds_read_b64_tr_b16 v[162:163], v245 offset:50176
    v_mfma_f32_32x32x16_bf16 v[64:79], v[144:147], v[180:183], v[64:79]
    ds_read_b64_tr_b16 v[164:165], v246 offset:49152
    ds_read_b64_tr_b16 v[166:167], v246 offset:50176
    v_mfma_f32_32x32x16_bf16 v[80:95], v[144:147], v[184:187], v[80:95]
    ds_read_b128 v[200:203], v253 offset:40960
    ds_read_b128 v[204:207], v253 offset:45056
    v_mfma_f32_32x32x16_bf16 v[96:111], v[148:151], v[176:179], v[96:111]
    ds_read_b128 v[208:211], v253 offset:49152
    s_waitcnt lgkmcnt(7)
    v_mfma_f32_32x32x16_bf16 v[112:127], v[148:151], v[180:183], v[112:127]
    ds_read_b64_tr_b16 v[168:169], v245 offset:53248
    ds_read_b64_tr_b16 v[170:171], v245 offset:54272
    v_mfma_f32_32x32x16_bf16 v[128:143], v[148:151], v[184:187], v[128:143]
    ds_read_b64_tr_b16 v[172:173], v246 offset:53248
    ds_read_b64_tr_b16 v[174:175], v246 offset:54272
    v_mfma_f32_32x32x16_bf16 v[48:63], v[152:155], v[188:191], v[48:63]
    ds_read_b128 v[212:215], v254 offset:40960
    ds_read_b128 v[216:219], v254 offset:45056
    v_mfma_f32_32x32x16_bf16 v[64:79], v[152:155], v[192:195], v[64:79]
    ds_read_b128 v[220:223], v254 offset:49152
    v_mfma_f32_32x32x16_bf16 v[80:95], v[152:155], v[196:199], v[80:95]
    v_mfma_f32_32x32x16_bf16 v[96:111], v[156:159], v[188:191], v[96:111]
    v_mfma_f32_32x32x16_bf16 v[112:127], v[156:159], v[192:195], v[112:127]
    v_mfma_f32_32x32x16_bf16 v[128:143], v[156:159], v[196:199], v[128:143]
    s_waitcnt vmcnt(10) lgkmcnt(0)
    s_barrier
    v_mfma_f32_32x32x16_bf16 v[48:63], v[160:163], v[200:203], v[48:63]
    ds_read_b64_tr_b16 v[144:145], v243 offset:0
    ds_read_b64_tr_b16 v[146:147], v243 offset:1024
    v_mfma_f32_32x32x16_bf16 v[64:79], v[160:163], v[204:207], v[64:79]
    ds_read_b64_tr_b16 v[148:149], v244 offset:0
    ds_read_b64_tr_b16 v[150:151], v244 offset:1024
    v_mfma_f32_32x32x16_bf16 v[80:95], v[160:163], v[208:211], v[80:95]
    ds_read_b128 v[176:179], v247 offset:0
    ds_read_b128 v[180:183], v247 offset:4096
    v_mfma_f32_32x32x16_bf16 v[96:111], v[164:167], v[200:203], v[96:111]
    ds_read_b128 v[184:187], v247 offset:8192
    v_mfma_f32_32x32x16_bf16 v[112:127], v[164:167], v[204:207], v[112:127]
    ds_read_b64_tr_b16 v[152:153], v243 offset:4096
    ds_read_b64_tr_b16 v[154:155], v243 offset:5120
    v_mfma_f32_32x32x16_bf16 v[128:143], v[164:167], v[208:211], v[128:143]
    ds_read_b64_tr_b16 v[156:157], v244 offset:4096
    ds_read_b64_tr_b16 v[158:159], v244 offset:5120
    v_mfma_f32_32x32x16_bf16 v[48:63], v[168:171], v[212:215], v[48:63]
    ds_read_b128 v[188:191], v248 offset:0
    ds_read_b128 v[192:195], v248 offset:4096
    v_mfma_f32_32x32x16_bf16 v[64:79], v[168:171], v[216:219], v[64:79]
    ds_read_b128 v[196:199], v248 offset:8192
    v_mfma_f32_32x32x16_bf16 v[80:95], v[168:171], v[220:223], v[80:95]
    v_mfma_f32_32x32x16_bf16 v[96:111], v[172:175], v[212:215], v[96:111]
    v_mfma_f32_32x32x16_bf16 v[112:127], v[172:175], v[216:219], v[112:127]
    v_mfma_f32_32x32x16_bf16 v[128:143], v[172:175], v[220:223], v[128:143]
    s_waitcnt lgkmcnt(7)
    v_mfma_f32_32x32x16_bf16 v[48:63], v[144:147], v[176:179], v[48:63]
    ds_read_b64_tr_b16 v[160:161], v243 offset:8192
    ds_read_b64_tr_b16 v[162:163], v243 offset:9216
    v_mfma_f32_32x32x16_bf16 v[64:79], v[144:147], v[180:183], v[64:79]
    ds_read_b64_tr_b16 v[164:165], v244 offset:8192
    ds_read_b64_tr_b16 v[166:167], v244 offset:9216
    v_mfma_f32_32x32x16_bf16 v[80:95], v[144:147], v[184:187], v[80:95]
    ds_read_b128 v[200:203], v249 offset:0
    ds_read_b128 v[204:207], v249 offset:4096
    v_mfma_f32_32x32x16_bf16 v[96:111], v[148:151], v[176:179], v[96:111]
    ds_read_b128 v[208:211], v249 offset:8192
    s_waitcnt lgkmcnt(7)
    v_mfma_f32_32x32x16_bf16 v[112:127], v[148:151], v[180:183], v[112:127]
    ds_read_b64_tr_b16 v[168:169], v243 offset:12288
    ds_read_b64_tr_b16 v[170:171], v243 offset:13312
    v_mfma_f32_32x32x16_bf16 v[128:143], v[148:151], v[184:187], v[128:143]
    ds_read_b64_tr_b16 v[172:173], v244 offset:12288
    ds_read_b64_tr_b16 v[174:175], v244 offset:13312
    v_mfma_f32_32x32x16_bf16 v[48:63], v[152:155], v[188:191], v[48:63]
    ds_read_b128 v[212:215], v250 offset:0
    ds_read_b128 v[216:219], v250 offset:4096
    v_mfma_f32_32x32x16_bf16 v[64:79], v[152:155], v[192:195], v[64:79]
    ds_read_b128 v[220:223], v250 offset:8192
    v_mfma_f32_32x32x16_bf16 v[80:95], v[152:155], v[196:199], v[80:95]
    v_mfma_f32_32x32x16_bf16 v[96:111], v[156:159], v[188:191], v[96:111]
    v_mfma_f32_32x32x16_bf16 v[112:127], v[156:159], v[192:195], v[112:127]
    v_mfma_f32_32x32x16_bf16 v[128:143], v[156:159], v[196:199], v[128:143]
    s_waitcnt vmcnt(0) lgkmcnt(0)
    s_barrier
    v_mfma_f32_32x32x16_bf16 v[48:63], v[160:163], v[200:203], v[48:63]
    ds_read_b64_tr_b16 v[144:145], v243 offset:40960
    ds_read_b64_tr_b16 v[146:147], v243 offset:41984
    v_mfma_f32_32x32x16_bf16 v[64:79], v[160:163], v[204:207], v[64:79]
    ds_read_b64_tr_b16 v[148:149], v244 offset:40960
    ds_read_b64_tr_b16 v[150:151], v244 offset:41984
    v_mfma_f32_32x32x16_bf16 v[80:95], v[160:163], v[208:211], v[80:95]
    ds_read_b128 v[176:179], v247 offset:40960
    ds_read_b128 v[180:183], v247 offset:45056
    v_mfma_f32_32x32x16_bf16 v[96:111], v[164:167], v[200:203], v[96:111]
    ds_read_b128 v[184:187], v247 offset:49152
    v_mfma_f32_32x32x16_bf16 v[112:127], v[164:167], v[204:207], v[112:127]
    ds_read_b64_tr_b16 v[152:153], v243 offset:45056
    ds_read_b64_tr_b16 v[154:155], v243 offset:46080
    v_mfma_f32_32x32x16_bf16 v[128:143], v[164:167], v[208:211], v[128:143]
    ds_read_b64_tr_b16 v[156:157], v244 offset:45056
    ds_read_b64_tr_b16 v[158:159], v244 offset:46080
    v_mfma_f32_32x32x16_bf16 v[48:63], v[168:171], v[212:215], v[48:63]
    ds_read_b128 v[188:191], v248 offset:40960
    ds_read_b128 v[192:195], v248 offset:45056
    v_mfma_f32_32x32x16_bf16 v[64:79], v[168:171], v[216:219], v[64:79]
    ds_read_b128 v[196:199], v248 offset:49152
    v_mfma_f32_32x32x16_bf16 v[80:95], v[168:171], v[220:223], v[80:95]
    v_mfma_f32_32x32x16_bf16 v[96:111], v[172:175], v[212:215], v[96:111]
    v_mfma_f32_32x32x16_bf16 v[112:127], v[172:175], v[216:219], v[112:127]
    v_mfma_f32_32x32x16_bf16 v[128:143], v[172:175], v[220:223], v[128:143]
    s_waitcnt lgkmcnt(7)
    v_mfma_f32_32x32x16_bf16 v[48:63], v[144:147], v[176:179], v[48:63]
    ds_read_b64_tr_b16 v[160:161], v243 offset:49152
    ds_read_b64_tr_b16 v[162:163], v243 offset:50176
    v_mfma_f32_32x32x16_bf16 v[64:79], v[144:147], v[180:183], v[64:79]
    ds_read_b64_tr_b16 v[164:165], v244 offset:49152
    ds_read_b64_tr_b16 v[166:167], v244 offset:50176
    v_mfma_f32_32x32x16_bf16 v[80:95], v[144:147], v[184:187], v[80:95]
    ds_read_b128 v[200:203], v249 offset:40960
    ds_read_b128 v[204:207], v249 offset:45056
    v_mfma_f32_32x32x16_bf16 v[96:111], v[148:151], v[176:179], v[96:111]
    ds_read_b128 v[208:211], v249 offset:49152
    s_waitcnt lgkmcnt(7)
    v_mfma_f32_32x32x16_bf16 v[112:127], v[148:151], v[180:183], v[112:127]
    ds_read_b64_tr_b16 v[168:169], v243 offset:53248
    ds_read_b64_tr_b16 v[170:171], v243 offset:54272
    v_mfma_f32_32x32x16_bf16 v[128:143], v[148:151], v[184:187], v[128:143]
    ds_read_b64_tr_b16 v[172:173], v244 offset:53248
    ds_read_b64_tr_b16 v[174:175], v244 offset:54272
    v_mfma_f32_32x32x16_bf16 v[48:63], v[152:155], v[188:191], v[48:63]
    ds_read_b128 v[212:215], v250 offset:40960
    ds_read_b128 v[216:219], v250 offset:45056
    v_mfma_f32_32x32x16_bf16 v[64:79], v[152:155], v[192:195], v[64:79]
    ds_read_b128 v[220:223], v250 offset:49152
    v_mfma_f32_32x32x16_bf16 v[80:95], v[152:155], v[196:199], v[80:95]
    v_mfma_f32_32x32x16_bf16 v[96:111], v[156:159], v[188:191], v[96:111]
    v_mfma_f32_32x32x16_bf16 v[112:127], v[156:159], v[192:195], v[112:127]
    v_add_u32 v15, s31, v0
    v_mfma_f32_32x32x16_bf16 v[128:143], v[156:159], v[196:199], v[128:143]
    s_waitcnt lgkmcnt(0)
    s_barrier
    v_mfma_f32_32x32x16_bf16 v[48:63], v[160:163], v[200:203], v[48:63]
    s_waitcnt vmcnt(63)
    ds_write_b128 v15, a[0:3] offset:0
    v_mfma_f32_32x32x16_bf16 v[64:79], v[160:163], v[204:207], v[64:79]
    ds_write_b128 v15, a[4:7] offset:1024
    v_mfma_f32_32x32x16_bf16 v[80:95], v[160:163], v[208:211], v[80:95]
    ds_write_b128 v15, a[8:11] offset:2048
    v_mfma_f32_32x32x16_bf16 v[96:111], v[164:167], v[200:203], v[96:111]
    ds_write_b128 v15, a[12:15] offset:3072
    v_mfma_f32_32x32x16_bf16 v[112:127], v[164:167], v[204:207], v[112:127]
    ds_write_b128 v15, a[16:19] offset:4096
    v_mfma_f32_32x32x16_bf16 v[128:143], v[164:167], v[208:211], v[128:143]
    ds_write_b128 v15, a[20:23] offset:5120
    v_mfma_f32_32x32x16_bf16 v[48:63], v[168:171], v[212:215], v[48:63]
    ds_write_b128 v15, a[24:27] offset:6144
    v_mfma_f32_32x32x16_bf16 v[64:79], v[168:171], v[216:219], v[64:79]
    ds_write_b128 v15, a[28:31] offset:7168
    v_mfma_f32_32x32x16_bf16 v[80:95], v[168:171], v[220:223], v[80:95]
    s_add_u32 s33, s28, 2
    s_lshr_b32 s34, s33, 3
    s_lshl_b32 s34, s34, 25
    s_add_u32 s33, s33, s58
    s_and_b32 s33, s33, 7
    s_lshl_b32 s33, s33, 15
    s_add_u32 s29, s33, s34
    v_mfma_f32_32x32x16_bf16 v[96:111], v[172:175], v[212:215], v[96:111]
    s_add_u32 s29, s29, s32
    s_add_u32 s30, s29, 4096
    v_mov_b32 v16, 0x3e0293ee
    v_mov_b32 v17, 0x3e0293ee
    v_mfma_f32_32x32x16_bf16 v[112:127], v[172:175], v[216:219], v[112:127]
    v_add_u32 v18, s57, v0
    v_add_u32 v19, s59, v18
    v_add_u32 v20, s59, v19
    v_mfma_f32_32x32x16_bf16 v[128:143], v[172:175], v[220:223], v[128:143]
    ds_read_b128 v[144:147], v1
    v_xor_b32 v13, 32, v1
    ds_read_b128 v[148:151], v13
    v_xor_b32 v12, 64, v1
    ds_read_b128 v[152:155], v12
    v_xor_b32 v13, 96, v1
    ds_read_b128 v[156:159], v13
    v_xor_b32 v12, 128, v1
    ds_read_b128 v[160:163], v12
    v_xor_b32 v13, 160, v1
    ds_read_b128 v[164:167], v13
    v_xor_b32 v12, 192, v1
    ds_read_b128 v[168:171], v12
    v_xor_b32 v13, 224, v1
    ds_read_b128 v[172:175], v13
    v_xor_b32 v1, 0x4000, v1
    v_pk_mul_f32 v[48:49], v[48:49], v[16:17]
    v_pk_mul_f32 v[50:51], v[50:51], v[16:17]
    v_pk_mul_f32 v[52:53], v[52:53], v[16:17]
    v_pk_mul_f32 v[54:55], v[54:55], v[16:17]
    v_pk_mul_f32 v[56:57], v[56:57], v[16:17]
    v_pk_mul_f32 v[58:59], v[58:59], v[16:17]
    v_pk_mul_f32 v[60:61], v[60:61], v[16:17]
    v_pk_mul_f32 v[62:63], v[62:63], v[16:17]
    s_waitcnt lgkmcnt(0)
    s_add_u32 m0, s31, 0
    s_nop 0
    buffer_load_dwordx4 v3, s[4:7], s29 offen offset:0 nt lds
    v_cvt_pk_bf16_f32 v176, v48, v49
    v_cvt_pk_bf16_f32 v177, v50, v51
    v_cvt_pk_bf16_f32 v178, v52, v53
    v_cvt_pk_bf16_f32 v179, v54, v55
    v_cvt_pk_bf16_f32 v180, v56, v57
    v_cvt_pk_bf16_f32 v181, v58, v59
    v_cvt_pk_bf16_f32 v182, v60, v61
    v_cvt_pk_bf16_f32 v183, v62, v63
    buffer_load_dwordx4 v4, s[4:7], s29 offen offset:1024 nt lds
    ds_write_b128 v18, v[176:179] offset:0
    ds_write_b128 v18, v[180:183] offset:1024
    v_pk_mul_f32 v[64:65], v[64:65], v[16:17]
    v_pk_mul_f32 v[66:67], v[66:67], v[16:17]
    v_pk_mul_f32 v[68:69], v[68:69], v[16:17]
    v_pk_mul_f32 v[70:71], v[70:71], v[16:17]
    v_pk_mul_f32 v[72:73], v[72:73], v[16:17]
    v_pk_mul_f32 v[74:75], v[74:75], v[16:17]
    v_pk_mul_f32 v[76:77], v[76:77], v[16:17]
    v_pk_mul_f32 v[78:79], v[78:79], v[16:17]
    buffer_load_dwordx4 v5, s[4:7], s29 offen offset:2048 nt lds
    v_cvt_pk_bf16_f32 v184, v64, v65
    v_cvt_pk_bf16_f32 v185, v66, v67
    v_cvt_pk_bf16_f32 v186, v68, v69
    v_cvt_pk_bf16_f32 v187, v70, v71
    v_cvt_pk_bf16_f32 v188, v72, v73
    v_cvt_pk_bf16_f32 v189, v74, v75
    v_cvt_pk_bf16_f32 v190, v76, v77
    v_cvt_pk_bf16_f32 v191, v78, v79
    buffer_load_dwordx4 v6, s[4:7], s29 offen offset:3072 nt lds
    ds_write_b128 v19, v[184:187] offset:0
    ds_write_b128 v19, v[188:191] offset:1024
    v_pk_mul_f32 v[80:81], v[80:81], v[16:17]
    v_pk_mul_f32 v[82:83], v[82:83], v[16:17]
    v_pk_mul_f32 v[84:85], v[84:85], v[16:17]
    v_pk_mul_f32 v[86:87], v[86:87], v[16:17]
    v_pk_mul_f32 v[88:89], v[88:89], v[16:17]
    v_pk_mul_f32 v[90:91], v[90:91], v[16:17]
    v_pk_mul_f32 v[92:93], v[92:93], v[16:17]
    v_pk_mul_f32 v[94:95], v[94:95], v[16:17]
    s_add_u32 m0, s31, 4096
    s_nop 0
    buffer_load_dwordx4 v3, s[4:7], s30 offen offset:0 nt lds
    v_cvt_pk_bf16_f32 v192, v80, v81
    v_cvt_pk_bf16_f32 v193, v82, v83
    v_cvt_pk_bf16_f32 v194, v84, v85
    v_cvt_pk_bf16_f32 v195, v86, v87
    v_cvt_pk_bf16_f32 v196, v88, v89
    v_cvt_pk_bf16_f32 v197, v90, v91
    v_cvt_pk_bf16_f32 v198, v92, v93
    v_cvt_pk_bf16_f32 v199, v94, v95
    buffer_load_dwordx4 v4, s[4:7], s30 offen offset:1024 nt lds
    ds_write_b128 v20, v[192:195] offset:0
    ds_write_b128 v20, v[196:199] offset:1024
    v_pk_mul_f32 v[96:97], v[96:97], v[16:17]
    v_pk_mul_f32 v[98:99], v[98:99], v[16:17]
    v_pk_mul_f32 v[100:101], v[100:101], v[16:17]
    v_pk_mul_f32 v[102:103], v[102:103], v[16:17]
    v_pk_mul_f32 v[104:105], v[104:105], v[16:17]
    v_pk_mul_f32 v[106:107], v[106:107], v[16:17]
    v_pk_mul_f32 v[108:109], v[108:109], v[16:17]
    v_pk_mul_f32 v[110:111], v[110:111], v[16:17]
    buffer_load_dwordx4 v5, s[4:7], s30 offen offset:2048 nt lds
    v_cvt_pk_bf16_f32 v200, v96, v97
    v_cvt_pk_bf16_f32 v201, v98, v99
    v_cvt_pk_bf16_f32 v202, v100, v101
    v_cvt_pk_bf16_f32 v203, v102, v103
    v_cvt_pk_bf16_f32 v204, v104, v105
    v_cvt_pk_bf16_f32 v205, v106, v107
    v_cvt_pk_bf16_f32 v206, v108, v109
    v_cvt_pk_bf16_f32 v207, v110, v111
    buffer_load_dwordx4 v6, s[4:7], s30 offen offset:3072 nt lds
    ds_write_b128 v18, v[200:203] offset:2048
    ds_write_b128 v18, v[204:207] offset:3072
    v_pk_mul_f32 v[112:113], v[112:113], v[16:17]
    v_pk_mul_f32 v[114:115], v[114:115], v[16:17]
    v_pk_mul_f32 v[116:117], v[116:117], v[16:17]
    v_pk_mul_f32 v[118:119], v[118:119], v[16:17]
    v_pk_mul_f32 v[120:121], v[120:121], v[16:17]
    v_pk_mul_f32 v[122:123], v[122:123], v[16:17]
    v_pk_mul_f32 v[124:125], v[124:125], v[16:17]
    v_pk_mul_f32 v[126:127], v[126:127], v[16:17]
    v_cvt_pk_bf16_f32 v208, v112, v113
    v_cvt_pk_bf16_f32 v209, v114, v115
    v_cvt_pk_bf16_f32 v210, v116, v117
    v_cvt_pk_bf16_f32 v211, v118, v119
    v_cvt_pk_bf16_f32 v212, v120, v121
    v_cvt_pk_bf16_f32 v213, v122, v123
    v_cvt_pk_bf16_f32 v214, v124, v125
    v_cvt_pk_bf16_f32 v215, v126, v127
    ds_write_b128 v19, v[208:211] offset:2048
    ds_write_b128 v19, v[212:215] offset:3072
    v_pk_mul_f32 v[128:129], v[128:129], v[16:17]
    v_pk_mul_f32 v[130:131], v[130:131], v[16:17]
    v_pk_mul_f32 v[132:133], v[132:133], v[16:17]
    v_pk_mul_f32 v[134:135], v[134:135], v[16:17]
    v_pk_mul_f32 v[136:137], v[136:137], v[16:17]
    v_pk_mul_f32 v[138:139], v[138:139], v[16:17]
    v_pk_mul_f32 v[140:141], v[140:141], v[16:17]
    v_pk_mul_f32 v[142:143], v[142:143], v[16:17]
    v_cvt_pk_bf16_f32 v216, v128, v129
    v_cvt_pk_bf16_f32 v217, v130, v131
    v_cvt_pk_bf16_f32 v218, v132, v133
    v_cvt_pk_bf16_f32 v219, v134, v135
    v_cvt_pk_bf16_f32 v220, v136, v137
    v_cvt_pk_bf16_f32 v221, v138, v139
    v_cvt_pk_bf16_f32 v222, v140, v141
    v_cvt_pk_bf16_f32 v223, v142, v143
    ds_write_b128 v20, v[216:219] offset:2048
    ds_write_b128 v20, v[220:223] offset:3072
    s_waitcnt vmcnt(63)
    ds_write_b128 v15, a[32:35] offset:8192
    ds_write_b128 v15, a[36:39] offset:9216
    ds_write_b128 v15, a[40:43] offset:10240
    ds_write_b128 v15, a[44:47] offset:11264
    ds_write_b128 v15, a[48:51] offset:12288
    ds_write_b128 v15, a[52:55] offset:13312
    ds_write_b128 v15, a[56:59] offset:14336
    ds_write_b128 v15, a[60:63] offset:15360
    s_waitcnt lgkmcnt(8)
    s_barrier
    v_add_u32 v12, 0x10000, v0
    ds_read_b128 a[192:195], v0 offset:24576
    ds_read_b128 a[196:199], v0 offset:25600
    ds_read_b128 a[200:203], v0 offset:26624
    ds_read_b128 a[204:207], v0 offset:27648
    ds_read_b128 a[208:211], v0 offset:28672
    ds_read_b128 a[212:215], v0 offset:29696
    ds_read_b128 a[216:219], v0 offset:30720
    ds_read_b128 a[220:223], v0 offset:31744
    ds_read_b128 a[224:227], v0 offset:57344
    ds_read_b128 a[228:231], v0 offset:58368
    ds_read_b128 a[232:235], v0 offset:59392
    ds_read_b128 a[236:239], v0 offset:60416
    ds_read_b128 a[240:243], v0 offset:61440
    ds_read_b128 a[244:247], v0 offset:62464
    ds_read_b128 a[248:251], v0 offset:63488
    ds_read_b128 a[252:255], v0 offset:64512
    ds_read_b128 v[208:211], v12 offset:24576
    ds_read_b128 v[212:215], v12 offset:25600
    ds_read_b128 v[216:219], v12 offset:26624
    ds_read_b128 v[220:223], v12 offset:27648
    ds_read_b128 v[224:227], v12 offset:28672
    ds_read_b128 v[228:231], v12 offset:29696
    ds_read_b128 v[232:235], v12 offset:30720
    ds_read_b128 v[236:239], v12 offset:31744
    s_waitcnt vmcnt(63)
    ds_write_b128 v15, a[64:67] offset:16384
    ds_write_b128 v15, a[68:71] offset:17408
    ds_write_b128 v15, a[72:75] offset:18432
    ds_write_b128 v15, a[76:79] offset:19456
    ds_write_b128 v15, a[80:83] offset:20480
    ds_write_b128 v15, a[84:87] offset:21504
    ds_write_b128 v15, a[88:91] offset:22528
    ds_write_b128 v15, a[92:95] offset:23552
QEND:
    s_mov_b32 s12, s48
    s_and_b32 s13, s49, 0xffff
    s_mov_b32 s14, 5242880
    s_mov_b32 s16, s50
    s_and_b32 s17, s51, 0xffff
    s_mov_b32 s18, 1966080
    s_add_u32 s52, s53, 0x9e3779b1
    s_lshl_b32 s57, s24, 15
    s_lshr_b32 s41, s2, 3
    s_mul_i32 s42, s41, 52
    s_lshr_b32 s42, s42, 8
    s_mul_i32 s43, s42, 5
    s_sub_u32 s43, s41, s43
    s_and_b32 s47, s2, 3
    s_mul_i32 s35, s42, 86
    s_lshr_b32 s35, s35, 5
    s_mul_i32 s33, s43, 103
    s_lshr_b32 s33, s33, 5
    s_add_u32 s35, s35, s33
    s_mov_b32 s36, 0
    s_mov_b32 s37, 0
    s_mul_i32 s38, s47, 1310720
    s_mul_i32 s3, s24, 20480
    s_add_u32 s38, s38, s3
    s_lshl_b32 s3, s43, 8
    s_add_u32 s38, s38, s3
    s_lshl_b32 s42, s42, 2
    s_add_u32 s42, s42, s24
    s_mul_i32 s44, s42, 81920
    s_add_u32 s44, s44, s3
    s_mul_i32 s3, s25, 1280
    s_add_u32 s44, s44, s3
    s_lshl_b32 s3, s47, 6
    s_add_u32 s44, s44, s3
    s_lshl_b32 s40, s42, 18
    s_lshl_b32 s3, s47, 16
    s_add_u32 s40, s40, s3
    s_lshl_b32 s3, s25, 15
    s_lshl_b32 s33, s47, 10
    s_add_u32 s3, s3, s33
    s_lshl_b32 s45, s27, 12
    s_add_u32 s45, s45, s3
    s_and_b32 s33, s26, 7
    s_lshl_b32 s33, s33, 2
    s_add_u32 s45, s45, s33
    s_mul_i32 s46, s42, 43
    s_lshr_b32 s46, s46, 7
    s_lshl_b32 s46, s46, 12
    s_lshl_b32 s33, s43, 7
    s_add_u32 s46, s46, s33
    s_add_u32 s46, s46, s3
    s_lshl_b32 s3, s25, 5
    s_add_u32 s3, s3, s41
    s_lshl_b32 s54, s3, 11
    s_lshl_b32 s33, s47, 2
    s_add_u32 s54, s54, s33
    s_add_u32 s54, s54, 65536
    s_lshl_b32 s33, s24, 9
    s_add_u32 s54, s54, s33
    s_mul_i32 s55, s3, 196608
    s_lshl_b32 s3, s24, 12
    s_add_u32 s55, s55, s3
    v_lshrrev_b32 v17, 8, v0
    v_lshlrev_b32 v16, 6, v17
    v_and_b32 v18, 0xf0, v0
    v_xor_b32 v16, v16, v18
    v_mul_u32_u24 v17, 0x500, v17
    v_add_u32 v248, v16, v17
    v_lshlrev_b32 v253, 3, v0
    v_mov_b32 v252, s52
    v_and_b32 v16, 0x400, v253
    v_mad_u32_u24 v16, v16, 15, v253
    v_mov_b32 v17, s53
    v_mov_b32 v18, 163328
    v_mov_b32 v19, 0
    s_lshl_b32 s33, s24, 2
    s_lshl_b64 exec, 15, s33
    buffer_store_dword v17, v16, s[92:95], s45 offen sc1
    s_mov_b64 exec, 15
    buffer_store_dword v17, v253, s[92:95], s54 offen sc1
    ds_write_b32 v18, v19
    s_mov_b64 exec, -1
    s_nop 1
    v_lshrrev_b32 v16, 4, v0
    v_bfe_u32 v17, v16, 1, 1
    v_bfe_u32 v18, v16, 3, 2
    v_lshl_add_u32 v17, v18, 1, v17
    v_bfe_u32 v18, v16, 2, 1
    v_bfe_u32 v19, v16, 5, 1
    v_xor_b32 v18, v18, v19
    v_lshl_add_u32 v17, v18, 4, v17
    v_and_b32 v18, 1, v16
    v_lshlrev_b32 v18, 4, v18
    v_mov_b32 v19, 0x3f80
    v_lshlrev_b32 v18, v18, v19
    v_cmp_eq_u32 vcc, 0, v17
    s_nop 1
    v_cndmask_b32 v240, 0, v18, vcc
    v_cmp_eq_u32 vcc, 1, v17
    s_nop 1
    v_cndmask_b32 v241, 0, v18, vcc
    v_cmp_eq_u32 vcc, 2, v17
    s_nop 1
    v_cndmask_b32 v242, 0, v18, vcc
    v_cmp_eq_u32 vcc, 3, v17
    s_nop 1
    v_cndmask_b32 v243, 0, v18, vcc
    v_cmp_eq_u32 vcc, 4, v17
    s_nop 1
    v_cndmask_b32 v244, 0, v18, vcc
    v_cmp_eq_u32 vcc, 5, v17
    s_nop 1
    v_cndmask_b32 v245, 0, v18, vcc
    v_cmp_eq_u32 vcc, 6, v17
    s_nop 1
    v_cndmask_b32 v246, 0, v18, vcc
    v_cmp_eq_u32 vcc, 7, v17
    s_nop 1
    v_cndmask_b32 v247, 0, v18, vcc
    s_waitcnt lgkmcnt(0)
    v_mfma_f32_32x32x16_bf16 v[48:63], v[144:147], a[192:195], 0
    v_mfma_f32_32x32x16_bf16 v[48:63], v[148:151], a[196:199], v[48:63]
    ds_read_b64_tr_b16 v[176:177], v2 offset:0
    ds_read_b64_tr_b16 v[178:179], v2 offset:2048
    ds_read_b64_tr_b16 v[180:181], v2 offset:4096
    v_mfma_f32_32x32x16_bf16 v[48:63], v[152:155], a[200:203], v[48:63]
    ds_read_b64_tr_b16 v[182:183], v2 offset:6144
    v_xor_b32 v13, 64, v2
    v_mfma_f32_32x32x16_bf16 v[48:63], v[156:159], a[204:207], v[48:63]
    ds_read_b64_tr_b16 v[184:185], v13 offset:0
    ds_read_b64_tr_b16 v[186:187], v13 offset:2048
    ds_read_b64_tr_b16 v[188:189], v13 offset:4096
    v_mfma_f32_32x32x16_bf16 v[48:63], v[160:163], a[208:211], v[48:63]
    ds_read_b64_tr_b16 v[190:191], v13 offset:6144
    v_xor_b32 v12, 128, v2
    v_mfma_f32_32x32x16_bf16 v[48:63], v[164:167], a[212:215], v[48:63]
    ds_read_b64_tr_b16 v[192:193], v12 offset:0
    ds_read_b64_tr_b16 v[194:195], v12 offset:2048
    ds_read_b64_tr_b16 v[196:197], v12 offset:4096
    v_mfma_f32_32x32x16_bf16 v[48:63], v[168:171], a[216:219], v[48:63]
    ds_read_b64_tr_b16 v[198:199], v12 offset:6144
    v_xor_b32 v13, 192, v2
    v_mfma_f32_32x32x16_bf16 v[48:63], v[172:175], a[220:223], v[48:63]
    ds_read_b64_tr_b16 v[200:201], v13 offset:0
    ds_read_b64_tr_b16 v[202:203], v13 offset:2048
    ds_read_b64_tr_b16 v[204:205], v13 offset:4096
    v_mfma_f32_32x32x16_bf16 v[64:79], v[144:147], a[224:227], 0
    ds_read_b64_tr_b16 v[206:207], v13 offset:6144
    v_xor_b32 v2, 0x4000, v2
    v_mfma_f32_32x32x16_bf16 v[64:79], v[148:151], a[228:231], v[64:79]
    s_waitcnt vmcnt(10) lgkmcnt(0)
    s_barrier
    v_mfma_f32_32x32x16_bf16 v[64:79], v[152:155], a[232:235], v[64:79]
    ds_write_b128 v15, a[96:99] offset:24576
    s_add_u32 s33, s31, 8192
    s_and_b32 s34, s28, 7
    s_cmp_eq_u32 s34, 7
    s_cselect_b32 m0, 158720, s33
    s_cselect_b32 s29, 0x7fff0000, s29
    buffer_load_dwordx4 v7, s[8:11], s29 offen offset:0 nt lds
    v_mov_b32 v96, 0
    v_mov_b32 v97, 0
    v_mov_b32 v98, 0
    v_mov_b32 v99, 0
    v_mov_b32 v100, 0
    v_mov_b32 v101, 0
    v_mov_b32 v102, 0
    v_mov_b32 v103, 0
    v_mfma_f32_32x32x16_bf16 v[64:79], v[156:159], a[236:239], v[64:79]
    ds_write_b128 v15, a[100:103] offset:25600
    v_mov_b32 v104, 0
    v_mov_b32 v105, 0
    v_mov_b32 v106, 0
    v_mov_b32 v107, 0
    v_mov_b32 v108, 0
    v_mov_b32 v109, 0
    v_mov_b32 v110, 0
    v_mfma_f32_32x32x16_bf16 v[64:79], v[160:163], a[240:243], v[64:79]
    ds_write_b128 v15, a[104:107] offset:26624
    buffer_load_dwordx4 v7, s[8:11], s29 offen offset:1024 nt lds
    v_mov_b32 v111, 0
    v_exp_f32 v16, v48
    v_exp_f32 v17, v49
    v_exp_f32 v18, v50
    v_exp_f32 v19, v51
    v_mfma_f32_32x32x16_bf16 v[64:79], v[164:167], a[244:247], v[64:79]
    ds_write_b128 v15, a[108:111] offset:27648
    v_add_f32 v11, v16, v17
    v_cvt_pk_bf16_f32 v24, v16, v17
    v_exp_f32 v20, v52
    v_add_f32 v11, v11, v18
    v_exp_f32 v21, v53
    v_mfma_f32_32x32x16_bf16 v[64:79], v[168:171], a[248:251], v[64:79]
    ds_write_b128 v15, a[112:115] offset:28672
    buffer_load_dwordx4 v7, s[8:11], s29 offen offset:2048 nt lds
    v_add_f32 v11, v11, v19
    v_cvt_pk_bf16_f32 v25, v18, v19
    v_exp_f32 v22, v54
    v_add_f32 v11, v11, v20
    v_exp_f32 v23, v55
    v_mfma_f32_32x32x16_bf16 v[64:79], v[172:175], a[252:255], v[64:79]
    ds_write_b128 v15, a[116:119] offset:29696
    v_add_f32 v11, v11, v21
    v_cvt_pk_bf16_f32 v26, v20, v21
    v_exp_f32 v16, v56
    v_add_f32 v11, v11, v22
    v_exp_f32 v17, v57
    v_mfma_f32_32x32x16_bf16 v[80:95], v[144:147], v[208:211], 0
    ds_write_b128 v15, a[120:123] offset:30720
    buffer_load_dwordx4 v7, s[8:11], s29 offen offset:3072 nt lds
    v_add_f32 v11, v11, v23
    v_cvt_pk_bf16_f32 v27, v22, v23
    v_exp_f32 v18, v58
    v_add_f32 v11, v11, v16
    v_exp_f32 v19, v59
    v_add_f32 v11, v11, v17
    v_mfma_f32_32x32x16_bf16 v[80:95], v[148:151], v[212:215], v[80:95]
    ds_write_b128 v15, a[124:127] offset:31744
    v_cvt_pk_bf16_f32 v28, v16, v17
    v_exp_f32 v20, v60
    v_add_f32 v11, v11, v18
    v_exp_f32 v21, v61
    v_add_f32 v11, v11, v19
    v_mfma_f32_32x32x16_bf16 v[80:95], v[152:155], v[216:219], v[80:95]
    s_add_u32 s33, s31, 12288
    s_and_b32 s34, s28, 7
    s_cmp_eq_u32 s34, 7
    s_cselect_b32 m0, 158720, s33
    s_cselect_b32 s30, 0x7fff0000, s30
    buffer_load_dwordx4 v7, s[8:11], s30 offen offset:0 nt lds
    v_cvt_pk_bf16_f32 v29, v18, v19
    v_exp_f32 v22, v62
    v_add_f32 v11, v11, v20
    v_exp_f32 v23, v63
    v_add_f32 v11, v11, v21
    v_cvt_pk_bf16_f32 v30, v20, v21
    v_mfma_f32_32x32x16_bf16 v[80:95], v[156:159], v[220:223], v[80:95]
    v_add_f32 v11, v11, v22
    v_add_f32 v11, v11, v23
    v_cvt_pk_bf16_f32 v31, v22, v23
    v_subrev_u32 v16, 0x30800000, v11
    v_cmp_lt_u32 vcc, 503316480, v16
    s_cbranch_vccnz FSLOW0A
FBACK0A:
    v_mov_b32 v8, v11
    v_mfma_f32_32x32x16_bf16 v[80:95], v[160:163], v[224:227], v[80:95]
    buffer_load_dwordx4 v7, s[8:11], s30 offen offset:1024 nt lds
    v_mov_b32 v112, 0
    v_mov_b32 v113, 0
    v_mov_b32 v114, 0
    v_mov_b32 v115, 0
    v_mov_b32 v116, 0
    v_mov_b32 v117, 0
    v_mov_b32 v118, 0
    v_mov_b32 v119, 0
    v_mfma_f32_32x32x16_bf16 v[80:95], v[164:167], v[228:231], v[80:95]
    v_mov_b32 v120, 0
    v_mov_b32 v121, 0
    v_mov_b32 v122, 0
    v_mov_b32 v123, 0
    v_mov_b32 v124, 0
    v_mov_b32 v125, 0
    v_mov_b32 v126, 0
    v_mfma_f32_32x32x16_bf16 v[80:95], v[168:171], v[232:235], v[80:95]
    buffer_load_dwordx4 v7, s[8:11], s30 offen offset:2048 nt lds
    v_mov_b32 v127, 0
    v_exp_f32 v16, v64
    v_exp_f32 v17, v65
    v_exp_f32 v18, v66
    v_exp_f32 v19, v67
    v_mfma_f32_32x32x16_bf16 v[80:95], v[172:175], v[236:239], v[80:95]
    s_waitcnt lgkmcnt(0)
    v_add_f32 v11, v16, v17
    v_cvt_pk_bf16_f32 v32, v16, v17
    v_exp_f32 v20, v68
    v_add_f32 v11, v11, v18
    v_exp_f32 v21, v69
    v_mfma_f32_32x32x16_bf16 a[0:15], v[176:179], v[24:27], 0
    buffer_load_dwordx4 v7, s[8:11], s30 offen offset:3072 nt lds
    v_add_f32 v11, v11, v19
    v_cvt_pk_bf16_f32 v33, v18, v19
    v_exp_f32 v22, v70
    v_add_f32 v11, v11, v20
    v_exp_f32 v23, v71
    v_mfma_f32_32x32x16_bf16 a[0:15], v[180:183], v[28:31], a[0:15]
    v_add_f32 v11, v11, v21
    v_cvt_pk_bf16_f32 v34, v20, v21
    v_exp_f32 v16, v72
    v_add_f32 v11, v11, v22
    v_exp_f32 v17, v73
    v_mfma_f32_32x32x16_bf16 a[48:63], v[184:187], v[24:27], 0
    v_add_f32 v11, v11, v23
    v_cvt_pk_bf16_f32 v35, v22, v23
    v_exp_f32 v18, v74
    v_add_f32 v11, v11, v16
    v_exp_f32 v19, v75
    v_add_f32 v11, v11, v17
    v_mfma_f32_32x32x16_bf16 a[48:63], v[188:191], v[28:31], a[48:63]
    v_cvt_pk_bf16_f32 v36, v16, v17
    v_exp_f32 v20, v76
    v_add_f32 v11, v11, v18
    v_exp_f32 v21, v77
    v_add_f32 v11, v11, v19
    v_mfma_f32_32x32x16_bf16 a[96:111], v[192:195], v[24:27], 0
    v_cvt_pk_bf16_f32 v37, v18, v19
    v_exp_f32 v22, v78
    v_add_f32 v11, v11, v20
    v_exp_f32 v23, v79
    v_add_f32 v11, v11, v21
    v_cvt_pk_bf16_f32 v38, v20, v21
    v_mfma_f32_32x32x16_bf16 a[96:111], v[196:199], v[28:31], a[96:111]
    v_add_f32 v11, v11, v22
    v_add_f32 v11, v11, v23
    v_cvt_pk_bf16_f32 v39, v22, v23
    v_subrev_u32 v16, 0x30800000, v11
    v_cmp_lt_u32 vcc, 503316480, v16
    s_cbranch_vccnz FSLOW1A
FBACK1A:
    v_mov_b32 v9, v11
    v_mfma_f32_32x32x16_bf16 a[144:159], v[200:203], v[24:27], 0
    v_mov_b32 v128, 0
    v_mov_b32 v129, 0
    v_mov_b32 v130, 0
    v_mov_b32 v131, 0
    v_mov_b32 v132, 0
    v_mov_b32 v133, 0
    v_mov_b32 v134, 0
    v_mov_b32 v135, 0
    v_mfma_f32_32x32x16_bf16 a[144:159], v[204:207], v[28:31], a[144:159]
    v_mov_b32 v136, 0
    v_mov_b32 v137, 0
    v_mov_b32 v138, 0
    v_mov_b32 v139, 0
    v_mov_b32 v140, 0
    v_mov_b32 v141, 0
    v_mov_b32 v142, 0
    v_mfma_f32_32x32x16_bf16 a[16:31], v[176:179], v[32:35], 0
    v_mov_b32 v143, 0
    v_exp_f32 v16, v80
    v_exp_f32 v17, v81
    v_exp_f32 v18, v82
    v_exp_f32 v19, v83
    v_mfma_f32_32x32x16_bf16 a[16:31], v[180:183], v[36:39], a[16:31]
    v_add_f32 v11, v16, v17
    v_cvt_pk_bf16_f32 v40, v16, v17
    v_exp_f32 v20, v84
    v_add_f32 v11, v11, v18
    v_exp_f32 v21, v85
    v_mfma_f32_32x32x16_bf16 a[64:79], v[184:187], v[32:35], 0
    v_add_f32 v11, v11, v19
    v_cvt_pk_bf16_f32 v41, v18, v19
    v_exp_f32 v22, v86
    v_add_f32 v11, v11, v20
    v_exp_f32 v23, v87
    v_mfma_f32_32x32x16_bf16 a[64:79], v[188:191], v[36:39], a[64:79]
    v_add_f32 v11, v11, v21
    v_cvt_pk_bf16_f32 v42, v20, v21
    v_exp_f32 v16, v88
    v_add_f32 v11, v11, v22
    v_exp_f32 v17, v89
    v_mfma_f32_32x32x16_bf16 a[112:127], v[192:195], v[32:35], 0
    v_add_f32 v11, v11, v23
    v_cvt_pk_bf16_f32 v43, v22, v23
    v_exp_f32 v18, v90
    v_add_f32 v11, v11, v16
    v_exp_f32 v19, v91
    v_add_f32 v11, v11, v17
    v_mfma_f32_32x32x16_bf16 a[112:127], v[196:199], v[36:39], a[112:127]
    v_cvt_pk_bf16_f32 v44, v16, v17
    v_exp_f32 v20, v92
    v_add_f32 v11, v11, v18
    v_exp_f32 v21, v93
    v_add_f32 v11, v11, v19
    v_mfma_f32_32x32x16_bf16 a[160:175], v[200:203], v[32:35], 0
    v_cvt_pk_bf16_f32 v45, v18, v19
    v_exp_f32 v22, v94
    v_add_f32 v11, v11, v20
    v_exp_f32 v23, v95
    v_add_f32 v11, v11, v21
    v_cvt_pk_bf16_f32 v46, v20, v21
    v_mfma_f32_32x32x16_bf16 a[160:175], v[204:207], v[36:39], a[160:175]
    v_add_f32 v11, v11, v22
    v_add_f32 v11, v11, v23
    v_cvt_pk_bf16_f32 v47, v22, v23
    v_subrev_u32 v16, 0x30800000, v11
    v_cmp_lt_u32 vcc, 503316480, v16
    s_cbranch_vccnz FSLOW2A
FBACK2A:
    v_mov_b32 v10, v11
    v_mfma_f32_32x32x16_bf16 a[32:47], v[176:179], v[40:43], 0
    ds_read_b128 v[144:147], v1
    v_xor_b32 v13, 32, v1
    ds_read_b128 v[148:151], v13
    v_mfma_f32_32x32x16_bf16 a[32:47], v[180:183], v[44:47], a[32:47]
    v_xor_b32 v12, 64, v1
    ds_read_b128 v[152:155], v12
    v_mfma_f32_32x32x16_bf16 a[80:95], v[184:187], v[40:43], 0
    v_xor_b32 v13, 96, v1
    ds_read_b128 v[156:159], v13
    v_mfma_f32_32x32x16_bf16 a[80:95], v[188:191], v[44:47], a[80:95]
    v_xor_b32 v12, 128, v1
    ds_read_b128 v[160:163], v12
    v_xor_b32 v13, 160, v1
    v_mfma_f32_32x32x16_bf16 a[128:143], v[192:195], v[40:43], 0
    ds_read_b128 v[164:167], v13
    v_xor_b32 v12, 192, v1
    v_mfma_f32_32x32x16_bf16 a[128:143], v[196:199], v[44:47], a[128:143]
    ds_read_b128 v[168:171], v12
    v_xor_b32 v13, 224, v1
    v_mfma_f32_32x32x16_bf16 a[176:191], v[200:203], v[40:43], 0
    ds_read_b128 v[172:175], v13
    v_xor_b32 v1, 0x4000, v1
    v_mfma_f32_32x32x16_bf16 a[176:191], v[204:207], v[44:47], a[176:191]
    s_xor_b32 s31, s31, 0x4000
    s_add_u32 s28, s28, 1
LOOP:
    s_waitcnt lgkmcnt(0)
    v_mfma_f32_32x32x16_bf16 v[48:63], v[144:147], a[192:195], v[96:111]
    s_add_u32 s33, s28, 2
    s_lshr_b32 s34, s33, 3
    s_lshl_b32 s34, s34, 25
    s_add_u32 s33, s33, s58
    s_and_b32 s33, s33, 7
    s_lshl_b32 s33, s33, 15
    s_add_u32 s29, s33, s34
    s_add_u32 s29, s29, s32
    s_add_u32 s30, s29, 4096
    s_waitcnt vmcnt(16)
    v_mfma_f32_32x32x16_bf16 v[48:63], v[148:151], a[196:199], v[48:63]
    ds_read_b64_tr_b16 v[176:177], v2 offset:0
    ds_read_b64_tr_b16 v[178:179], v2 offset:2048
    ds_read_b64_tr_b16 v[180:181], v2 offset:4096
    s_add_u32 m0, s31, 0
    s_nop 0
    buffer_load_dwordx4 v3, s[4:7], s29 offen offset:0 nt lds
    v_mfma_f32_32x32x16_bf16 v[48:63], v[152:155], a[200:203], v[48:63]
    ds_read_b64_tr_b16 v[182:183], v2 offset:6144
    v_xor_b32 v13, 64, v2
    v_mfma_f32_32x32x16_bf16 v[48:63], v[156:159], a[204:207], v[48:63]
    ds_read_b64_tr_b16 v[184:185], v13 offset:0
    ds_read_b64_tr_b16 v[186:187], v13 offset:2048
    ds_read_b64_tr_b16 v[188:189], v13 offset:4096
    v_mfma_f32_32x32x16_bf16 v[48:63], v[160:163], a[208:211], v[48:63]
    ds_read_b64_tr_b16 v[190:191], v13 offset:6144
    v_xor_b32 v12, 128, v2
    buffer_load_dwordx4 v4, s[4:7], s29 offen offset:1024 nt lds
    v_mfma_f32_32x32x16_bf16 v[48:63], v[164:167], a[212:215], v[48:63]
    ds_read_b64_tr_b16 v[192:193], v12 offset:0
    ds_read_b64_tr_b16 v[194:195], v12 offset:2048
    ds_read_b64_tr_b16 v[196:197], v12 offset:4096
    v_mfma_f32_32x32x16_bf16 v[48:63], v[168:171], a[216:219], v[48:63]
    ds_read_b64_tr_b16 v[198:199], v12 offset:6144
    v_xor_b32 v13, 192, v2
    v_mfma_f32_32x32x16_bf16 v[48:63], v[172:175], a[220:223], v[48:63]
    ds_read_b64_tr_b16 v[200:201], v13 offset:0
    ds_read_b64_tr_b16 v[202:203], v13 offset:2048
    ds_read_b64_tr_b16 v[204:205], v13 offset:4096
    buffer_load_dwordx4 v5, s[4:7], s29 offen offset:2048 nt lds
    v_mfma_f32_32x32x16_bf16 v[64:79], v[144:147], a[224:227], v[112:127]
    ds_read_b64_tr_b16 v[206:207], v13 offset:6144
    v_xor_b32 v2, 0x4000, v2
    v_mfma_f32_32x32x16_bf16 v[64:79], v[148:151], a[228:231], v[64:79]
    v_mfma_f32_32x32x16_bf16 v[64:79], v[152:155], a[232:235], v[64:79]
    buffer_load_dwordx4 v6, s[4:7], s29 offen offset:3072 nt lds
    v_exp_f32 v16, v48
    v_exp_f32 v17, v49
    v_exp_f32 v18, v50
    v_mfma_f32_32x32x16_bf16 v[64:79], v[156:159], a[236:239], v[64:79]
    v_exp_f32 v19, v51
    v_add_f32 v11, v16, v17
    v_cvt_pk_bf16_f32 v24, v16, v17
    v_exp_f32 v20, v52
    v_mfma_f32_32x32x16_bf16 v[64:79], v[160:163], a[240:243], v[64:79]
    v_add_f32 v11, v11, v18
    v_exp_f32 v21, v53
    v_add_f32 v11, v11, v19
    v_cvt_pk_bf16_f32 v25, v18, v19
    v_exp_f32 v22, v54
    v_mfma_f32_32x32x16_bf16 v[64:79], v[164:167], a[244:247], v[64:79]
    s_add_u32 m0, s31, 4096
    s_nop 0
    buffer_load_dwordx4 v3, s[4:7], s30 offen offset:0 nt lds
    v_add_f32 v11, v11, v20
    v_exp_f32 v23, v55
    v_add_f32 v11, v11, v21
    v_mfma_f32_32x32x16_bf16 v[64:79], v[168:171], a[248:251], v[64:79]
    v_cvt_pk_bf16_f32 v26, v20, v21
    v_exp_f32 v16, v56
    v_add_f32 v11, v11, v22
    v_exp_f32 v17, v57
    v_mfma_f32_32x32x16_bf16 v[64:79], v[172:175], a[252:255], v[64:79]
    v_add_f32 v11, v11, v23
    v_cvt_pk_bf16_f32 v27, v22, v23
    v_exp_f32 v18, v58
    v_add_f32 v11, v11, v16
    v_exp_f32 v19, v59
    v_mfma_f32_32x32x16_bf16 v[80:95], v[144:147], v[208:211], v[128:143]
    buffer_load_dwordx4 v4, s[4:7], s30 offen offset:1024 nt lds
    v_add_f32 v11, v11, v17
    v_cvt_pk_bf16_f32 v28, v16, v17
    v_exp_f32 v20, v60
    v_add_f32 v11, v11, v18
    v_mfma_f32_32x32x16_bf16 v[80:95], v[148:151], v[212:215], v[80:95]
    v_exp_f32 v21, v61
    v_add_f32 v11, v11, v19
    v_cvt_pk_bf16_f32 v29, v18, v19
    v_exp_f32 v22, v62
    v_mfma_f32_32x32x16_bf16 v[80:95], v[152:155], v[216:219], v[80:95]
    v_add_f32 v11, v11, v20
    v_exp_f32 v23, v63
    v_add_f32 v11, v11, v21
    v_cvt_pk_bf16_f32 v30, v20, v21
    v_mfma_f32_32x32x16_bf16 v[80:95], v[156:159], v[220:223], v[80:95]
    buffer_load_dwordx4 v5, s[4:7], s30 offen offset:2048 nt lds
    v_add_f32 v11, v11, v22
    v_add_f32 v11, v11, v23
    v_cvt_pk_bf16_f32 v31, v22, v23
    v_cmp_lt_f32 vcc, s39, v11
    s_cbranch_vccnz SLOW0
BACK0:
    v_add_f32 v8, v8, v11
    v_mfma_f32_32x32x16_bf16 v[80:95], v[160:163], v[224:227], v[80:95]
    v_exp_f32 v16, v64
    v_exp_f32 v17, v65
    v_exp_f32 v18, v66
    v_mfma_f32_32x32x16_bf16 v[80:95], v[164:167], v[228:231], v[80:95]
    v_exp_f32 v19, v67
    v_add_f32 v11, v16, v17
    v_cvt_pk_bf16_f32 v32, v16, v17
    v_exp_f32 v20, v68
    v_mfma_f32_32x32x16_bf16 v[80:95], v[168:171], v[232:235], v[80:95]
    buffer_load_dwordx4 v6, s[4:7], s30 offen offset:3072 nt lds
    v_add_f32 v11, v11, v18
    v_exp_f32 v21, v69
    v_add_f32 v11, v11, v19
    v_cvt_pk_bf16_f32 v33, v18, v19
    v_exp_f32 v22, v70
    v_mfma_f32_32x32x16_bf16 v[80:95], v[172:175], v[236:239], v[80:95]
    s_waitcnt lgkmcnt(0)
    v_add_f32 v11, v11, v20
    v_exp_f32 v23, v71
    v_add_f32 v11, v11, v21
    v_mfma_f32_32x32x16_bf16 a[0:15], v[176:179], v[24:27], a[0:15]
    s_add_u32 s33, s31, 8192
    s_and_b32 s34, s28, 7
    s_cmp_eq_u32 s34, 7
    s_cselect_b32 m0, 158720, s33
    s_cselect_b32 s29, 0x7fff0000, s29
    buffer_load_dwordx4 v7, s[8:11], s29 offen offset:0 nt lds
    v_cvt_pk_bf16_f32 v34, v20, v21
    v_exp_f32 v16, v72
    v_add_f32 v11, v11, v22
    v_exp_f32 v17, v73
    v_mfma_f32_32x32x16_bf16 a[0:15], v[180:183], v[28:31], a[0:15]
    v_add_f32 v11, v11, v23
    v_cvt_pk_bf16_f32 v35, v22, v23
    v_exp_f32 v18, v74
    v_add_f32 v11, v11, v16
    v_exp_f32 v19, v75
    v_mfma_f32_32x32x16_bf16 a[48:63], v[184:187], v[24:27], a[48:63]
    v_add_f32 v11, v11, v17
    v_cvt_pk_bf16_f32 v36, v16, v17
    v_exp_f32 v20, v76
    v_add_f32 v11, v11, v18
    v_mfma_f32_32x32x16_bf16 a[48:63], v[188:191], v[28:31], a[48:63]
    buffer_load_dwordx4 v7, s[8:11], s29 offen offset:1024 nt lds
    v_exp_f32 v21, v77
    v_add_f32 v11, v11, v19
    v_cvt_pk_bf16_f32 v37, v18, v19
    v_exp_f32 v22, v78
    v_mfma_f32_32x32x16_bf16 a[96:111], v[192:195], v[24:27], a[96:111]
    v_add_f32 v11, v11, v20
    v_exp_f32 v23, v79
    v_add_f32 v11, v11, v21
    v_cvt_pk_bf16_f32 v38, v20, v21
    v_mfma_f32_32x32x16_bf16 a[96:111], v[196:199], v[28:31], a[96:111]
    v_add_f32 v11, v11, v22
    v_add_f32 v11, v11, v23
    v_cvt_pk_bf16_f32 v39, v22, v23
    v_cmp_lt_f32 vcc, s39, v11
    s_cbranch_vccnz SLOW1
BACK1:
    v_add_f32 v9, v9, v11
    v_mfma_f32_32x32x16_bf16 a[144:159], v[200:203], v[24:27], a[144:159]
    buffer_load_dwordx4 v7, s[8:11], s29 offen offset:2048 nt lds
    v_exp_f32 v16, v80
    v_exp_f32 v17, v81
    v_exp_f32 v18, v82
    v_mfma_f32_32x32x16_bf16 a[144:159], v[204:207], v[28:31], a[144:159]
    v_exp_f32 v19, v83
    v_add_f32 v11, v16, v17
    v_cvt_pk_bf16_f32 v40, v16, v17
    v_exp_f32 v20, v84
    v_mfma_f32_32x32x16_bf16 a[16:31], v[176:179], v[32:35], a[16:31]
    v_add_f32 v11, v11, v18
    v_exp_f32 v21, v85
    v_add_f32 v11, v11, v19
    v_cvt_pk_bf16_f32 v41, v18, v19
    v_exp_f32 v22, v86
    v_mfma_f32_32x32x16_bf16 a[16:31], v[180:183], v[36:39], a[16:31]
    buffer_load_dwordx4 v7, s[8:11], s29 offen offset:3072 nt lds
    v_add_f32 v11, v11, v20
    v_exp_f32 v23, v87
    v_add_f32 v11, v11, v21
    v_mfma_f32_32x32x16_bf16 a[64:79], v[184:187], v[32:35], a[64:79]
    v_cvt_pk_bf16_f32 v42, v20, v21
    v_exp_f32 v16, v88
    v_add_f32 v11, v11, v22
    v_exp_f32 v17, v89
    v_mfma_f32_32x32x16_bf16 a[64:79], v[188:191], v[36:39], a[64:79]
    v_add_f32 v11, v11, v23
    v_cvt_pk_bf16_f32 v43, v22, v23
    v_exp_f32 v18, v90
    v_add_f32 v11, v11, v16
    v_exp_f32 v19, v91
    v_mfma_f32_32x32x16_bf16 a[112:127], v[192:195], v[32:35], a[112:127]
    s_add_u32 s33, s31, 12288
    s_and_b32 s34, s28, 7
    s_cmp_eq_u32 s34, 7
    s_cselect_b32 m0, 158720, s33
    s_cselect_b32 s30, 0x7fff0000, s30
    buffer_load_dwordx4 v7, s[8:11], s30 offen offset:0 nt lds
    v_add_f32 v11, v11, v17
    v_cvt_pk_bf16_f32 v44, v16, v17
    v_exp_f32 v20, v92
    v_add_f32 v11, v11, v18
    v_mfma_f32_32x32x16_bf16 a[112:127], v[196:199], v[36:39], a[112:127]
    v_exp_f32 v21, v93
    v_add_f32 v11, v11, v19
    v_cvt_pk_bf16_f32 v45, v18, v19
    v_exp_f32 v22, v94
    v_mfma_f32_32x32x16_bf16 a[160:175], v[200:203], v[32:35], a[160:175]
    v_add_f32 v11, v11, v20
    v_exp_f32 v23, v95
    v_add_f32 v11, v11, v21
    v_cvt_pk_bf16_f32 v46, v20, v21
    v_mfma_f32_32x32x16_bf16 a[160:175], v[204:207], v[36:39], a[160:175]
    buffer_load_dwordx4 v7, s[8:11], s30 offen offset:1024 nt lds
    v_add_f32 v11, v11, v22
    v_add_f32 v11, v11, v23
    v_cvt_pk_bf16_f32 v47, v22, v23
    v_cmp_lt_f32 vcc, s39, v11
    s_cbranch_vccnz SLOW2
BACK2:
    v_add_f32 v10, v10, v11
    v_mfma_f32_32x32x16_bf16 a[32:47], v[176:179], v[40:43], a[32:47]
    s_waitcnt vmcnt(22)
    ds_read_b128 v[144:147], v1
    v_xor_b32 v13, 32, v1
    ds_read_b128 v[148:151], v13
    v_mfma_f32_32x32x16_bf16 a[32:47], v[180:183], v[44:47], a[32:47]
    v_xor_b32 v12, 64, v1
    ds_read_b128 v[152:155], v12
    v_mfma_f32_32x32x16_bf16 a[80:95], v[184:187], v[40:43], a[80:95]
    buffer_load_dwordx4 v7, s[8:11], s30 offen offset:2048 nt lds
    v_xor_b32 v13, 96, v1
    ds_read_b128 v[156:159], v13
    v_mfma_f32_32x32x16_bf16 a[80:95], v[188:191], v[44:47], a[80:95]
    v_xor_b32 v12, 128, v1
    ds_read_b128 v[160:163], v12
    v_xor_b32 v13, 160, v1
    v_mfma_f32_32x32x16_bf16 a[128:143], v[192:195], v[40:43], a[128:143]
    ds_read_b128 v[164:167], v13
    v_xor_b32 v12, 192, v1
    v_mfma_f32_32x32x16_bf16 a[128:143], v[196:199], v[44:47], a[128:143]
    buffer_load_dwordx4 v7, s[8:11], s30 offen offset:3072 nt lds
    ds_read_b128 v[168:171], v12
    v_xor_b32 v13, 224, v1
    v_mfma_f32_32x32x16_bf16 a[176:191], v[200:203], v[40:43], a[176:191]
    ds_read_b128 v[172:175], v13
    v_xor_b32 v1, 0x4000, v1
    v_mfma_f32_32x32x16_bf16 a[176:191], v[204:207], v[44:47], a[176:191]
    s_xor_b32 s31, s31, 0x4000
    s_add_u32 s28, s28, 1
    s_cmp_eq_u32 s28, 14
    s_cbranch_scc1 PEEL
    s_cmp_lg_u32 s28, 8
    s_cbranch_scc1 LOOP
    s_nop 7
    s_nop 7
    v_add_u32 v12, 131072, v0
    ds_read_b128 a[192:195], v12 offset:0
    ds_read_b128 a[196:199], v12 offset:1024
    ds_read_b128 a[200:203], v12 offset:2048
    ds_read_b128 a[204:207], v12 offset:3072
    ds_read_b128 a[208:211], v12 offset:4096
    ds_read_b128 a[212:215], v12 offset:5120
    ds_read_b128 a[216:219], v12 offset:6144
    ds_read_b128 a[220:223], v12 offset:7168
    ds_read_b128 a[224:227], v12 offset:8192
    ds_read_b128 a[228:231], v12 offset:9216
    ds_read_b128 a[232:235], v12 offset:10240
    ds_read_b128 a[236:239], v12 offset:11264
    ds_read_b128 a[240:243], v12 offset:12288
    ds_read_b128 a[244:247], v12 offset:13312
    ds_read_b128 a[248:251], v12 offset:14336
    ds_read_b128 a[252:255], v12 offset:15360
    ds_read_b128 v[208:211], v12 offset:16384
    ds_read_b128 v[212:215], v12 offset:17408
    ds_read_b128 v[216:219], v12 offset:18432
    ds_read_b128 v[220:223], v12 offset:19456
    ds_read_b128 v[224:227], v12 offset:20480
    ds_read_b128 v[228:231], v12 offset:21504
    ds_read_b128 v[232:235], v12 offset:22528
    ds_read_b128 v[236:239], v12 offset:23552
    s_waitcnt lgkmcnt(0)
    s_barrier
COMBINE:
    v_mov_b32 v17, v8
    v_mov_b32 v16, v96
    s_nop 0
    v_permlane32_swap_b32 v17, v8
    s_nop 0
    v_add_f32 v17, v17, v8
    v_mov_b32 v19, v9
    v_mov_b32 v18, v112
    s_nop 0
    v_permlane32_swap_b32 v19, v9
    s_nop 0
    v_add_f32 v19, v19, v9
    v_mov_b32 v21, v10
    v_mov_b32 v20, v128
    s_nop 0
    v_permlane32_swap_b32 v21, v10
    s_nop 0
    v_add_f32 v21, v21, v10
    s_lshl_b32 s33, s24, 3
    v_add_u32 v12, s33, v255
    ds_write_b64 v12, v[16:17] offset:0
    ds_write_b64 v12, v[18:19] offset:1024
    ds_write_b64 v12, v[20:21] offset:2048
    s_cmp_eq_u32 s28, 16
    s_cselect_b32 s33, 0, 1
    s_xor_b32 s33, s24, s33
    s_mul_i32 s33, s33, 6144
    s_add_u32 s33, s33, 131072
    v_add_u32 v13, s33, v0
    v_accvgpr_read_b32 v24, a48
    v_accvgpr_read_b32 v25, a49
    v_accvgpr_read_b32 v26, a50
    v_accvgpr_read_b32 v27, a51
    v_accvgpr_read_b32 v28, a52
    v_accvgpr_read_b32 v29, a53
    v_accvgpr_read_b32 v30, a54
    v_accvgpr_read_b32 v31, a55
    v_accvgpr_read_b32 v32, a56
    v_accvgpr_read_b32 v33, a57
    v_accvgpr_read_b32 v34, a58
    v_accvgpr_read_b32 v35, a59
    v_accvgpr_read_b32 v36, a60
    v_accvgpr_read_b32 v37, a61
    v_accvgpr_read_b32 v38, a62
    v_accvgpr_read_b32 v39, a63
    v_cvt_pk_bf16_f32 v72, v24, v25
    v_cvt_pk_bf16_f32 v73, v26, v27
    v_cvt_pk_bf16_f32 v74, v28, v29
    v_cvt_pk_bf16_f32 v75, v30, v31
    v_cvt_pk_bf16_f32 v76, v32, v33
    v_cvt_pk_bf16_f32 v77, v34, v35
    v_cvt_pk_bf16_f32 v78, v36, v37
    v_cvt_pk_bf16_f32 v79, v38, v39
    ds_write_b128 v13, v[72:75] offset:0
    ds_write_b128 v13, v[76:79] offset:1024
    v_accvgpr_read_b32 v40, a64
    v_accvgpr_read_b32 v41, a65
    v_accvgpr_read_b32 v42, a66
    v_accvgpr_read_b32 v43, a67
    v_accvgpr_read_b32 v44, a68
    v_accvgpr_read_b32 v45, a69
    v_accvgpr_read_b32 v46, a70
    v_accvgpr_read_b32 v47, a71
    v_accvgpr_read_b32 v48, a72
    v_accvgpr_read_b32 v49, a73
    v_accvgpr_read_b32 v50, a74
    v_accvgpr_read_b32 v51, a75
    v_accvgpr_read_b32 v52, a76
    v_accvgpr_read_b32 v53, a77
    v_accvgpr_read_b32 v54, a78
    v_accvgpr_read_b32 v55, a79
    v_cvt_pk_bf16_f32 v80, v40, v41
    v_cvt_pk_bf16_f32 v81, v42, v43
    v_cvt_pk_bf16_f32 v82, v44, v45
    v_cvt_pk_bf16_f32 v83, v46, v47
    v_cvt_pk_bf16_f32 v84, v48, v49
    v_cvt_pk_bf16_f32 v85, v50, v51
    v_cvt_pk_bf16_f32 v86, v52, v53
    v_cvt_pk_bf16_f32 v87, v54, v55
    ds_write_b128 v13, v[80:83] offset:2048
    ds_write_b128 v13, v[84:87] offset:3072
    v_accvgpr_read_b32 v24, a80
    v_accvgpr_read_b32 v25, a81
    v_accvgpr_read_b32 v26, a82
    v_accvgpr_read_b32 v27, a83
    v_accvgpr_read_b32 v28, a84
    v_accvgpr_read_b32 v29, a85
    v_accvgpr_read_b32 v30, a86
    v_accvgpr_read_b32 v31, a87
    v_accvgpr_read_b32 v32, a88
    v_accvgpr_read_b32 v33, a89
    v_accvgpr_read_b32 v34, a90
    v_accvgpr_read_b32 v35, a91
    v_accvgpr_read_b32 v36, a92
    v_accvgpr_read_b32 v37, a93
    v_accvgpr_read_b32 v38, a94
    v_accvgpr_read_b32 v39, a95
    v_cvt_pk_bf16_f32 v88, v24, v25
    v_cvt_pk_bf16_f32 v89, v26, v27
    v_cvt_pk_bf16_f32 v90, v28, v29
    v_cvt_pk_bf16_f32 v91, v30, v31
    v_cvt_pk_bf16_f32 v92, v32, v33
    v_cvt_pk_bf16_f32 v93, v34, v35
    v_cvt_pk_bf16_f32 v94, v36, v37
    v_cvt_pk_bf16_f32 v95, v38, v39
    ds_write_b128 v13, v[88:91] offset:4096
    ds_write_b128 v13, v[92:95] offset:5120
    s_cmp_eq_u32 s28, 16
    s_cselect_b32 s33, 0, 2
    s_xor_b32 s33, s24, s33
    s_lshl_b32 s33, s33, 15
    v_add_u32 v14, s33, v0
    v_accvgpr_read_b32 v40, a96
    v_accvgpr_read_b32 v41, a97
    v_accvgpr_read_b32 v42, a98
    v_accvgpr_read_b32 v43, a99
    v_accvgpr_read_b32 v44, a100
    v_accvgpr_read_b32 v45, a101
    v_accvgpr_read_b32 v46, a102
    v_accvgpr_read_b32 v47, a103
    v_accvgpr_read_b32 v48, a104
    v_accvgpr_read_b32 v49, a105
    v_accvgpr_read_b32 v50, a106
    v_accvgpr_read_b32 v51, a107
    v_accvgpr_read_b32 v52, a108
    v_accvgpr_read_b32 v53, a109
    v_accvgpr_read_b32 v54, a110
    v_accvgpr_read_b32 v55, a111
    v_cvt_pk_bf16_f32 v96, v40, v41
    v_cvt_pk_bf16_f32 v97, v42, v43
    v_cvt_pk_bf16_f32 v98, v44, v45
    v_cvt_pk_bf16_f32 v99, v46, v47
    v_cvt_pk_bf16_f32 v100, v48, v49
    v_cvt_pk_bf16_f32 v101, v50, v51
    v_cvt_pk_bf16_f32 v102, v52, v53
    v_cvt_pk_bf16_f32 v103, v54, v55
    ds_write_b128 v14, v[96:99] offset:0
    ds_write_b128 v14, v[100:103] offset:1024
    v_accvgpr_read_b32 v24, a112
    v_accvgpr_read_b32 v25, a113
    v_accvgpr_read_b32 v26, a114
    v_accvgpr_read_b32 v27, a115
    v_accvgpr_read_b32 v28, a116
    v_accvgpr_read_b32 v29, a117
    v_accvgpr_read_b32 v30, a118
    v_accvgpr_read_b32 v31, a119
    v_accvgpr_read_b32 v32, a120
    v_accvgpr_read_b32 v33, a121
    v_accvgpr_read_b32 v34, a122
    v_accvgpr_read_b32 v35, a123
    v_accvgpr_read_b32 v36, a124
    v_accvgpr_read_b32 v37, a125
    v_accvgpr_read_b32 v38, a126
    v_accvgpr_read_b32 v39, a127
    v_cvt_pk_bf16_f32 v104, v24, v25
    v_cvt_pk_bf16_f32 v105, v26, v27
    v_cvt_pk_bf16_f32 v106, v28, v29
    v_cvt_pk_bf16_f32 v107, v30, v31
    v_cvt_pk_bf16_f32 v108, v32, v33
    v_cvt_pk_bf16_f32 v109, v34, v35
    v_cvt_pk_bf16_f32 v110, v36, v37
    v_cvt_pk_bf16_f32 v111, v38, v39
    ds_write_b128 v14, v[104:107] offset:2048
    ds_write_b128 v14, v[108:111] offset:3072
    v_accvgpr_read_b32 v40, a128
    v_accvgpr_read_b32 v41, a129
    v_accvgpr_read_b32 v42, a130
    v_accvgpr_read_b32 v43, a131
    v_accvgpr_read_b32 v44, a132
    v_accvgpr_read_b32 v45, a133
    v_accvgpr_read_b32 v46, a134
    v_accvgpr_read_b32 v47, a135
    v_accvgpr_read_b32 v48, a136
    v_accvgpr_read_b32 v49, a137
    v_accvgpr_read_b32 v50, a138
    v_accvgpr_read_b32 v51, a139
    v_accvgpr_read_b32 v52, a140
    v_accvgpr_read_b32 v53, a141
    v_accvgpr_read_b32 v54, a142
    v_accvgpr_read_b32 v55, a143
    v_cvt_pk_bf16_f32 v112, v40, v41
    v_cvt_pk_bf16_f32 v113, v42, v43
    v_cvt_pk_bf16_f32 v114, v44, v45
    v_cvt_pk_bf16_f32 v115, v46, v47
    v_cvt_pk_bf16_f32 v116, v48, v49
    v_cvt_pk_bf16_f32 v117, v50, v51
    v_cvt_pk_bf16_f32 v118, v52, v53
    v_cvt_pk_bf16_f32 v119, v54, v55
    ds_write_b128 v14, v[112:115] offset:4096
    ds_write_b128 v14, v[116:119] offset:5120
    s_cmp_eq_u32 s28, 16
    s_cselect_b32 s33, 0, 3
    s_xor_b32 s33, s24, s33
    s_lshl_b32 s33, s33, 15
    v_add_u32 v15, s33, v0
    v_accvgpr_read_b32 v24, a144
    v_accvgpr_read_b32 v25, a145
    v_accvgpr_read_b32 v26, a146
    v_accvgpr_read_b32 v27, a147
    v_accvgpr_read_b32 v28, a148
    v_accvgpr_read_b32 v29, a149
    v_accvgpr_read_b32 v30, a150
    v_accvgpr_read_b32 v31, a151
    v_accvgpr_read_b32 v32, a152
    v_accvgpr_read_b32 v33, a153
    v_accvgpr_read_b32 v34, a154
    v_accvgpr_read_b32 v35, a155
    v_accvgpr_read_b32 v36, a156
    v_accvgpr_read_b32 v37, a157
    v_accvgpr_read_b32 v38, a158
    v_accvgpr_read_b32 v39, a159
    v_cvt_pk_bf16_f32 v120, v24, v25
    v_cvt_pk_bf16_f32 v121, v26, v27
    v_cvt_pk_bf16_f32 v122, v28, v29
    v_cvt_pk_bf16_f32 v123, v30, v31
    v_cvt_pk_bf16_f32 v124, v32, v33
    v_cvt_pk_bf16_f32 v125, v34, v35
    v_cvt_pk_bf16_f32 v126, v36, v37
    v_cvt_pk_bf16_f32 v127, v38, v39
    ds_write_b128 v15, v[120:123] offset:24576
    ds_write_b128 v15, v[124:127] offset:25600
    v_accvgpr_read_b32 v40, a160
    v_accvgpr_read_b32 v41, a161
    v_accvgpr_read_b32 v42, a162
    v_accvgpr_read_b32 v43, a163
    v_accvgpr_read_b32 v44, a164
    v_accvgpr_read_b32 v45, a165
    v_accvgpr_read_b32 v46, a166
    v_accvgpr_read_b32 v47, a167
    v_accvgpr_read_b32 v48, a168
    v_accvgpr_read_b32 v49, a169
    v_accvgpr_read_b32 v50, a170
    v_accvgpr_read_b32 v51, a171
    v_accvgpr_read_b32 v52, a172
    v_accvgpr_read_b32 v53, a173
    v_accvgpr_read_b32 v54, a174
    v_accvgpr_read_b32 v55, a175
    v_cvt_pk_bf16_f32 v128, v40, v41
    v_cvt_pk_bf16_f32 v129, v42, v43
    v_cvt_pk_bf16_f32 v130, v44, v45
    v_cvt_pk_bf16_f32 v131, v46, v47
    v_cvt_pk_bf16_f32 v132, v48, v49
    v_cvt_pk_bf16_f32 v133, v50, v51
    v_cvt_pk_bf16_f32 v134, v52, v53
    v_cvt_pk_bf16_f32 v135, v54, v55
    ds_write_b128 v15, v[128:131] offset:26624
    ds_write_b128 v15, v[132:135] offset:27648
    v_accvgpr_read_b32 v24, a176
    v_accvgpr_read_b32 v25, a177
    v_accvgpr_read_b32 v26, a178
    v_accvgpr_read_b32 v27, a179
    v_accvgpr_read_b32 v28, a180
    v_accvgpr_read_b32 v29, a181
    v_accvgpr_read_b32 v30, a182
    v_accvgpr_read_b32 v31, a183
    v_accvgpr_read_b32 v32, a184
    v_accvgpr_read_b32 v33, a185
    v_accvgpr_read_b32 v34, a186
    v_accvgpr_read_b32 v35, a187
    v_accvgpr_read_b32 v36, a188
    v_accvgpr_read_b32 v37, a189
    v_accvgpr_read_b32 v38, a190
    v_accvgpr_read_b32 v39, a191
    v_cvt_pk_bf16_f32 v136, v24, v25
    v_cvt_pk_bf16_f32 v137, v26, v27
    v_cvt_pk_bf16_f32 v138, v28, v29
    v_cvt_pk_bf16_f32 v139, v30, v31
    v_cvt_pk_bf16_f32 v140, v32, v33
    v_cvt_pk_bf16_f32 v141, v34, v35
    v_cvt_pk_bf16_f32 v142, v36, v37
    v_cvt_pk_bf16_f32 v143, v38, v39
    ds_write_b128 v15, v[136:139] offset:28672
    ds_write_b128 v15, v[140:143] offset:29696
    s_cmp_eq_u32 s28, 16
    s_cbranch_scc0 CP1
    s_add_u32 s33, s36, s35
    s_and_b32 s33, s33, 15
    s_mul_i32 s41, s33, 81920
    s_add_u32 s41, s41, s38
    s_add_u32 s36, s36, 1
    s_add_u32 m0, s57, 8192
    s_add_u32 s33, s41, 0
    buffer_load_dwordx4 v248, s[12:15], s33 offen lds
    s_add_u32 m0, s57, 9216
    s_add_u32 s33, s41, 5120
    buffer_load_dwordx4 v248, s[12:15], s33 offen lds
    s_add_u32 m0, s57, 10240
    s_add_u32 s33, s41, 10240
    buffer_load_dwordx4 v248, s[12:15], s33 offen lds
    s_add_u32 m0, s57, 11264
    s_add_u32 s33, s41, 15360
    buffer_load_dwordx4 v248, s[12:15], s33 offen lds
    s_add_u32 s33, s36, s35
    s_and_b32 s33, s33, 15
    s_mul_i32 s41, s33, 81920
    s_add_u32 s41, s41, s38
    s_add_u32 s36, s36, 1
    s_add_u32 m0, s57, 12288
    s_add_u32 s33, s41, 0
    buffer_load_dwordx4 v248, s[12:15], s33 offen lds
    s_add_u32 m0, s57, 13312
    s_add_u32 s33, s41, 5120
    buffer_load_dwordx4 v248, s[12:15], s33 offen lds
    s_add_u32 m0, s57, 14336
    s_add_u32 s33, s41, 10240
    buffer_load_dwordx4 v248, s[12:15], s33 offen lds
    s_add_u32 m0, s57, 15360
    s_add_u32 s33, s41, 15360
    buffer_load_dwordx4 v248, s[12:15], s33 offen lds
CP1:
    v_accvgpr_read_b32 v24, a0
    v_accvgpr_read_b32 v25, a1
    v_accvgpr_read_b32 v26, a2
    v_accvgpr_read_b32 v27, a3
    v_accvgpr_read_b32 v28, a4
    v_accvgpr_read_b32 v29, a5
    v_accvgpr_read_b32 v30, a6
    v_accvgpr_read_b32 v31, a7
    v_accvgpr_read_b32 v32, a8
    v_accvgpr_read_b32 v33, a9
    v_accvgpr_read_b32 v34, a10
    v_accvgpr_read_b32 v35, a11
    v_accvgpr_read_b32 v36, a12
    v_accvgpr_read_b32 v37, a13
    v_accvgpr_read_b32 v38, a14
    v_accvgpr_read_b32 v39, a15
    v_accvgpr_read_b32 v40, a16
    v_accvgpr_read_b32 v41, a17
    v_accvgpr_read_b32 v42, a18
    v_accvgpr_read_b32 v43, a19
    v_accvgpr_read_b32 v44, a20
    v_accvgpr_read_b32 v45, a21
    v_accvgpr_read_b32 v46, a22
    v_accvgpr_read_b32 v47, a23
    v_accvgpr_read_b32 v48, a24
    v_accvgpr_read_b32 v49, a25
    v_accvgpr_read_b32 v50, a26
    v_accvgpr_read_b32 v51, a27
    v_accvgpr_read_b32 v52, a28
    v_accvgpr_read_b32 v53, a29
    v_accvgpr_read_b32 v54, a30
    v_accvgpr_read_b32 v55, a31
    v_accvgpr_read_b32 v56, a32
    v_accvgpr_read_b32 v57, a33
    v_accvgpr_read_b32 v58, a34
    v_accvgpr_read_b32 v59, a35
    v_accvgpr_read_b32 v60, a36
    v_accvgpr_read_b32 v61, a37
    v_accvgpr_read_b32 v62, a38
    v_accvgpr_read_b32 v63, a39
    v_accvgpr_read_b32 v64, a40
    v_accvgpr_read_b32 v65, a41
    v_accvgpr_read_b32 v66, a42
    v_accvgpr_read_b32 v67, a43
    v_accvgpr_read_b32 v68, a44
    v_accvgpr_read_b32 v69, a45
    v_accvgpr_read_b32 v70, a46
    v_accvgpr_read_b32 v71, a47
    s_cmp_eq_u32 s28, 16
    s_cselect_b32 s33, 1, 0
    s_xor_b32 s33, s24, s33
    s_mul_i32 s33, s33, 6144
    s_add_u32 s33, s33, 131072
    v_add_u32 v203, s33, v0
    v_xor_b32 v200, 8, v12
    s_cmp_eq_u32 s28, 16
    s_cselect_b32 s33, 2, 0
    s_xor_b32 s33, s24, s33
    s_lshl_b32 s33, s33, 15
    v_add_u32 v204, s33, v0
    v_xor_b32 v201, 16, v12
    s_cmp_eq_u32 s28, 16
    s_cselect_b32 s33, 3, 0
    s_xor_b32 s33, s24, s33
    s_lshl_b32 s33, s33, 15
    v_add_u32 v205, s33, v0
    v_xor_b32 v202, 24, v12
    s_waitcnt lgkmcnt(0)
    s_barrier
    ds_read_b64 v[176:177], v200 offset:0
    ds_read_b64 v[178:179], v201 offset:0
    ds_read_b64 v[180:181], v202 offset:0
    ds_read_b64 v[182:183], v200 offset:1024
    ds_read_b64 v[184:185], v201 offset:1024
    ds_read_b64 v[186:187], v202 offset:1024
    ds_read_b64 v[188:189], v200 offset:2048
    ds_read_b64 v[190:191], v201 offset:2048
    ds_read_b64 v[192:193], v202 offset:2048
    ds_read_b128 v[72:75], v203 offset:0
    ds_read_b128 v[76:79], v203 offset:2048
    ds_read_b128 v[80:83], v203 offset:4096
    ds_read_b128 v[84:87], v203 offset:1024
    ds_read_b128 v[88:91], v203 offset:3072
    ds_read_b128 v[92:95], v203 offset:5120
    s_waitcnt lgkmcnt(6)
    ds_read_b128 v[96:99], v204 offset:0
    ds_read_b128 v[100:103], v204 offset:2048
    ds_read_b128 v[104:107], v204 offset:4096
    ds_read_b128 v[108:111], v204 offset:1024
    ds_read_b128 v[112:115], v204 offset:3072
    ds_read_b128 v[116:119], v204 offset:5120
    v_xor_b32 v194, v176, v16
    v_xor_b32 v195, v178, v16
    v_xor_b32 v196, v180, v16
    v_or3_b32 v8, v194, v195, v196
    v_xor_b32 v194, v182, v18
    v_xor_b32 v195, v184, v18
    v_xor_b32 v196, v186, v18
    v_or3_b32 v9, v194, v195, v196
    v_xor_b32 v194, v188, v20
    v_xor_b32 v195, v190, v20
    v_xor_b32 v196, v192, v20
    v_or3_b32 v10, v194, v195, v196
    v_or3_b32 v8, v8, v9, v10
    v_cmp_ne_u32 vcc, 0, v8
    s_cbranch_vccnz SLOWC
    ds_read_b128 v[120:123], v205 offset:24576
    s_waitcnt lgkmcnt(12)
    v_mfma_f32_32x32x16_bf16 v[24:39], v[240:243], v[72:75], v[24:39]
    ds_read_b128 v[124:127], v205 offset:26624
    s_waitcnt lgkmcnt(12)
    v_mfma_f32_32x32x16_bf16 v[40:55], v[240:243], v[76:79], v[40:55]
    ds_read_b128 v[128:131], v205 offset:28672
    s_waitcnt lgkmcnt(12)
    v_mfma_f32_32x32x16_bf16 v[56:71], v[240:243], v[80:83], v[56:71]
    ds_read_b128 v[132:135], v205 offset:25600
    s_waitcnt lgkmcnt(12)
    v_mfma_f32_32x32x16_bf16 v[24:39], v[244:247], v[84:87], v[24:39]
    ds_read_b128 v[136:139], v205 offset:27648
    s_waitcnt lgkmcnt(12)
    v_mfma_f32_32x32x16_bf16 v[40:55], v[244:247], v[88:91], v[40:55]
    ds_read_b128 v[140:143], v205 offset:29696
    s_waitcnt lgkmcnt(12)
    v_mfma_f32_32x32x16_bf16 v[56:71], v[244:247], v[92:95], v[56:71]
    s_waitcnt lgkmcnt(11)
    v_mfma_f32_32x32x16_bf16 v[24:39], v[240:243], v[96:99], v[24:39]
    v_add_f32 v17, v17, v177
    v_add_f32 v179, v179, v181
    v_add_f32 v17, v17, v179
    v_rcp_f32 v16, v17
    s_waitcnt lgkmcnt(10)
    v_mfma_f32_32x32x16_bf16 v[40:55], v[240:243], v[100:103], v[40:55]
    v_add_f32 v19, v19, v183
    v_add_f32 v185, v185, v187
    v_add_f32 v19, v19, v185
    v_rcp_f32 v18, v19
    s_waitcnt lgkmcnt(9)
    v_mfma_f32_32x32x16_bf16 v[56:71], v[240:243], v[104:107], v[56:71]
    v_add_f32 v21, v21, v189
    v_add_f32 v191, v191, v193
    v_add_f32 v21, v21, v191
    v_rcp_f32 v20, v21
    s_waitcnt lgkmcnt(8)
    v_mfma_f32_32x32x16_bf16 v[24:39], v[244:247], v[108:111], v[24:39]
    s_waitcnt lgkmcnt(7)
    v_mfma_f32_32x32x16_bf16 v[40:55], v[244:247], v[112:115], v[40:55]
    s_waitcnt lgkmcnt(6)
    v_mfma_f32_32x32x16_bf16 v[56:71], v[244:247], v[116:119], v[56:71]
    s_waitcnt lgkmcnt(5)
    v_mfma_f32_32x32x16_bf16 v[24:39], v[240:243], v[120:123], v[24:39]
    s_waitcnt lgkmcnt(4)
    v_mfma_f32_32x32x16_bf16 v[40:55], v[240:243], v[124:127], v[40:55]
    s_waitcnt lgkmcnt(3)
    v_mfma_f32_32x32x16_bf16 v[56:71], v[240:243], v[128:131], v[56:71]
    s_waitcnt lgkmcnt(2)
    v_mfma_f32_32x32x16_bf16 v[24:39], v[244:247], v[132:135], v[24:39]
    s_waitcnt lgkmcnt(1)
    v_mfma_f32_32x32x16_bf16 v[40:55], v[244:247], v[136:139], v[40:55]
    s_waitcnt lgkmcnt(0)
    v_mfma_f32_32x32x16_bf16 v[56:71], v[244:247], v[140:143], v[56:71]
CFIN:
    s_cmp_eq_u32 s28, 16
    s_cbranch_scc0 CB1
    s_nop 7
    s_nop 3
    s_branch CB2
CB1:
    s_add_u32 s33, s28, 1
    s_lshr_b32 s34, s33, 3
    s_lshl_b32 s34, s34, 25
    s_add_u32 s33, s33, s58
    s_and_b32 s33, s33, 7
    s_lshl_b32 s33, s33, 15
    s_add_u32 s29, s33, s34
    s_add_u32 s29, s29, s32
    s_add_u32 s30, s29, 4096
    s_add_u32 m0, s31, 24576
    s_nop 0
    buffer_load_dwordx4 v7, s[8:11], s29 offen offset:0 nt lds
    buffer_load_dwordx4 v7, s[8:11], s29 offen offset:1024 nt lds
    buffer_load_dwordx4 v7, s[8:11], s29 offen offset:2048 nt lds
    buffer_load_dwordx4 v7, s[8:11], s29 offen offset:3072 nt lds
    s_add_u32 m0, s31, 28672
    s_nop 0
    buffer_load_dwordx4 v7, s[8:11], s30 offen offset:0 nt lds
    buffer_load_dwordx4 v7, s[8:11], s30 offen offset:1024 nt lds
    buffer_load_dwordx4 v7, s[8:11], s30 offen offset:2048 nt lds
    buffer_load_dwordx4 v7, s[8:11], s30 offen offset:3072 nt lds
CB2:
    v_pk_mul_f32 v[24:25], v[24:25], v[16:17] op_sel_hi:[1,0]
    v_pk_mul_f32 v[26:27], v[26:27], v[16:17] op_sel_hi:[1,0]
    v_pk_mul_f32 v[28:29], v[28:29], v[16:17] op_sel_hi:[1,0]
    v_pk_mul_f32 v[30:31], v[30:31], v[16:17] op_sel_hi:[1,0]
    v_pk_mul_f32 v[32:33], v[32:33], v[16:17] op_sel_hi:[1,0]
    v_pk_mul_f32 v[34:35], v[34:35], v[16:17] op_sel_hi:[1,0]
    v_pk_mul_f32 v[36:37], v[36:37], v[16:17] op_sel_hi:[1,0]
    v_pk_mul_f32 v[38:39], v[38:39], v[16:17] op_sel_hi:[1,0]
    v_cvt_pk_bf16_f32 v176, v24, v25
    v_cvt_pk_bf16_f32 v177, v26, v27
    v_cvt_pk_bf16_f32 v178, v28, v29
    v_cvt_pk_bf16_f32 v179, v30, v31
    v_cvt_pk_bf16_f32 v180, v32, v33
    v_cvt_pk_bf16_f32 v181, v34, v35
    v_cvt_pk_bf16_f32 v182, v36, v37
    v_cvt_pk_bf16_f32 v183, v38, v39
    s_add_u32 s33, s56, 0
    buffer_store_dwordx4 v[176:179], v0, s[20:23], s33 offen offset:0 sc1
    buffer_store_dwordx4 v[180:183], v0, s[20:23], s33 offen offset:1024 sc1
    v_pk_mul_f32 v[40:41], v[40:41], v[18:19] op_sel_hi:[1,0]
    v_pk_mul_f32 v[42:43], v[42:43], v[18:19] op_sel_hi:[1,0]
    v_pk_mul_f32 v[44:45], v[44:45], v[18:19] op_sel_hi:[1,0]
    v_pk_mul_f32 v[46:47], v[46:47], v[18:19] op_sel_hi:[1,0]
    v_pk_mul_f32 v[48:49], v[48:49], v[18:19] op_sel_hi:[1,0]
    v_pk_mul_f32 v[50:51], v[50:51], v[18:19] op_sel_hi:[1,0]
    v_pk_mul_f32 v[52:53], v[52:53], v[18:19] op_sel_hi:[1,0]
    v_pk_mul_f32 v[54:55], v[54:55], v[18:19] op_sel_hi:[1,0]
    v_cvt_pk_bf16_f32 v184, v40, v41
    v_cvt_pk_bf16_f32 v185, v42, v43
    v_cvt_pk_bf16_f32 v186, v44, v45
    v_cvt_pk_bf16_f32 v187, v46, v47
    v_cvt_pk_bf16_f32 v188, v48, v49
    v_cvt_pk_bf16_f32 v189, v50, v51
    v_cvt_pk_bf16_f32 v190, v52, v53
    v_cvt_pk_bf16_f32 v191, v54, v55
    s_add_u32 s33, s56, 262144
    buffer_store_dwordx4 v[184:187], v0, s[20:23], s33 offen offset:0 sc1
    buffer_store_dwordx4 v[188:191], v0, s[20:23], s33 offen offset:1024 sc1
    v_pk_mul_f32 v[56:57], v[56:57], v[20:21] op_sel_hi:[1,0]
    v_pk_mul_f32 v[58:59], v[58:59], v[20:21] op_sel_hi:[1,0]
    v_pk_mul_f32 v[60:61], v[60:61], v[20:21] op_sel_hi:[1,0]
    v_pk_mul_f32 v[62:63], v[62:63], v[20:21] op_sel_hi:[1,0]
    v_pk_mul_f32 v[64:65], v[64:65], v[20:21] op_sel_hi:[1,0]
    v_pk_mul_f32 v[66:67], v[66:67], v[20:21] op_sel_hi:[1,0]
    v_pk_mul_f32 v[68:69], v[68:69], v[20:21] op_sel_hi:[1,0]
    v_pk_mul_f32 v[70:71], v[70:71], v[20:21] op_sel_hi:[1,0]
    v_cvt_pk_bf16_f32 v192, v56, v57
    v_cvt_pk_bf16_f32 v193, v58, v59
    v_cvt_pk_bf16_f32 v194, v60, v61
    v_cvt_pk_bf16_f32 v195, v62, v63
    v_cvt_pk_bf16_f32 v196, v64, v65
    v_cvt_pk_bf16_f32 v197, v66, v67
    v_cvt_pk_bf16_f32 v198, v68, v69
    v_cvt_pk_bf16_f32 v199, v70, v71
    s_add_u32 s33, s56, 524288
    buffer_store_dwordx4 v[192:195], v0, s[20:23], s33 offen offset:0 sc1
    buffer_store_dwordx4 v[196:199], v0, s[20:23], s33 offen offset:1024 sc1
    s_add_u32 s56, s56, 3145728
    s_nop 1
    s_cmp_eq_u32 s28, 16
    s_cbranch_scc1 OPROJ
    s_waitcnt lgkmcnt(0)
    v_mfma_f32_32x32x16_bf16 v[48:63], v[144:147], a[192:195], 0
    s_add_u32 s33, s28, 2
    s_lshr_b32 s34, s33, 3
    s_lshl_b32 s34, s34, 25
    s_add_u32 s33, s33, s58
    s_and_b32 s33, s33, 7
    s_lshl_b32 s33, s33, 15
    s_add_u32 s29, s33, s34
    s_add_u32 s29, s29, s32
    s_add_u32 s30, s29, 4096
    s_waitcnt vmcnt(16)
    v_mfma_f32_32x32x16_bf16 v[48:63], v[148:151], a[196:199], v[48:63]
    ds_read_b64_tr_b16 v[176:177], v2 offset:0
    ds_read_b64_tr_b16 v[178:179], v2 offset:2048
    ds_read_b64_tr_b16 v[180:181], v2 offset:4096
    s_add_u32 m0, s31, 0
    s_nop 0
    buffer_load_dwordx4 v3, s[4:7], s29 offen offset:0 nt lds
    v_mfma_f32_32x32x16_bf16 v[48:63], v[152:155], a[200:203], v[48:63]
    ds_read_b64_tr_b16 v[182:183], v2 offset:6144
    v_xor_b32 v13, 64, v2
    v_mfma_f32_32x32x16_bf16 v[48:63], v[156:159], a[204:207], v[48:63]
    ds_read_b64_tr_b16 v[184:185], v13 offset:0
    ds_read_b64_tr_b16 v[186:187], v13 offset:2048
    ds_read_b64_tr_b16 v[188:189], v13 offset:4096
    v_mfma_f32_32x32x16_bf16 v[48:63], v[160:163], a[208:211], v[48:63]
    ds_read_b64_tr_b16 v[190:191], v13 offset:6144
    v_xor_b32 v12, 128, v2
    buffer_load_dwordx4 v4, s[4:7], s29 offen offset:1024 nt lds
    v_mfma_f32_32x32x16_bf16 v[48:63], v[164:167], a[212:215], v[48:63]
    ds_read_b64_tr_b16 v[192:193], v12 offset:0
    ds_read_b64_tr_b16 v[194:195], v12 offset:2048
    ds_read_b64_tr_b16 v[196:197], v12 offset:4096
    v_mfma_f32_32x32x16_bf16 v[48:63], v[168:171], a[216:219], v[48:63]
    ds_read_b64_tr_b16 v[198:199], v12 offset:6144
    v_xor_b32 v13, 192, v2
    v_mfma_f32_32x32x16_bf16 v[48:63], v[172:175], a[220:223], v[48:63]
    ds_read_b64_tr_b16 v[200:201], v13 offset:0
    ds_read_b64_tr_b16 v[202:203], v13 offset:2048
    ds_read_b64_tr_b16 v[204:205], v13 offset:4096
    buffer_load_dwordx4 v5, s[4:7], s29 offen offset:2048 nt lds
    v_mfma_f32_32x32x16_bf16 v[64:79], v[144:147], a[224:227], 0
    ds_read_b64_tr_b16 v[206:207], v13 offset:6144
    v_xor_b32 v2, 0x4000, v2
    v_mfma_f32_32x32x16_bf16 v[64:79], v[148:151], a[228:231], v[64:79]
    v_mfma_f32_32x32x16_bf16 v[64:79], v[152:155], a[232:235], v[64:79]
    buffer_load_dwordx4 v6, s[4:7], s29 offen offset:3072 nt lds
    v_mov_b32 v96, 0
    v_mov_b32 v97, 0
    v_mov_b32 v98, 0
    v_mov_b32 v99, 0
    v_mov_b32 v100, 0
    v_mov_b32 v101, 0
    v_mov_b32 v102, 0
    v_mov_b32 v103, 0
    v_mfma_f32_32x32x16_bf16 v[64:79], v[156:159], a[236:239], v[64:79]
    v_mov_b32 v104, 0
    v_mov_b32 v105, 0
    v_mov_b32 v106, 0
    v_mov_b32 v107, 0
    v_mov_b32 v108, 0
    v_mov_b32 v109, 0
    v_mov_b32 v110, 0
    v_mfma_f32_32x32x16_bf16 v[64:79], v[160:163], a[240:243], v[64:79]
    v_mov_b32 v111, 0
    v_exp_f32 v16, v48
    v_exp_f32 v17, v49
    v_exp_f32 v18, v50
    v_exp_f32 v19, v51
    v_mfma_f32_32x32x16_bf16 v[64:79], v[164:167], a[244:247], v[64:79]
    s_add_u32 m0, s31, 4096
    s_nop 0
    buffer_load_dwordx4 v3, s[4:7], s30 offen offset:0 nt lds
    v_add_f32 v11, v16, v17
    v_cvt_pk_bf16_f32 v24, v16, v17
    v_exp_f32 v20, v52
    v_add_f32 v11, v11, v18
    v_exp_f32 v21, v53
    v_mfma_f32_32x32x16_bf16 v[64:79], v[168:171], a[248:251], v[64:79]
    v_add_f32 v11, v11, v19
    v_cvt_pk_bf16_f32 v25, v18, v19
    v_exp_f32 v22, v54
    v_add_f32 v11, v11, v20
    v_exp_f32 v23, v55
    v_mfma_f32_32x32x16_bf16 v[64:79], v[172:175], a[252:255], v[64:79]
    v_add_f32 v11, v11, v21
    v_cvt_pk_bf16_f32 v26, v20, v21
    v_exp_f32 v16, v56
    v_add_f32 v11, v11, v22
    v_exp_f32 v17, v57
    v_mfma_f32_32x32x16_bf16 v[80:95], v[144:147], v[208:211], 0
    buffer_load_dwordx4 v4, s[4:7], s30 offen offset:1024 nt lds
    v_add_f32 v11, v11, v23
    v_cvt_pk_bf16_f32 v27, v22, v23
    v_exp_f32 v18, v58
    v_add_f32 v11, v11, v16
    v_exp_f32 v19, v59
    v_add_f32 v11, v11, v17
    v_mfma_f32_32x32x16_bf16 v[80:95], v[148:151], v[212:215], v[80:95]
    v_cvt_pk_bf16_f32 v28, v16, v17
    v_exp_f32 v20, v60
    v_add_f32 v11, v11, v18
    v_exp_f32 v21, v61
    v_add_f32 v11, v11, v19
    v_mfma_f32_32x32x16_bf16 v[80:95], v[152:155], v[216:219], v[80:95]
    v_cvt_pk_bf16_f32 v29, v18, v19
    v_exp_f32 v22, v62
    v_add_f32 v11, v11, v20
    v_exp_f32 v23, v63
    v_add_f32 v11, v11, v21
    v_cvt_pk_bf16_f32 v30, v20, v21
    v_mfma_f32_32x32x16_bf16 v[80:95], v[156:159], v[220:223], v[80:95]
    buffer_load_dwordx4 v5, s[4:7], s30 offen offset:2048 nt lds
    v_add_f32 v11, v11, v22
    v_add_f32 v11, v11, v23
    v_cvt_pk_bf16_f32 v31, v22, v23
    v_subrev_u32 v16, 0x30800000, v11
    v_cmp_lt_u32 vcc, 503316480, v16
    s_cbranch_vccnz FSLOW0B
FBACK0B:
    v_mov_b32 v8, v11
    v_mfma_f32_32x32x16_bf16 v[80:95], v[160:163], v[224:227], v[80:95]
    v_mov_b32 v112, 0
    v_mov_b32 v113, 0
    v_mov_b32 v114, 0
    v_mov_b32 v115, 0
    v_mov_b32 v116, 0
    v_mov_b32 v117, 0
    v_mov_b32 v118, 0
    v_mov_b32 v119, 0
    v_mfma_f32_32x32x16_bf16 v[80:95], v[164:167], v[228:231], v[80:95]
    v_mov_b32 v120, 0
    v_mov_b32 v121, 0
    v_mov_b32 v122, 0
    v_mov_b32 v123, 0
    v_mov_b32 v124, 0
    v_mov_b32 v125, 0
    v_mov_b32 v126, 0
    v_mfma_f32_32x32x16_bf16 v[80:95], v[168:171], v[232:235], v[80:95]
    buffer_load_dwordx4 v6, s[4:7], s30 offen offset:3072 nt lds
    v_mov_b32 v127, 0
    v_exp_f32 v16, v64
    v_exp_f32 v17, v65
    v_exp_f32 v18, v66
    v_exp_f32 v19, v67
    v_mfma_f32_32x32x16_bf16 v[80:95], v[172:175], v[236:239], v[80:95]
    s_waitcnt lgkmcnt(0)
    v_add_f32 v11, v16, v17
    v_cvt_pk_bf16_f32 v32, v16, v17
    v_exp_f32 v20, v68
    v_add_f32 v11, v11, v18
    v_exp_f32 v21, v69
    v_mfma_f32_32x32x16_bf16 a[0:15], v[176:179], v[24:27], 0
    s_add_u32 s33, s31, 8192
    s_and_b32 s34, s28, 7
    s_cmp_eq_u32 s34, 7
    s_cselect_b32 m0, 158720, s33
    s_cselect_b32 s29, 0x7fff0000, s29
    buffer_load_dwordx4 v7, s[8:11], s29 offen offset:0 nt lds
    v_add_f32 v11, v11, v19
    v_cvt_pk_bf16_f32 v33, v18, v19
    v_exp_f32 v22, v70
    v_add_f32 v11, v11, v20
    v_exp_f32 v23, v71
    v_mfma_f32_32x32x16_bf16 a[0:15], v[180:183], v[28:31], a[0:15]
    v_add_f32 v11, v11, v21
    v_cvt_pk_bf16_f32 v34, v20, v21
    v_exp_f32 v16, v72
    v_add_f32 v11, v11, v22
    v_exp_f32 v17, v73
    v_mfma_f32_32x32x16_bf16 a[48:63], v[184:187], v[24:27], 0
    v_add_f32 v11, v11, v23
    v_cvt_pk_bf16_f32 v35, v22, v23
    v_exp_f32 v18, v74
    v_add_f32 v11, v11, v16
    v_exp_f32 v19, v75
    v_add_f32 v11, v11, v17
    v_mfma_f32_32x32x16_bf16 a[48:63], v[188:191], v[28:31], a[48:63]
    buffer_load_dwordx4 v7, s[8:11], s29 offen offset:1024 nt lds
    v_cvt_pk_bf16_f32 v36, v16, v17
    v_exp_f32 v20, v76
    v_add_f32 v11, v11, v18
    v_exp_f32 v21, v77
    v_add_f32 v11, v11, v19
    v_mfma_f32_32x32x16_bf16 a[96:111], v[192:195], v[24:27], 0
    v_cvt_pk_bf16_f32 v37, v18, v19
    v_exp_f32 v22, v78
    v_add_f32 v11, v11, v20
    v_exp_f32 v23, v79
    v_add_f32 v11, v11, v21
    v_cvt_pk_bf16_f32 v38, v20, v21
    v_mfma_f32_32x32x16_bf16 a[96:111], v[196:199], v[28:31], a[96:111]
    v_add_f32 v11, v11, v22
    v_add_f32 v11, v11, v23
    v_cvt_pk_bf16_f32 v39, v22, v23
    v_subrev_u32 v16, 0x30800000, v11
    v_cmp_lt_u32 vcc, 503316480, v16
    s_cbranch_vccnz FSLOW1B
FBACK1B:
    v_mov_b32 v9, v11
    v_mfma_f32_32x32x16_bf16 a[144:159], v[200:203], v[24:27], 0
    buffer_load_dwordx4 v7, s[8:11], s29 offen offset:2048 nt lds
    v_mov_b32 v128, 0
    v_mov_b32 v129, 0
    v_mov_b32 v130, 0
    v_mov_b32 v131, 0
    v_mov_b32 v132, 0
    v_mov_b32 v133, 0
    v_mov_b32 v134, 0
    v_mov_b32 v135, 0
    v_mfma_f32_32x32x16_bf16 a[144:159], v[204:207], v[28:31], a[144:159]
    v_mov_b32 v136, 0
    v_mov_b32 v137, 0
    v_mov_b32 v138, 0
    v_mov_b32 v139, 0
    v_mov_b32 v140, 0
    v_mov_b32 v141, 0
    v_mov_b32 v142, 0
    v_mfma_f32_32x32x16_bf16 a[16:31], v[176:179], v[32:35], 0
    v_mov_b32 v143, 0
    v_exp_f32 v16, v80
    v_exp_f32 v17, v81
    v_exp_f32 v18, v82
    v_exp_f32 v19, v83
    v_mfma_f32_32x32x16_bf16 a[16:31], v[180:183], v[36:39], a[16:31]
    buffer_load_dwordx4 v7, s[8:11], s29 offen offset:3072 nt lds
    v_add_f32 v11, v16, v17
    v_cvt_pk_bf16_f32 v40, v16, v17
    v_exp_f32 v20, v84
    v_add_f32 v11, v11, v18
    v_exp_f32 v21, v85
    v_mfma_f32_32x32x16_bf16 a[64:79], v[184:187], v[32:35], 0
    v_add_f32 v11, v11, v19
    v_cvt_pk_bf16_f32 v41, v18, v19
    v_exp_f32 v22, v86
    v_add_f32 v11, v11, v20
    v_exp_f32 v23, v87
    v_mfma_f32_32x32x16_bf16 a[64:79], v[188:191], v[36:39], a[64:79]
    v_add_f32 v11, v11, v21
    v_cvt_pk_bf16_f32 v42, v20, v21
    v_exp_f32 v16, v88
    v_add_f32 v11, v11, v22
    v_exp_f32 v17, v89
    v_mfma_f32_32x32x16_bf16 a[112:127], v[192:195], v[32:35], 0
    s_add_u32 s33, s31, 12288
    s_and_b32 s34, s28, 7
    s_cmp_eq_u32 s34, 7
    s_cselect_b32 m0, 158720, s33
    s_cselect_b32 s30, 0x7fff0000, s30
    buffer_load_dwordx4 v7, s[8:11], s30 offen offset:0 nt lds
    v_add_f32 v11, v11, v23
    v_cvt_pk_bf16_f32 v43, v22, v23
    v_exp_f32 v18, v90
    v_add_f32 v11, v11, v16
    v_exp_f32 v19, v91
    v_add_f32 v11, v11, v17
    v_mfma_f32_32x32x16_bf16 a[112:127], v[196:199], v[36:39], a[112:127]
    v_cvt_pk_bf16_f32 v44, v16, v17
    v_exp_f32 v20, v92
    v_add_f32 v11, v11, v18
    v_exp_f32 v21, v93
    v_add_f32 v11, v11, v19
    v_mfma_f32_32x32x16_bf16 a[160:175], v[200:203], v[32:35], 0
    v_cvt_pk_bf16_f32 v45, v18, v19
    v_exp_f32 v22, v94
    v_add_f32 v11, v11, v20
    v_exp_f32 v23, v95
    v_add_f32 v11, v11, v21
    v_cvt_pk_bf16_f32 v46, v20, v21
    v_mfma_f32_32x32x16_bf16 a[160:175], v[204:207], v[36:39], a[160:175]
    buffer_load_dwordx4 v7, s[8:11], s30 offen offset:1024 nt lds
    v_add_f32 v11, v11, v22
    v_add_f32 v11, v11, v23
    v_cvt_pk_bf16_f32 v47, v22, v23
    v_subrev_u32 v16, 0x30800000, v11
    v_cmp_lt_u32 vcc, 503316480, v16
    s_cbranch_vccnz FSLOW2B
FBACK2B:
    v_mov_b32 v10, v11
    v_mfma_f32_32x32x16_bf16 a[32:47], v[176:179], v[40:43], 0
    s_waitcnt vmcnt(22)
    ds_read_b128 v[144:147], v1
    v_xor_b32 v13, 32, v1
    ds_read_b128 v[148:151], v13
    v_mfma_f32_32x32x16_bf16 a[32:47], v[180:183], v[44:47], a[32:47]
    v_xor_b32 v12, 64, v1
    ds_read_b128 v[152:155], v12
    v_mfma_f32_32x32x16_bf16 a[80:95], v[184:187], v[40:43], 0
    buffer_load_dwordx4 v7, s[8:11], s30 offen offset:2048 nt lds
    v_xor_b32 v13, 96, v1
    ds_read_b128 v[156:159], v13
    v_mfma_f32_32x32x16_bf16 a[80:95], v[188:191], v[44:47], a[80:95]
    v_xor_b32 v12, 128, v1
    ds_read_b128 v[160:163], v12
    v_xor_b32 v13, 160, v1
    v_mfma_f32_32x32x16_bf16 a[128:143], v[192:195], v[40:43], 0
    ds_read_b128 v[164:167], v13
    v_xor_b32 v12, 192, v1
    v_mfma_f32_32x32x16_bf16 a[128:143], v[196:199], v[44:47], a[128:143]
    buffer_load_dwordx4 v7, s[8:11], s30 offen offset:3072 nt lds
    ds_read_b128 v[168:171], v12
    v_xor_b32 v13, 224, v1
    v_mfma_f32_32x32x16_bf16 a[176:191], v[200:203], v[40:43], 0
    ds_read_b128 v[172:175], v13
    v_xor_b32 v1, 0x4000, v1
    v_mfma_f32_32x32x16_bf16 a[176:191], v[204:207], v[44:47], a[176:191]
    s_xor_b32 s31, s31, 0x4000
    s_add_u32 s28, s28, 1
    s_waitcnt vmcnt(16)
    v_mov_b32 v16, 163328
    v_mov_b32 v17, 1
    s_mov_b64 exec, 1
    ds_add_rtn_u32 v18, v16, v17
    s_waitcnt lgkmcnt(0)
    v_cmp_eq_u32 vcc, 3, v18
    s_cbranch_vccz PUB1
    s_mov_b64 exec, 63
    buffer_store_dword v252, v253, s[92:95], s45 offen sc1
PUB1:
    s_mov_b64 exec, -1
    s_add_u32 s45, s45, 16384
    s_nop 0
    s_branch LOOP
PEEL:
    s_waitcnt lgkmcnt(0)
    v_mfma_f32_32x32x16_bf16 v[48:63], v[144:147], a[192:195], v[96:111]
    s_waitcnt vmcnt(16)
    v_mfma_f32_32x32x16_bf16 v[48:63], v[148:151], a[196:199], v[48:63]
    ds_read_b64_tr_b16 v[176:177], v2 offset:0
    ds_read_b64_tr_b16 v[178:179], v2 offset:2048
    ds_read_b64_tr_b16 v[180:181], v2 offset:4096
    v_mfma_f32_32x32x16_bf16 v[48:63], v[152:155], a[200:203], v[48:63]
    ds_read_b64_tr_b16 v[182:183], v2 offset:6144
    v_xor_b32 v13, 64, v2
    v_mfma_f32_32x32x16_bf16 v[48:63], v[156:159], a[204:207], v[48:63]
    ds_read_b64_tr_b16 v[184:185], v13 offset:0
    ds_read_b64_tr_b16 v[186:187], v13 offset:2048
    ds_read_b64_tr_b16 v[188:189], v13 offset:4096
    v_mfma_f32_32x32x16_bf16 v[48:63], v[160:163], a[208:211], v[48:63]
    ds_read_b64_tr_b16 v[190:191], v13 offset:6144
    v_xor_b32 v12, 128, v2
    v_mfma_f32_32x32x16_bf16 v[48:63], v[164:167], a[212:215], v[48:63]
    ds_read_b64_tr_b16 v[192:193], v12 offset:0
    ds_read_b64_tr_b16 v[194:195], v12 offset:2048
    ds_read_b64_tr_b16 v[196:197], v12 offset:4096
    v_mfma_f32_32x32x16_bf16 v[48:63], v[168:171], a[216:219], v[48:63]
    ds_read_b64_tr_b16 v[198:199], v12 offset:6144
    v_xor_b32 v13, 192, v2
    v_mfma_f32_32x32x16_bf16 v[48:63], v[172:175], a[220:223], v[48:63]
    ds_read_b64_tr_b16 v[200:201], v13 offset:0
    ds_read_b64_tr_b16 v[202:203], v13 offset:2048
    ds_read_b64_tr_b16 v[204:205], v13 offset:4096
    v_mfma_f32_32x32x16_bf16 v[64:79], v[144:147], a[224:227], v[112:127]
    ds_read_b64_tr_b16 v[206:207], v13 offset:6144
    v_xor_b32 v2, 0x4000, v2
    v_mfma_f32_32x32x16_bf16 v[64:79], v[148:151], a[228:231], v[64:79]
    v_mfma_f32_32x32x16_bf16 v[64:79], v[152:155], a[232:235], v[64:79]
    v_exp_f32 v16, v48
    v_exp_f32 v17, v49
    v_exp_f32 v18, v50
    v_mfma_f32_32x32x16_bf16 v[64:79], v[156:159], a[236:239], v[64:79]
    v_exp_f32 v19, v51
    v_add_f32 v11, v16, v17
    v_cvt_pk_bf16_f32 v24, v16, v17
    v_exp_f32 v20, v52
    v_mfma_f32_32x32x16_bf16 v[64:79], v[160:163], a[240:243], v[64:79]
    v_add_f32 v11, v11, v18
    v_exp_f32 v21, v53
    v_add_f32 v11, v11, v19
    v_cvt_pk_bf16_f32 v25, v18, v19
    v_exp_f32 v22, v54
    v_mfma_f32_32x32x16_bf16 v[64:79], v[164:167], a[244:247], v[64:79]
    v_add_f32 v11, v11, v20
    v_exp_f32 v23, v55
    v_add_f32 v11, v11, v21
    v_mfma_f32_32x32x16_bf16 v[64:79], v[168:171], a[248:251], v[64:79]
    v_cvt_pk_bf16_f32 v26, v20, v21
    v_exp_f32 v16, v56
    v_add_f32 v11, v11, v22
    v_exp_f32 v17, v57
    v_mfma_f32_32x32x16_bf16 v[64:79], v[172:175], a[252:255], v[64:79]
    v_add_f32 v11, v11, v23
    v_cvt_pk_bf16_f32 v27, v22, v23
    v_exp_f32 v18, v58
    v_add_f32 v11, v11, v16
    v_exp_f32 v19, v59
    v_mfma_f32_32x32x16_bf16 v[80:95], v[144:147], v[208:211], v[128:143]
    v_add_f32 v11, v11, v17
    v_cvt_pk_bf16_f32 v28, v16, v17
    v_exp_f32 v20, v60
    v_add_f32 v11, v11, v18
    v_mfma_f32_32x32x16_bf16 v[80:95], v[148:151], v[212:215], v[80:95]
    v_exp_f32 v21, v61
    v_add_f32 v11, v11, v19
    v_cvt_pk_bf16_f32 v29, v18, v19
    v_exp_f32 v22, v62
    v_mfma_f32_32x32x16_bf16 v[80:95], v[152:155], v[216:219], v[80:95]
    v_add_f32 v11, v11, v20
    v_exp_f32 v23, v63
    v_add_f32 v11, v11, v21
    v_cvt_pk_bf16_f32 v30, v20, v21
    v_mfma_f32_32x32x16_bf16 v[80:95], v[156:159], v[220:223], v[80:95]
    v_add_f32 v11, v11, v22
    v_add_f32 v11, v11, v23
    v_cvt_pk_bf16_f32 v31, v22, v23
    v_cmp_lt_f32 vcc, s39, v11
    s_cbranch_vccnz SLOW0_14
BACK0_14:
    v_add_f32 v8, v8, v11
    v_mfma_f32_32x32x16_bf16 v[80:95], v[160:163], v[224:227], v[80:95]
    v_exp_f32 v16, v64
    v_exp_f32 v17, v65
    v_exp_f32 v18, v66
    v_mfma_f32_32x32x16_bf16 v[80:95], v[164:167], v[228:231], v[80:95]
    v_exp_f32 v19, v67
    v_add_f32 v11, v16, v17
    v_cvt_pk_bf16_f32 v32, v16, v17
    v_exp_f32 v20, v68
    v_mfma_f32_32x32x16_bf16 v[80:95], v[168:171], v[232:235], v[80:95]
    v_add_f32 v11, v11, v18
    v_exp_f32 v21, v69
    v_add_f32 v11, v11, v19
    v_cvt_pk_bf16_f32 v33, v18, v19
    v_exp_f32 v22, v70
    v_mfma_f32_32x32x16_bf16 v[80:95], v[172:175], v[236:239], v[80:95]
    s_waitcnt lgkmcnt(0)
    v_add_f32 v11, v11, v20
    v_exp_f32 v23, v71
    v_add_f32 v11, v11, v21
    v_mfma_f32_32x32x16_bf16 a[0:15], v[176:179], v[24:27], a[0:15]
    v_cvt_pk_bf16_f32 v34, v20, v21
    v_exp_f32 v16, v72
    v_add_f32 v11, v11, v22
    v_exp_f32 v17, v73
    v_mfma_f32_32x32x16_bf16 a[0:15], v[180:183], v[28:31], a[0:15]
    v_add_f32 v11, v11, v23
    v_cvt_pk_bf16_f32 v35, v22, v23
    v_exp_f32 v18, v74
    v_add_f32 v11, v11, v16
    v_exp_f32 v19, v75
    v_mfma_f32_32x32x16_bf16 a[48:63], v[184:187], v[24:27], a[48:63]
    v_add_f32 v11, v11, v17
    v_cvt_pk_bf16_f32 v36, v16, v17
    v_exp_f32 v20, v76
    v_add_f32 v11, v11, v18
    v_mfma_f32_32x32x16_bf16 a[48:63], v[188:191], v[28:31], a[48:63]
    v_exp_f32 v21, v77
    v_add_f32 v11, v11, v19
    v_cvt_pk_bf16_f32 v37, v18, v19
    v_exp_f32 v22, v78
    v_mfma_f32_32x32x16_bf16 a[96:111], v[192:195], v[24:27], a[96:111]
    v_add_f32 v11, v11, v20
    v_exp_f32 v23, v79
    v_add_f32 v11, v11, v21
    v_cvt_pk_bf16_f32 v38, v20, v21
    v_mfma_f32_32x32x16_bf16 a[96:111], v[196:199], v[28:31], a[96:111]
    v_add_f32 v11, v11, v22
    v_add_f32 v11, v11, v23
    v_cvt_pk_bf16_f32 v39, v22, v23
    v_cmp_lt_f32 vcc, s39, v11
    s_cbranch_vccnz SLOW1_14
BACK1_14:
    v_add_f32 v9, v9, v11
    v_mfma_f32_32x32x16_bf16 a[144:159], v[200:203], v[24:27], a[144:159]
    v_exp_f32 v16, v80
    v_exp_f32 v17, v81
    v_exp_f32 v18, v82
    v_mfma_f32_32x32x16_bf16 a[144:159], v[204:207], v[28:31], a[144:159]
    v_exp_f32 v19, v83
    v_add_f32 v11, v16, v17
    v_cvt_pk_bf16_f32 v40, v16, v17
    v_exp_f32 v20, v84
    v_mfma_f32_32x32x16_bf16 a[16:31], v[176:179], v[32:35], a[16:31]
    v_add_f32 v11, v11, v18
    v_exp_f32 v21, v85
    v_add_f32 v11, v11, v19
    v_cvt_pk_bf16_f32 v41, v18, v19
    v_exp_f32 v22, v86
    v_mfma_f32_32x32x16_bf16 a[16:31], v[180:183], v[36:39], a[16:31]
    v_add_f32 v11, v11, v20
    v_exp_f32 v23, v87
    v_add_f32 v11, v11, v21
    v_mfma_f32_32x32x16_bf16 a[64:79], v[184:187], v[32:35], a[64:79]
    v_cvt_pk_bf16_f32 v42, v20, v21
    v_exp_f32 v16, v88
    v_add_f32 v11, v11, v22
    v_exp_f32 v17, v89
    v_mfma_f32_32x32x16_bf16 a[64:79], v[188:191], v[36:39], a[64:79]
    v_add_f32 v11, v11, v23
    v_cvt_pk_bf16_f32 v43, v22, v23
    v_exp_f32 v18, v90
    v_add_f32 v11, v11, v16
    v_exp_f32 v19, v91
    v_mfma_f32_32x32x16_bf16 a[112:127], v[192:195], v[32:35], a[112:127]
    v_add_f32 v11, v11, v17
    v_cvt_pk_bf16_f32 v44, v16, v17
    v_exp_f32 v20, v92
    v_add_f32 v11, v11, v18
    v_mfma_f32_32x32x16_bf16 a[112:127], v[196:199], v[36:39], a[112:127]
    v_exp_f32 v21, v93
    v_add_f32 v11, v11, v19
    v_cvt_pk_bf16_f32 v45, v18, v19
    v_exp_f32 v22, v94
    v_mfma_f32_32x32x16_bf16 a[160:175], v[200:203], v[32:35], a[160:175]
    v_add_f32 v11, v11, v20
    v_exp_f32 v23, v95
    v_add_f32 v11, v11, v21
    v_cvt_pk_bf16_f32 v46, v20, v21
    v_mfma_f32_32x32x16_bf16 a[160:175], v[204:207], v[36:39], a[160:175]
    v_add_f32 v11, v11, v22
    v_add_f32 v11, v11, v23
    v_cvt_pk_bf16_f32 v47, v22, v23
    v_cmp_lt_f32 vcc, s39, v11
    s_cbranch_vccnz SLOW2_14
BACK2_14:
    v_add_f32 v10, v10, v11
    v_mfma_f32_32x32x16_bf16 a[32:47], v[176:179], v[40:43], a[32:47]
    s_waitcnt vmcnt(8)
    ds_read_b128 v[144:147], v1
    v_xor_b32 v13, 32, v1
    ds_read_b128 v[148:151], v13
    v_mfma_f32_32x32x16_bf16 a[32:47], v[180:183], v[44:47], a[32:47]
    v_xor_b32 v12, 64, v1
    ds_read_b128 v[152:155], v12
    v_mfma_f32_32x32x16_bf16 a[80:95], v[184:187], v[40:43], a[80:95]
    v_xor_b32 v13, 96, v1
    ds_read_b128 v[156:159], v13
    v_mfma_f32_32x32x16_bf16 a[80:95], v[188:191], v[44:47], a[80:95]
    v_xor_b32 v12, 128, v1
    ds_read_b128 v[160:163], v12
    v_xor_b32 v13, 160, v1
    v_mfma_f32_32x32x16_bf16 a[128:143], v[192:195], v[40:43], a[128:143]
    ds_read_b128 v[164:167], v13
    v_xor_b32 v12, 192, v1
    v_mfma_f32_32x32x16_bf16 a[128:143], v[196:199], v[44:47], a[128:143]
    ds_read_b128 v[168:171], v12
    v_xor_b32 v13, 224, v1
    v_mfma_f32_32x32x16_bf16 a[176:191], v[200:203], v[40:43], a[176:191]
    ds_read_b128 v[172:175], v13
    v_xor_b32 v1, 0x4000, v1
    v_mfma_f32_32x32x16_bf16 a[176:191], v[204:207], v[44:47], a[176:191]
    s_xor_b32 s31, s31, 0x4000
    s_add_u32 s28, s28, 1
    s_waitcnt lgkmcnt(0)
    v_mfma_f32_32x32x16_bf16 v[48:63], v[144:147], a[192:195], v[96:111]
    s_waitcnt vmcnt(0)
    v_mfma_f32_32x32x16_bf16 v[48:63], v[148:151], a[196:199], v[48:63]
    ds_read_b64_tr_b16 v[176:177], v2 offset:0
    ds_read_b64_tr_b16 v[178:179], v2 offset:2048
    ds_read_b64_tr_b16 v[180:181], v2 offset:4096
    v_mfma_f32_32x32x16_bf16 v[48:63], v[152:155], a[200:203], v[48:63]
    ds_read_b64_tr_b16 v[182:183], v2 offset:6144
    v_xor_b32 v13, 64, v2
    v_mfma_f32_32x32x16_bf16 v[48:63], v[156:159], a[204:207], v[48:63]
    ds_read_b64_tr_b16 v[184:185], v13 offset:0
    ds_read_b64_tr_b16 v[186:187], v13 offset:2048
    ds_read_b64_tr_b16 v[188:189], v13 offset:4096
    v_mfma_f32_32x32x16_bf16 v[48:63], v[160:163], a[208:211], v[48:63]
    ds_read_b64_tr_b16 v[190:191], v13 offset:6144
    v_xor_b32 v12, 128, v2
    v_mfma_f32_32x32x16_bf16 v[48:63], v[164:167], a[212:215], v[48:63]
    ds_read_b64_tr_b16 v[192:193], v12 offset:0
    ds_read_b64_tr_b16 v[194:195], v12 offset:2048
    ds_read_b64_tr_b16 v[196:197], v12 offset:4096
    v_mfma_f32_32x32x16_bf16 v[48:63], v[168:171], a[216:219], v[48:63]
    ds_read_b64_tr_b16 v[198:199], v12 offset:6144
    v_xor_b32 v13, 192, v2
    v_mfma_f32_32x32x16_bf16 v[48:63], v[172:175], a[220:223], v[48:63]
    ds_read_b64_tr_b16 v[200:201], v13 offset:0
    ds_read_b64_tr_b16 v[202:203], v13 offset:2048
    ds_read_b64_tr_b16 v[204:205], v13 offset:4096
    v_mfma_f32_32x32x16_bf16 v[64:79], v[144:147], a[224:227], v[112:127]
    ds_read_b64_tr_b16 v[206:207], v13 offset:6144
    v_xor_b32 v2, 0x4000, v2
    v_mfma_f32_32x32x16_bf16 v[64:79], v[148:151], a[228:231], v[64:79]
    v_mfma_f32_32x32x16_bf16 v[64:79], v[152:155], a[232:235], v[64:79]
    v_exp_f32 v16, v48
    v_exp_f32 v17, v49
    v_exp_f32 v18, v50
    v_mfma_f32_32x32x16_bf16 v[64:79], v[156:159], a[236:239], v[64:79]
    v_exp_f32 v19, v51
    v_add_f32 v11, v16, v17
    v_cvt_pk_bf16_f32 v24, v16, v17
    v_exp_f32 v20, v52
    v_mfma_f32_32x32x16_bf16 v[64:79], v[160:163], a[240:243], v[64:79]
    v_add_f32 v11, v11, v18
    v_exp_f32 v21, v53
    v_add_f32 v11, v11, v19
    v_cvt_pk_bf16_f32 v25, v18, v19
    v_exp_f32 v22, v54
    v_mfma_f32_32x32x16_bf16 v[64:79], v[164:167], a[244:247], v[64:79]
    v_add_f32 v11, v11, v20
    v_exp_f32 v23, v55
    v_add_f32 v11, v11, v21
    v_mfma_f32_32x32x16_bf16 v[64:79], v[168:171], a[248:251], v[64:79]
    v_cvt_pk_bf16_f32 v26, v20, v21
    v_exp_f32 v16, v56
    v_add_f32 v11, v11, v22
    v_exp_f32 v17, v57
    v_mfma_f32_32x32x16_bf16 v[64:79], v[172:175], a[252:255], v[64:79]
    v_add_f32 v11, v11, v23
    v_cvt_pk_bf16_f32 v27, v22, v23
    v_exp_f32 v18, v58
    v_add_f32 v11, v11, v16
    v_exp_f32 v19, v59
    v_mfma_f32_32x32x16_bf16 v[80:95], v[144:147], v[208:211], v[128:143]
    v_add_f32 v11, v11, v17
    v_cvt_pk_bf16_f32 v28, v16, v17
    v_exp_f32 v20, v60
    v_add_f32 v11, v11, v18
    v_mfma_f32_32x32x16_bf16 v[80:95], v[148:151], v[212:215], v[80:95]
    v_exp_f32 v21, v61
    v_add_f32 v11, v11, v19
    v_cvt_pk_bf16_f32 v29, v18, v19
    v_exp_f32 v22, v62
    v_mfma_f32_32x32x16_bf16 v[80:95], v[152:155], v[216:219], v[80:95]
    v_add_f32 v11, v11, v20
    v_exp_f32 v23, v63
    v_add_f32 v11, v11, v21
    v_cvt_pk_bf16_f32 v30, v20, v21
    v_mfma_f32_32x32x16_bf16 v[80:95], v[156:159], v[220:223], v[80:95]
    v_add_f32 v11, v11, v22
    v_add_f32 v11, v11, v23
    v_cvt_pk_bf16_f32 v31, v22, v23
    v_cmp_lt_f32 vcc, s39, v11
    s_cbranch_vccnz SLOW0_15
BACK0_15:
    v_add_f32 v8, v8, v11
    v_mfma_f32_32x32x16_bf16 v[80:95], v[160:163], v[224:227], v[80:95]
    v_exp_f32 v16, v64
    v_exp_f32 v17, v65
    v_exp_f32 v18, v66
    v_mfma_f32_32x32x16_bf16 v[80:95], v[164:167], v[228:231], v[80:95]
    v_exp_f32 v19, v67
    v_add_f32 v11, v16, v17
    v_cvt_pk_bf16_f32 v32, v16, v17
    v_exp_f32 v20, v68
    v_mfma_f32_32x32x16_bf16 v[80:95], v[168:171], v[232:235], v[80:95]
    v_add_f32 v11, v11, v18
    v_exp_f32 v21, v69
    v_add_f32 v11, v11, v19
    v_cvt_pk_bf16_f32 v33, v18, v19
    v_exp_f32 v22, v70
    v_mfma_f32_32x32x16_bf16 v[80:95], v[172:175], v[236:239], v[80:95]
    s_waitcnt lgkmcnt(0)
    v_add_f32 v11, v11, v20
    v_exp_f32 v23, v71
    v_add_f32 v11, v11, v21
    v_mfma_f32_32x32x16_bf16 a[0:15], v[176:179], v[24:27], a[0:15]
    v_cvt_pk_bf16_f32 v34, v20, v21
    v_exp_f32 v16, v72
    v_add_f32 v11, v11, v22
    v_exp_f32 v17, v73
    v_mfma_f32_32x32x16_bf16 a[0:15], v[180:183], v[28:31], a[0:15]
    v_add_f32 v11, v11, v23
    v_cvt_pk_bf16_f32 v35, v22, v23
    v_exp_f32 v18, v74
    v_add_f32 v11, v11, v16
    v_exp_f32 v19, v75
    v_mfma_f32_32x32x16_bf16 a[48:63], v[184:187], v[24:27], a[48:63]
    v_add_f32 v11, v11, v17
    v_cvt_pk_bf16_f32 v36, v16, v17
    v_exp_f32 v20, v76
    v_add_f32 v11, v11, v18
    v_mfma_f32_32x32x16_bf16 a[48:63], v[188:191], v[28:31], a[48:63]
    v_exp_f32 v21, v77
    v_add_f32 v11, v11, v19
    v_cvt_pk_bf16_f32 v37, v18, v19
    v_exp_f32 v22, v78
    v_mfma_f32_32x32x16_bf16 a[96:111], v[192:195], v[24:27], a[96:111]
    v_add_f32 v11, v11, v20
    v_exp_f32 v23, v79
    v_add_f32 v11, v11, v21
    v_cvt_pk_bf16_f32 v38, v20, v21
    v_mfma_f32_32x32x16_bf16 a[96:111], v[196:199], v[28:31], a[96:111]
    v_add_f32 v11, v11, v22
    v_add_f32 v11, v11, v23
    v_cvt_pk_bf16_f32 v39, v22, v23
    v_cmp_lt_f32 vcc, s39, v11
    s_cbranch_vccnz SLOW1_15
BACK1_15:
    v_add_f32 v9, v9, v11
    v_mfma_f32_32x32x16_bf16 a[144:159], v[200:203], v[24:27], a[144:159]
    v_exp_f32 v16, v80
    v_exp_f32 v17, v81
    v_exp_f32 v18, v82
    v_mfma_f32_32x32x16_bf16 a[144:159], v[204:207], v[28:31], a[144:159]
    v_exp_f32 v19, v83
    v_add_f32 v11, v16, v17
    v_cvt_pk_bf16_f32 v40, v16, v17
    v_exp_f32 v20, v84
    v_mfma_f32_32x32x16_bf16 a[16:31], v[176:179], v[32:35], a[16:31]
    v_add_f32 v11, v11, v18
    v_exp_f32 v21, v85
    v_add_f32 v11, v11, v19
    v_cvt_pk_bf16_f32 v41, v18, v19
    v_exp_f32 v22, v86
    v_mfma_f32_32x32x16_bf16 a[16:31], v[180:183], v[36:39], a[16:31]
    v_add_f32 v11, v11, v20
    v_exp_f32 v23, v87
    v_add_f32 v11, v11, v21
    v_mfma_f32_32x32x16_bf16 a[64:79], v[184:187], v[32:35], a[64:79]
    v_cvt_pk_bf16_f32 v42, v20, v21
    v_exp_f32 v16, v88
    v_add_f32 v11, v11, v22
    v_exp_f32 v17, v89
    v_mfma_f32_32x32x16_bf16 a[64:79], v[188:191], v[36:39], a[64:79]
    v_add_f32 v11, v11, v23
    v_cvt_pk_bf16_f32 v43, v22, v23
    v_exp_f32 v18, v90
    v_add_f32 v11, v11, v16
    v_exp_f32 v19, v91
    v_mfma_f32_32x32x16_bf16 a[112:127], v[192:195], v[32:35], a[112:127]
    v_add_f32 v11, v11, v17
    v_cvt_pk_bf16_f32 v44, v16, v17
    v_exp_f32 v20, v92
    v_add_f32 v11, v11, v18
    v_mfma_f32_32x32x16_bf16 a[112:127], v[196:199], v[36:39], a[112:127]
    v_exp_f32 v21, v93
    v_add_f32 v11, v11, v19
    v_cvt_pk_bf16_f32 v45, v18, v19
    v_exp_f32 v22, v94
    v_mfma_f32_32x32x16_bf16 a[160:175], v[200:203], v[32:35], a[160:175]
    v_add_f32 v11, v11, v20
    v_exp_f32 v23, v95
    v_add_f32 v11, v11, v21
    v_cvt_pk_bf16_f32 v46, v20, v21
    v_mfma_f32_32x32x16_bf16 a[160:175], v[204:207], v[36:39], a[160:175]
    v_add_f32 v11, v11, v22
    v_add_f32 v11, v11, v23
    v_cvt_pk_bf16_f32 v47, v22, v23
    v_cmp_lt_f32 vcc, s39, v11
    s_cbranch_vccnz SLOW2_15
BACK2_15:
    v_add_f32 v10, v10, v11
    v_mfma_f32_32x32x16_bf16 a[32:47], v[176:179], v[40:43], a[32:47]
    v_mfma_f32_32x32x16_bf16 a[32:47], v[180:183], v[44:47], a[32:47]
    v_mfma_f32_32x32x16_bf16 a[80:95], v[184:187], v[40:43], a[80:95]
    v_mfma_f32_32x32x16_bf16 a[80:95], v[188:191], v[44:47], a[80:95]
    v_mfma_f32_32x32x16_bf16 a[128:143], v[192:195], v[40:43], a[128:143]
    v_mfma_f32_32x32x16_bf16 a[128:143], v[196:199], v[44:47], a[128:143]
    v_mfma_f32_32x32x16_bf16 a[176:191], v[200:203], v[40:43], a[176:191]
    v_mfma_f32_32x32x16_bf16 a[176:191], v[204:207], v[44:47], a[176:191]
    s_xor_b32 s31, s31, 0x4000
    s_add_u32 s28, s28, 1
    s_nop 7
    s_nop 7
    s_branch COMBINE
OPROJ:
    v_lshrrev_b32 v21, 4, v0
    v_and_b32 v13, 7, v21
    v_lshlrev_b32 v10, 2, v13
    buffer_load_dword v1, v10, s[92:95], s46 offen sc1
    v_lshrrev_b32 v12, 5, v21
    v_bfe_u32 v13, v21, 2, 2
    v_lshlrev_b32 v14, 3, v12
    v_add_u32 v14, v14, v13
    v_lshlrev_b32 v14, 8, v14
    s_and_b32 s33, s2, 3
    v_xor_b32 v13, s33, v13
    v_lshlrev_b32 v13, 6, v13
    v_add_u32 v14, v14, v13
    v_and_b32 v13, 16, v21
    v_lshlrev_b32 v13, 1, v13
    v_add_u32 v14, v14, v13
    v_and_b32 v13, 1, v21
    v_lshlrev_b32 v13, 4, v13
    v_add_u32 v14, v14, v13
    v_and_b32 v13, 2, v21
    v_lshlrev_b32 v13, 2, v13
    v_add_u32 v2, v14, v13
    v_xor_b32 v3, 64, v2
    v_xor_b32 v4, 128, v2
    v_xor_b32 v5, 192, v2
    v_add_u32 v6, 0x10000, v2
    v_add_u32 v7, 0x10000, v3
    v_add_u32 v8, 0x10000, v4
    v_add_u32 v9, 0x10000, v5
    v_and_b32 v13, 31, v21
    v_mul_u32_u24 v13, 0xa00, v13
    v_lshlrev_b32 v12, 4, v12
    v_add_u32 v11, v12, v13
    v_and_b32 v13, 3, v21
    v_max_u32 v13, 1, v13
    v_xor_b32 v13, s33, v13
    v_lshlrev_b32 v15, 2, v13
    s_add_u32 s4, s92, 8388608
    s_addc_u32 s5, s93, 0
    s_mov_b32 s6, 12582912
    v_accvgpr_write_b32 a0, 0
    v_accvgpr_write_b32 a1, 0
    v_accvgpr_write_b32 a2, 0
    v_accvgpr_write_b32 a3, 0
    v_accvgpr_write_b32 a4, 0
    v_accvgpr_write_b32 a5, 0
    v_accvgpr_write_b32 a6, 0
    v_accvgpr_write_b32 a7, 0
    v_accvgpr_write_b32 a8, 0
    v_accvgpr_write_b32 a9, 0
    v_accvgpr_write_b32 a10, 0
    v_accvgpr_write_b32 a11, 0
    v_accvgpr_write_b32 a12, 0
    v_accvgpr_write_b32 a13, 0
    v_accvgpr_write_b32 a14, 0
    v_accvgpr_write_b32 a15, 0
    v_accvgpr_write_b32 a16, 0
    v_accvgpr_write_b32 a17, 0
    v_accvgpr_write_b32 a18, 0
    v_accvgpr_write_b32 a19, 0
    v_accvgpr_write_b32 a20, 0
    v_accvgpr_write_b32 a21, 0
    v_accvgpr_write_b32 a22, 0
    v_accvgpr_write_b32 a23, 0
    v_accvgpr_write_b32 a24, 0
    v_accvgpr_write_b32 a25, 0
    v_accvgpr_write_b32 a26, 0
    v_accvgpr_write_b32 a27, 0
    v_accvgpr_write_b32 a28, 0
    v_accvgpr_write_b32 a29, 0
    v_accvgpr_write_b32 a30, 0
    v_accvgpr_write_b32 a31, 0
    v_accvgpr_write_b32 a32, 0
    v_accvgpr_write_b32 a33, 0
    v_accvgpr_write_b32 a34, 0
    v_accvgpr_write_b32 a35, 0
    v_accvgpr_write_b32 a36, 0
    v_accvgpr_write_b32 a37, 0
    v_accvgpr_write_b32 a38, 0
    v_accvgpr_write_b32 a39, 0
    v_accvgpr_write_b32 a40, 0
    v_accvgpr_write_b32 a41, 0
    v_accvgpr_write_b32 a42, 0
    v_accvgpr_write_b32 a43, 0
    v_accvgpr_write_b32 a44, 0
    v_accvgpr_write_b32 a45, 0
    v_accvgpr_write_b32 a46, 0
    v_accvgpr_write_b32 a47, 0
    v_accvgpr_write_b32 a48, 0
    v_accvgpr_write_b32 a49, 0
    v_accvgpr_write_b32 a50, 0
    v_accvgpr_write_b32 a51, 0
    v_accvgpr_write_b32 a52, 0
    v_accvgpr_write_b32 a53, 0
    v_accvgpr_write_b32 a54, 0
    v_accvgpr_write_b32 a55, 0
    v_accvgpr_write_b32 a56, 0
    v_accvgpr_write_b32 a57, 0
    v_accvgpr_write_b32 a58, 0
    v_accvgpr_write_b32 a59, 0
    v_accvgpr_write_b32 a60, 0
    v_accvgpr_write_b32 a61, 0
    v_accvgpr_write_b32 a62, 0
    v_accvgpr_write_b32 a63, 0
    s_waitcnt vmcnt(1)
    v_mov_b32 v16, 163328
    v_mov_b32 v17, 1
    s_mov_b64 exec, 1
    ds_add_rtn_u32 v18, v16, v17
    s_waitcnt lgkmcnt(0)
    v_cmp_eq_u32 vcc, 7, v18
    s_cbranch_vccz PUB2
    s_mov_b64 exec, 63
    buffer_store_dword v252, v253, s[92:95], s45 offen sc1
PUB2:
    s_mov_b64 exec, -1
    s_add_u32 s45, s45, 16384
    s_nop 0
    s_cmp_ge_u32 s2, 240
    s_cbranch_scc1 NOTILE
    s_mov_b32 s47, 30000
    s_branch POLLC
POLL:
    s_mov_b32 s34, 8
POLLW:
    s_nop 15
    s_sub_u32 s34, s34, 1
    s_cbranch_scc0 POLLW
POLLB:
    buffer_load_dword v1, v10, s[92:95], s46 offen sc1
    s_sub_u32 s47, s47, 1
    s_cbranch_scc1 POLLD
POLLC:
    s_waitcnt vmcnt(0)
    v_cmp_ne_u32 vcc, s52, v1
    s_cbranch_vccnz POLL
POLLD:
    s_add_u32 s33, s37, s35
    s_and_b32 s33, s33, 15
    s_lshl_b32 s33, s33, 12
    s_add_u32 s42, s40, s33
    s_add_u32 s37, s37, 1
    buffer_load_dwordx4 v[24:27], v0, s[20:23], s42 offen offset:0 sc1
    buffer_load_dwordx4 v[28:31], v0, s[20:23], s42 offen offset:1024 sc1
    buffer_load_dwordx4 v[32:35], v0, s[20:23], s42 offen offset:2048 sc1
    buffer_load_dwordx4 v[36:39], v0, s[20:23], s42 offen offset:3072 sc1
    s_add_u32 s33, s36, s35
    s_and_b32 s33, s33, 15
    s_mul_i32 s41, s33, 81920
    s_add_u32 s41, s41, s38
    s_add_u32 s36, s36, 1
    s_add_u32 m0, s57, 16384
    s_add_u32 s33, s41, 0
    buffer_load_dwordx4 v248, s[12:15], s33 offen lds
    s_add_u32 m0, s57, 17408
    s_add_u32 s33, s41, 5120
    buffer_load_dwordx4 v248, s[12:15], s33 offen lds
    s_add_u32 m0, s57, 18432
    s_add_u32 s33, s41, 10240
    buffer_load_dwordx4 v248, s[12:15], s33 offen lds
    s_add_u32 m0, s57, 19456
    s_add_u32 s33, s41, 15360
    buffer_load_dwordx4 v248, s[12:15], s33 offen lds
    s_add_u32 s33, s37, s35
    s_and_b32 s33, s33, 15
    s_lshl_b32 s33, s33, 12
    s_add_u32 s42, s40, s33
    s_add_u32 s37, s37, 1
    buffer_load_dwordx4 v[40:43], v0, s[20:23], s42 offen offset:0 sc1
    buffer_load_dwordx4 v[44:47], v0, s[20:23], s42 offen offset:1024 sc1
    buffer_load_dwordx4 v[48:51], v0, s[20:23], s42 offen offset:2048 sc1
    buffer_load_dwordx4 v[52:55], v0, s[20:23], s42 offen offset:3072 sc1
    s_add_u32 s33, s36, s35
    s_and_b32 s33, s33, 15
    s_mul_i32 s41, s33, 81920
    s_add_u32 s41, s41, s38
    s_add_u32 s36, s36, 1
    s_add_u32 m0, s57, 20480
    s_add_u32 s33, s41, 0
    buffer_load_dwordx4 v248, s[12:15], s33 offen lds
    s_add_u32 m0, s57, 21504
    s_add_u32 s33, s41, 5120
    buffer_load_dwordx4 v248, s[12:15], s33 offen lds
    s_add_u32 m0, s57, 22528
    s_add_u32 s33, s41, 10240
    buffer_load_dwordx4 v248, s[12:15], s33 offen lds
    s_add_u32 m0, s57, 23552
    s_add_u32 s33, s41, 15360
    buffer_load_dwordx4 v248, s[12:15], s33 offen lds
    s_add_u32 s33, s37, s35
    s_and_b32 s33, s33, 15
    s_lshl_b32 s33, s33, 12
    s_add_u32 s42, s40, s33
    s_add_u32 s37, s37, 1
    buffer_load_dwordx4 v[56:59], v0, s[20:23], s42 offen offset:0 sc1
    buffer_load_dwordx4 v[60:63], v0, s[20:23], s42 offen offset:1024 sc1
    buffer_load_dwordx4 v[64:67], v0, s[20:23], s42 offen offset:2048 sc1
    buffer_load_dwordx4 v[68:71], v0, s[20:23], s42 offen offset:3072 sc1
    s_waitcnt vmcnt(24)
    s_barrier
    ds_read_b64_tr_b16 v[92:93], v3 offset:8192
    ds_read_b64_tr_b16 v[94:95], v3 offset:9216
    ds_read_b64_tr_b16 v[96:97], v4 offset:8192
    ds_read_b64_tr_b16 v[98:99], v4 offset:9216
    ds_read_b64_tr_b16 v[100:101], v5 offset:8192
    ds_read_b64_tr_b16 v[102:103], v5 offset:9216
    ds_read_b64_tr_b16 v[88:89], v2 offset:8192
    ds_read_b64_tr_b16 v[90:91], v2 offset:9216
    ds_read_b64_tr_b16 v[108:109], v3 offset:40960
    ds_read_b64_tr_b16 v[110:111], v3 offset:41984
    ds_read_b64_tr_b16 v[112:113], v4 offset:40960
    ds_read_b64_tr_b16 v[114:115], v4 offset:41984
    ds_read_b64_tr_b16 v[116:117], v5 offset:40960
    ds_read_b64_tr_b16 v[118:119], v5 offset:41984
    ds_read_b64_tr_b16 v[104:105], v2 offset:40960
    ds_read_b64_tr_b16 v[106:107], v2 offset:41984
    ds_read_b64_tr_b16 v[124:125], v7 offset:8192
    ds_read_b64_tr_b16 v[126:127], v7 offset:9216
    ds_read_b64_tr_b16 v[128:129], v8 offset:8192
    ds_read_b64_tr_b16 v[130:131], v8 offset:9216
    ds_read_b64_tr_b16 v[132:133], v9 offset:8192
    ds_read_b64_tr_b16 v[134:135], v9 offset:9216
    ds_read_b64_tr_b16 v[120:121], v6 offset:8192
    ds_read_b64_tr_b16 v[122:123], v6 offset:9216
    ds_read_b64_tr_b16 v[140:141], v7 offset:40960
    ds_read_b64_tr_b16 v[142:143], v7 offset:41984
    ds_read_b64_tr_b16 v[144:145], v8 offset:40960
    ds_read_b64_tr_b16 v[146:147], v8 offset:41984
    ds_read_b64_tr_b16 v[148:149], v9 offset:40960
    ds_read_b64_tr_b16 v[150:151], v9 offset:41984
    ds_read_b64_tr_b16 v[136:137], v6 offset:40960
    ds_read_b64_tr_b16 v[138:139], v6 offset:41984
    s_mov_b32 s47, 0
OP_LOOP:
    s_waitcnt vmcnt(16) lgkmcnt(0)
    s_barrier
    v_mfma_f32_32x32x16_bf16 a[16:31], v[92:95], v[24:27], a[16:31]
    ds_read_b64_tr_b16 v[156:157], v3 offset:12288
    ds_read_b64_tr_b16 v[158:159], v3 offset:13312
    ds_read_b64_tr_b16 v[160:161], v4 offset:12288
    s_add_u32 s33, s36, s35
    s_and_b32 s33, s33, 15
    s_mul_i32 s41, s33, 81920
    s_add_u32 s41, s41, s38
    s_add_u32 s36, s36, 1
    s_add_u32 m0, s57, 8192
    s_add_u32 s33, s41, 0
    buffer_load_dwordx4 v248, s[12:15], s33 offen lds
    v_mfma_f32_32x32x16_bf16 a[32:47], v[96:99], v[24:27], a[32:47]
    ds_read_b64_tr_b16 v[162:163], v4 offset:13312
    ds_read_b64_tr_b16 v[164:165], v5 offset:12288
    ds_read_b64_tr_b16 v[166:167], v5 offset:13312
    v_mfma_f32_32x32x16_bf16 a[48:63], v[100:103], v[24:27], a[48:63]
    ds_read_b64_tr_b16 v[152:153], v2 offset:12288
    ds_read_b64_tr_b16 v[154:155], v2 offset:13312
    s_add_u32 m0, s57, 9216
    s_add_u32 s33, s41, 5120
    buffer_load_dwordx4 v248, s[12:15], s33 offen lds
    v_mfma_f32_32x32x16_bf16 a[0:15], v[88:91], v[24:27], a[0:15]
    ds_read_b64_tr_b16 v[172:173], v3 offset:45056
    ds_read_b64_tr_b16 v[174:175], v3 offset:46080
    ds_read_b64_tr_b16 v[176:177], v4 offset:45056
    v_mfma_f32_32x32x16_bf16 a[16:31], v[108:111], v[28:31], a[16:31]
    ds_read_b64_tr_b16 v[178:179], v4 offset:46080
    ds_read_b64_tr_b16 v[180:181], v5 offset:45056
    ds_read_b64_tr_b16 v[182:183], v5 offset:46080
    s_add_u32 m0, s57, 10240
    s_add_u32 s33, s41, 10240
    buffer_load_dwordx4 v248, s[12:15], s33 offen lds
    v_mfma_f32_32x32x16_bf16 a[32:47], v[112:115], v[28:31], a[32:47]
    ds_read_b64_tr_b16 v[168:169], v2 offset:45056
    ds_read_b64_tr_b16 v[170:171], v2 offset:46080
    v_mfma_f32_32x32x16_bf16 a[48:63], v[116:119], v[28:31], a[48:63]
    ds_read_b64_tr_b16 v[188:189], v7 offset:12288
    ds_read_b64_tr_b16 v[190:191], v7 offset:13312
    ds_read_b64_tr_b16 v[192:193], v8 offset:12288
    s_add_u32 m0, s57, 11264
    s_add_u32 s33, s41, 15360
    buffer_load_dwordx4 v248, s[12:15], s33 offen lds
    v_mfma_f32_32x32x16_bf16 a[0:15], v[104:107], v[28:31], a[0:15]
    ds_read_b64_tr_b16 v[194:195], v8 offset:13312
    ds_read_b64_tr_b16 v[196:197], v9 offset:12288
    ds_read_b64_tr_b16 v[198:199], v9 offset:13312
    v_mfma_f32_32x32x16_bf16 a[16:31], v[124:127], v[32:35], a[16:31]
    ds_read_b64_tr_b16 v[184:185], v6 offset:12288
    ds_read_b64_tr_b16 v[186:187], v6 offset:13312
    s_add_u32 s33, s37, s35
    s_and_b32 s33, s33, 15
    s_lshl_b32 s33, s33, 12
    s_add_u32 s42, s40, s33
    s_add_u32 s37, s37, 1
    buffer_load_dwordx4 v[72:75], v0, s[20:23], s42 offen offset:0 sc1
    v_mfma_f32_32x32x16_bf16 a[32:47], v[128:131], v[32:35], a[32:47]
    ds_read_b64_tr_b16 v[204:205], v7 offset:45056
    ds_read_b64_tr_b16 v[206:207], v7 offset:46080
    ds_read_b64_tr_b16 v[208:209], v8 offset:45056
    v_mfma_f32_32x32x16_bf16 a[48:63], v[132:135], v[32:35], a[48:63]
    ds_read_b64_tr_b16 v[210:211], v8 offset:46080
    ds_read_b64_tr_b16 v[212:213], v9 offset:45056
    ds_read_b64_tr_b16 v[214:215], v9 offset:46080
    buffer_load_dwordx4 v[76:79], v0, s[20:23], s42 offen offset:1024 sc1
    v_mfma_f32_32x32x16_bf16 a[0:15], v[120:123], v[32:35], a[0:15]
    ds_read_b64_tr_b16 v[200:201], v6 offset:45056
    ds_read_b64_tr_b16 v[202:203], v6 offset:46080
    v_mfma_f32_32x32x16_bf16 a[16:31], v[140:143], v[36:39], a[16:31]
    buffer_load_dwordx4 v[80:83], v0, s[20:23], s42 offen offset:2048 sc1
    v_mfma_f32_32x32x16_bf16 a[32:47], v[144:147], v[36:39], a[32:47]
    v_mfma_f32_32x32x16_bf16 a[48:63], v[148:151], v[36:39], a[48:63]
    buffer_load_dwordx4 v[84:87], v0, s[20:23], s42 offen offset:3072 sc1
    v_mfma_f32_32x32x16_bf16 a[0:15], v[136:139], v[36:39], a[0:15]
    s_waitcnt vmcnt(16) lgkmcnt(0)
    s_barrier
    v_mfma_f32_32x32x16_bf16 a[16:31], v[156:159], v[40:43], a[16:31]
    ds_read_b64_tr_b16 v[92:93], v3 offset:16384
    ds_read_b64_tr_b16 v[94:95], v3 offset:17408
    ds_read_b64_tr_b16 v[96:97], v4 offset:16384
    s_add_u32 s33, s36, s35
    s_and_b32 s33, s33, 15
    s_mul_i32 s41, s33, 81920
    s_add_u32 s41, s41, s38
    s_add_u32 s36, s36, 1
    s_add_u32 m0, s57, 12288
    s_add_u32 s33, s41, 0
    buffer_load_dwordx4 v248, s[12:15], s33 offen lds
    v_mfma_f32_32x32x16_bf16 a[32:47], v[160:163], v[40:43], a[32:47]
    ds_read_b64_tr_b16 v[98:99], v4 offset:17408
    ds_read_b64_tr_b16 v[100:101], v5 offset:16384
    ds_read_b64_tr_b16 v[102:103], v5 offset:17408
    v_mfma_f32_32x32x16_bf16 a[48:63], v[164:167], v[40:43], a[48:63]
    ds_read_b64_tr_b16 v[88:89], v2 offset:16384
    ds_read_b64_tr_b16 v[90:91], v2 offset:17408
    s_add_u32 m0, s57, 13312
    s_add_u32 s33, s41, 5120
    buffer_load_dwordx4 v248, s[12:15], s33 offen lds
    v_mfma_f32_32x32x16_bf16 a[0:15], v[152:155], v[40:43], a[0:15]
    ds_read_b64_tr_b16 v[108:109], v3 offset:49152
    ds_read_b64_tr_b16 v[110:111], v3 offset:50176
    ds_read_b64_tr_b16 v[112:113], v4 offset:49152
    v_mfma_f32_32x32x16_bf16 a[16:31], v[172:175], v[44:47], a[16:31]
    ds_read_b64_tr_b16 v[114:115], v4 offset:50176
    ds_read_b64_tr_b16 v[116:117], v5 offset:49152
    ds_read_b64_tr_b16 v[118:119], v5 offset:50176
    s_add_u32 m0, s57, 14336
    s_add_u32 s33, s41, 10240
    buffer_load_dwordx4 v248, s[12:15], s33 offen lds
    v_mfma_f32_32x32x16_bf16 a[32:47], v[176:179], v[44:47], a[32:47]
    ds_read_b64_tr_b16 v[104:105], v2 offset:49152
    ds_read_b64_tr_b16 v[106:107], v2 offset:50176
    v_mfma_f32_32x32x16_bf16 a[48:63], v[180:183], v[44:47], a[48:63]
    ds_read_b64_tr_b16 v[124:125], v7 offset:16384
    ds_read_b64_tr_b16 v[126:127], v7 offset:17408
    ds_read_b64_tr_b16 v[128:129], v8 offset:16384
    s_add_u32 m0, s57, 15360
    s_add_u32 s33, s41, 15360
    buffer_load_dwordx4 v248, s[12:15], s33 offen lds
    v_mfma_f32_32x32x16_bf16 a[0:15], v[168:171], v[44:47], a[0:15]
    ds_read_b64_tr_b16 v[130:131], v8 offset:17408
    ds_read_b64_tr_b16 v[132:133], v9 offset:16384
    ds_read_b64_tr_b16 v[134:135], v9 offset:17408
    v_mfma_f32_32x32x16_bf16 a[16:31], v[188:191], v[48:51], a[16:31]
    ds_read_b64_tr_b16 v[120:121], v6 offset:16384
    ds_read_b64_tr_b16 v[122:123], v6 offset:17408
    s_add_u32 s33, s37, s35
    s_and_b32 s33, s33, 15
    s_lshl_b32 s33, s33, 12
    s_add_u32 s42, s40, s33
    s_add_u32 s37, s37, 1
    buffer_load_dwordx4 v[24:27], v0, s[20:23], s42 offen offset:0 sc1
    v_mfma_f32_32x32x16_bf16 a[32:47], v[192:195], v[48:51], a[32:47]
    ds_read_b64_tr_b16 v[140:141], v7 offset:49152
    ds_read_b64_tr_b16 v[142:143], v7 offset:50176
    ds_read_b64_tr_b16 v[144:145], v8 offset:49152
    v_mfma_f32_32x32x16_bf16 a[48:63], v[196:199], v[48:51], a[48:63]
    ds_read_b64_tr_b16 v[146:147], v8 offset:50176
    ds_read_b64_tr_b16 v[148:149], v9 offset:49152
    ds_read_b64_tr_b16 v[150:151], v9 offset:50176
    buffer_load_dwordx4 v[28:31], v0, s[20:23], s42 offen offset:1024 sc1
    v_mfma_f32_32x32x16_bf16 a[0:15], v[184:187], v[48:51], a[0:15]
    ds_read_b64_tr_b16 v[136:137], v6 offset:49152
    ds_read_b64_tr_b16 v[138:139], v6 offset:50176
    v_mfma_f32_32x32x16_bf16 a[16:31], v[204:207], v[52:55], a[16:31]
    buffer_load_dwordx4 v[32:35], v0, s[20:23], s42 offen offset:2048 sc1
    v_mfma_f32_32x32x16_bf16 a[32:47], v[208:211], v[52:55], a[32:47]
    v_mfma_f32_32x32x16_bf16 a[48:63], v[212:215], v[52:55], a[48:63]
    buffer_load_dwordx4 v[36:39], v0, s[20:23], s42 offen offset:3072 sc1
    v_mfma_f32_32x32x16_bf16 a[0:15], v[200:203], v[52:55], a[0:15]
    s_waitcnt vmcnt(16) lgkmcnt(0)
    s_barrier
    v_mfma_f32_32x32x16_bf16 a[16:31], v[92:95], v[56:59], a[16:31]
    ds_read_b64_tr_b16 v[156:157], v3 offset:20480
    ds_read_b64_tr_b16 v[158:159], v3 offset:21504
    ds_read_b64_tr_b16 v[160:161], v4 offset:20480
    s_add_u32 s33, s36, s35
    s_and_b32 s33, s33, 15
    s_mul_i32 s41, s33, 81920
    s_add_u32 s41, s41, s38
    s_add_u32 s36, s36, 1
    s_add_u32 m0, s57, 16384
    s_add_u32 s33, s41, 0
    buffer_load_dwordx4 v248, s[12:15], s33 offen lds
    v_mfma_f32_32x32x16_bf16 a[32:47], v[96:99], v[56:59], a[32:47]
    ds_read_b64_tr_b16 v[162:163], v4 offset:21504
    ds_read_b64_tr_b16 v[164:165], v5 offset:20480
    ds_read_b64_tr_b16 v[166:167], v5 offset:21504
    v_mfma_f32_32x32x16_bf16 a[48:63], v[100:103], v[56:59], a[48:63]
    ds_read_b64_tr_b16 v[152:153], v2 offset:20480
    ds_read_b64_tr_b16 v[154:155], v2 offset:21504
    s_add_u32 m0, s57, 17408
    s_add_u32 s33, s41, 5120
    buffer_load_dwordx4 v248, s[12:15], s33 offen lds
    v_mfma_f32_32x32x16_bf16 a[0:15], v[88:91], v[56:59], a[0:15]
    ds_read_b64_tr_b16 v[172:173], v3 offset:53248
    ds_read_b64_tr_b16 v[174:175], v3 offset:54272
    ds_read_b64_tr_b16 v[176:177], v4 offset:53248
    v_mfma_f32_32x32x16_bf16 a[16:31], v[108:111], v[60:63], a[16:31]
    ds_read_b64_tr_b16 v[178:179], v4 offset:54272
    ds_read_b64_tr_b16 v[180:181], v5 offset:53248
    ds_read_b64_tr_b16 v[182:183], v5 offset:54272
    s_add_u32 m0, s57, 18432
    s_add_u32 s33, s41, 10240
    buffer_load_dwordx4 v248, s[12:15], s33 offen lds
    v_mfma_f32_32x32x16_bf16 a[32:47], v[112:115], v[60:63], a[32:47]
    ds_read_b64_tr_b16 v[168:169], v2 offset:53248
    ds_read_b64_tr_b16 v[170:171], v2 offset:54272
    v_mfma_f32_32x32x16_bf16 a[48:63], v[116:119], v[60:63], a[48:63]
    ds_read_b64_tr_b16 v[188:189], v7 offset:20480
    ds_read_b64_tr_b16 v[190:191], v7 offset:21504
    ds_read_b64_tr_b16 v[192:193], v8 offset:20480
    s_add_u32 m0, s57, 19456
    s_add_u32 s33, s41, 15360
    buffer_load_dwordx4 v248, s[12:15], s33 offen lds
    v_mfma_f32_32x32x16_bf16 a[0:15], v[104:107], v[60:63], a[0:15]
    ds_read_b64_tr_b16 v[194:195], v8 offset:21504
    ds_read_b64_tr_b16 v[196:197], v9 offset:20480
    ds_read_b64_tr_b16 v[198:199], v9 offset:21504
    v_mfma_f32_32x32x16_bf16 a[16:31], v[124:127], v[64:67], a[16:31]
    ds_read_b64_tr_b16 v[184:185], v6 offset:20480
    ds_read_b64_tr_b16 v[186:187], v6 offset:21504
    s_add_u32 s33, s37, s35
    s_and_b32 s33, s33, 15
    s_lshl_b32 s33, s33, 12
    s_add_u32 s42, s40, s33
    s_add_u32 s37, s37, 1
    buffer_load_dwordx4 v[40:43], v0, s[20:23], s42 offen offset:0 sc1
    v_mfma_f32_32x32x16_bf16 a[32:47], v[128:131], v[64:67], a[32:47]
    ds_read_b64_tr_b16 v[204:205], v7 offset:53248
    ds_read_b64_tr_b16 v[206:207], v7 offset:54272
    ds_read_b64_tr_b16 v[208:209], v8 offset:53248
    v_mfma_f32_32x32x16_bf16 a[48:63], v[132:135], v[64:67], a[48:63]
    ds_read_b64_tr_b16 v[210:211], v8 offset:54272
    ds_read_b64_tr_b16 v[212:213], v9 offset:53248
    ds_read_b64_tr_b16 v[214:215], v9 offset:54272
    buffer_load_dwordx4 v[44:47], v0, s[20:23], s42 offen offset:1024 sc1
    v_mfma_f32_32x32x16_bf16 a[0:15], v[120:123], v[64:67], a[0:15]
    ds_read_b64_tr_b16 v[200:201], v6 offset:53248
    ds_read_b64_tr_b16 v[202:203], v6 offset:54272
    v_mfma_f32_32x32x16_bf16 a[16:31], v[140:143], v[68:71], a[16:31]
    buffer_load_dwordx4 v[48:51], v0, s[20:23], s42 offen offset:2048 sc1
    v_mfma_f32_32x32x16_bf16 a[32:47], v[144:147], v[68:71], a[32:47]
    v_mfma_f32_32x32x16_bf16 a[48:63], v[148:151], v[68:71], a[48:63]
    buffer_load_dwordx4 v[52:55], v0, s[20:23], s42 offen offset:3072 sc1
    v_mfma_f32_32x32x16_bf16 a[0:15], v[136:139], v[68:71], a[0:15]
    s_waitcnt vmcnt(16) lgkmcnt(0)
    s_barrier
    v_mfma_f32_32x32x16_bf16 a[16:31], v[156:159], v[72:75], a[16:31]
    ds_read_b64_tr_b16 v[92:93], v3 offset:8192
    ds_read_b64_tr_b16 v[94:95], v3 offset:9216
    ds_read_b64_tr_b16 v[96:97], v4 offset:8192
    s_add_u32 s33, s36, s35
    s_and_b32 s33, s33, 15
    s_mul_i32 s41, s33, 81920
    s_add_u32 s41, s41, s38
    s_add_u32 s36, s36, 1
    s_add_u32 m0, s57, 20480
    s_add_u32 s33, s41, 0
    buffer_load_dwordx4 v248, s[12:15], s33 offen lds
    v_mfma_f32_32x32x16_bf16 a[32:47], v[160:163], v[72:75], a[32:47]
    ds_read_b64_tr_b16 v[98:99], v4 offset:9216
    ds_read_b64_tr_b16 v[100:101], v5 offset:8192
    ds_read_b64_tr_b16 v[102:103], v5 offset:9216
    v_mfma_f32_32x32x16_bf16 a[48:63], v[164:167], v[72:75], a[48:63]
    ds_read_b64_tr_b16 v[88:89], v2 offset:8192
    ds_read_b64_tr_b16 v[90:91], v2 offset:9216
    s_add_u32 m0, s57, 21504
    s_add_u32 s33, s41, 5120
    buffer_load_dwordx4 v248, s[12:15], s33 offen lds
    v_mfma_f32_32x32x16_bf16 a[0:15], v[152:155], v[72:75], a[0:15]
    ds_read_b64_tr_b16 v[108:109], v3 offset:40960
    ds_read_b64_tr_b16 v[110:111], v3 offset:41984
    ds_read_b64_tr_b16 v[112:113], v4 offset:40960
    v_mfma_f32_32x32x16_bf16 a[16:31], v[172:175], v[76:79], a[16:31]
    ds_read_b64_tr_b16 v[114:115], v4 offset:41984
    ds_read_b64_tr_b16 v[116:117], v5 offset:40960
    ds_read_b64_tr_b16 v[118:119], v5 offset:41984
    s_add_u32 m0, s57, 22528
    s_add_u32 s33, s41, 10240
    buffer_load_dwordx4 v248, s[12:15], s33 offen lds
    v_mfma_f32_32x32x16_bf16 a[32:47], v[176:179], v[76:79], a[32:47]
    ds_read_b64_tr_b16 v[104:105], v2 offset:40960
    ds_read_b64_tr_b16 v[106:107], v2 offset:41984
    v_mfma_f32_32x32x16_bf16 a[48:63], v[180:183], v[76:79], a[48:63]
    ds_read_b64_tr_b16 v[124:125], v7 offset:8192
    ds_read_b64_tr_b16 v[126:127], v7 offset:9216
    ds_read_b64_tr_b16 v[128:129], v8 offset:8192
    s_add_u32 m0, s57, 23552
    s_add_u32 s33, s41, 15360
    buffer_load_dwordx4 v248, s[12:15], s33 offen lds
    v_mfma_f32_32x32x16_bf16 a[0:15], v[168:171], v[76:79], a[0:15]
    ds_read_b64_tr_b16 v[130:131], v8 offset:9216
    ds_read_b64_tr_b16 v[132:133], v9 offset:8192
    ds_read_b64_tr_b16 v[134:135], v9 offset:9216
    v_mfma_f32_32x32x16_bf16 a[16:31], v[188:191], v[80:83], a[16:31]
    ds_read_b64_tr_b16 v[120:121], v6 offset:8192
    ds_read_b64_tr_b16 v[122:123], v6 offset:9216
    s_add_u32 s33, s37, s35
    s_and_b32 s33, s33, 15
    s_lshl_b32 s33, s33, 12
    s_add_u32 s42, s40, s33
    s_add_u32 s37, s37, 1
    buffer_load_dwordx4 v[56:59], v0, s[20:23], s42 offen offset:0 sc1
    v_mfma_f32_32x32x16_bf16 a[32:47], v[192:195], v[80:83], a[32:47]
    ds_read_b64_tr_b16 v[140:141], v7 offset:40960
    ds_read_b64_tr_b16 v[142:143], v7 offset:41984
    ds_read_b64_tr_b16 v[144:145], v8 offset:40960
    v_mfma_f32_32x32x16_bf16 a[48:63], v[196:199], v[80:83], a[48:63]
    ds_read_b64_tr_b16 v[146:147], v8 offset:41984
    ds_read_b64_tr_b16 v[148:149], v9 offset:40960
    ds_read_b64_tr_b16 v[150:151], v9 offset:41984
    buffer_load_dwordx4 v[60:63], v0, s[20:23], s42 offen offset:1024 sc1
    v_mfma_f32_32x32x16_bf16 a[0:15], v[184:187], v[80:83], a[0:15]
    ds_read_b64_tr_b16 v[136:137], v6 offset:40960
    ds_read_b64_tr_b16 v[138:139], v6 offset:41984
    v_mfma_f32_32x32x16_bf16 a[16:31], v[204:207], v[84:87], a[16:31]
    buffer_load_dwordx4 v[64:67], v0, s[20:23], s42 offen offset:2048 sc1
    v_mfma_f32_32x32x16_bf16 a[32:47], v[208:211], v[84:87], a[32:47]
    v_mfma_f32_32x32x16_bf16 a[48:63], v[212:215], v[84:87], a[48:63]
    buffer_load_dwordx4 v[68:71], v0, s[20:23], s42 offen offset:3072 sc1
    v_mfma_f32_32x32x16_bf16 a[0:15], v[200:203], v[84:87], a[0:15]
    s_add_u32 s47, s47, 1
    s_cmp_lt_u32 s47, 3
    s_cbranch_scc1 OP_LOOP
    s_waitcnt vmcnt(16) lgkmcnt(0)
    s_barrier
    v_mfma_f32_32x32x16_bf16 a[16:31], v[92:95], v[24:27], a[16:31]
    ds_read_b64_tr_b16 v[156:157], v3 offset:12288
    ds_read_b64_tr_b16 v[158:159], v3 offset:13312
    ds_read_b64_tr_b16 v[160:161], v4 offset:12288
    s_add_u32 s33, s37, s35
    s_and_b32 s33, s33, 15
    s_lshl_b32 s33, s33, 12
    s_add_u32 s42, s40, s33
    s_add_u32 s37, s37, 1
    buffer_load_dwordx4 v[72:75], v0, s[20:23], s42 offen offset:0 sc1
    v_mfma_f32_32x32x16_bf16 a[32:47], v[96:99], v[24:27], a[32:47]
    ds_read_b64_tr_b16 v[162:163], v4 offset:13312
    ds_read_b64_tr_b16 v[164:165], v5 offset:12288
    ds_read_b64_tr_b16 v[166:167], v5 offset:13312
    v_mfma_f32_32x32x16_bf16 a[48:63], v[100:103], v[24:27], a[48:63]
    ds_read_b64_tr_b16 v[152:153], v2 offset:12288
    ds_read_b64_tr_b16 v[154:155], v2 offset:13312
    v_mfma_f32_32x32x16_bf16 a[0:15], v[88:91], v[24:27], a[0:15]
    ds_read_b64_tr_b16 v[172:173], v3 offset:45056
    ds_read_b64_tr_b16 v[174:175], v3 offset:46080
    ds_read_b64_tr_b16 v[176:177], v4 offset:45056
    v_mfma_f32_32x32x16_bf16 a[16:31], v[108:111], v[28:31], a[16:31]
    ds_read_b64_tr_b16 v[178:179], v4 offset:46080
    ds_read_b64_tr_b16 v[180:181], v5 offset:45056
    ds_read_b64_tr_b16 v[182:183], v5 offset:46080
    buffer_load_dwordx4 v[76:79], v0, s[20:23], s42 offen offset:1024 sc1
    v_mfma_f32_32x32x16_bf16 a[32:47], v[112:115], v[28:31], a[32:47]
    ds_read_b64_tr_b16 v[168:169], v2 offset:45056
    ds_read_b64_tr_b16 v[170:171], v2 offset:46080
    v_mfma_f32_32x32x16_bf16 a[48:63], v[116:119], v[28:31], a[48:63]
    ds_read_b64_tr_b16 v[188:189], v7 offset:12288
    ds_read_b64_tr_b16 v[190:191], v7 offset:13312
    ds_read_b64_tr_b16 v[192:193], v8 offset:12288
    v_mfma_f32_32x32x16_bf16 a[0:15], v[104:107], v[28:31], a[0:15]
    ds_read_b64_tr_b16 v[194:195], v8 offset:13312
    ds_read_b64_tr_b16 v[196:197], v9 offset:12288
    ds_read_b64_tr_b16 v[198:199], v9 offset:13312
    v_mfma_f32_32x32x16_bf16 a[16:31], v[124:127], v[32:35], a[16:31]
    ds_read_b64_tr_b16 v[184:185], v6 offset:12288
    ds_read_b64_tr_b16 v[186:187], v6 offset:13312
    buffer_load_dwordx4 v[80:83], v0, s[20:23], s42 offen offset:2048 sc1
    v_mfma_f32_32x32x16_bf16 a[32:47], v[128:131], v[32:35], a[32:47]
    ds_read_b64_tr_b16 v[204:205], v7 offset:45056
    ds_read_b64_tr_b16 v[206:207], v7 offset:46080
    ds_read_b64_tr_b16 v[208:209], v8 offset:45056
    v_mfma_f32_32x32x16_bf16 a[48:63], v[132:135], v[32:35], a[48:63]
    ds_read_b64_tr_b16 v[210:211], v8 offset:46080
    ds_read_b64_tr_b16 v[212:213], v9 offset:45056
    ds_read_b64_tr_b16 v[214:215], v9 offset:46080
    v_mfma_f32_32x32x16_bf16 a[0:15], v[120:123], v[32:35], a[0:15]
    ds_read_b64_tr_b16 v[200:201], v6 offset:45056
    ds_read_b64_tr_b16 v[202:203], v6 offset:46080
    v_mfma_f32_32x32x16_bf16 a[16:31], v[140:143], v[36:39], a[16:31]
    buffer_load_dwordx4 v[84:87], v0, s[20:23], s42 offen offset:3072 sc1
    v_mfma_f32_32x32x16_bf16 a[32:47], v[144:147], v[36:39], a[32:47]
    v_mfma_f32_32x32x16_bf16 a[48:63], v[148:151], v[36:39], a[48:63]
    v_mfma_f32_32x32x16_bf16 a[0:15], v[136:139], v[36:39], a[0:15]
    s_waitcnt vmcnt(12) lgkmcnt(0)
    s_barrier
    v_mfma_f32_32x32x16_bf16 a[16:31], v[156:159], v[40:43], a[16:31]
    ds_read_b64_tr_b16 v[92:93], v3 offset:16384
    ds_read_b64_tr_b16 v[94:95], v3 offset:17408
    ds_read_b64_tr_b16 v[96:97], v4 offset:16384
    v_mfma_f32_32x32x16_bf16 a[32:47], v[160:163], v[40:43], a[32:47]
    ds_read_b64_tr_b16 v[98:99], v4 offset:17408
    ds_read_b64_tr_b16 v[100:101], v5 offset:16384
    ds_read_b64_tr_b16 v[102:103], v5 offset:17408
    v_mfma_f32_32x32x16_bf16 a[48:63], v[164:167], v[40:43], a[48:63]
    ds_read_b64_tr_b16 v[88:89], v2 offset:16384
    ds_read_b64_tr_b16 v[90:91], v2 offset:17408
    v_mfma_f32_32x32x16_bf16 a[0:15], v[152:155], v[40:43], a[0:15]
    ds_read_b64_tr_b16 v[108:109], v3 offset:49152
    ds_read_b64_tr_b16 v[110:111], v3 offset:50176
    ds_read_b64_tr_b16 v[112:113], v4 offset:49152
    v_mfma_f32_32x32x16_bf16 a[16:31], v[172:175], v[44:47], a[16:31]
    ds_read_b64_tr_b16 v[114:115], v4 offset:50176
    ds_read_b64_tr_b16 v[116:117], v5 offset:49152
    ds_read_b64_tr_b16 v[118:119], v5 offset:50176
    v_mfma_f32_32x32x16_bf16 a[32:47], v[176:179], v[44:47], a[32:47]
    ds_read_b64_tr_b16 v[104:105], v2 offset:49152
    ds_read_b64_tr_b16 v[106:107], v2 offset:50176
    v_mfma_f32_32x32x16_bf16 a[48:63], v[180:183], v[44:47], a[48:63]
    ds_read_b64_tr_b16 v[124:125], v7 offset:16384
    ds_read_b64_tr_b16 v[126:127], v7 offset:17408
    ds_read_b64_tr_b16 v[128:129], v8 offset:16384
    v_mfma_f32_32x32x16_bf16 a[0:15], v[168:171], v[44:47], a[0:15]
    ds_read_b64_tr_b16 v[130:131], v8 offset:17408
    ds_read_b64_tr_b16 v[132:133], v9 offset:16384
    ds_read_b64_tr_b16 v[134:135], v9 offset:17408
    v_mfma_f32_32x32x16_bf16 a[16:31], v[188:191], v[48:51], a[16:31]
    ds_read_b64_tr_b16 v[120:121], v6 offset:16384
    ds_read_b64_tr_b16 v[122:123], v6 offset:17408
    v_mfma_f32_32x32x16_bf16 a[32:47], v[192:195], v[48:51], a[32:47]
    ds_read_b64_tr_b16 v[140:141], v7 offset:49152
    ds_read_b64_tr_b16 v[142:143], v7 offset:50176
    ds_read_b64_tr_b16 v[144:145], v8 offset:49152
    v_mfma_f32_32x32x16_bf16 a[48:63], v[196:199], v[48:51], a[48:63]
    ds_read_b64_tr_b16 v[146:147], v8 offset:50176
    ds_read_b64_tr_b16 v[148:149], v9 offset:49152
    ds_read_b64_tr_b16 v[150:151], v9 offset:50176
    v_mfma_f32_32x32x16_bf16 a[0:15], v[184:187], v[48:51], a[0:15]
    ds_read_b64_tr_b16 v[136:137], v6 offset:49152
    ds_read_b64_tr_b16 v[138:139], v6 offset:50176
    v_mfma_f32_32x32x16_bf16 a[16:31], v[204:207], v[52:55], a[16:31]
    v_mfma_f32_32x32x16_bf16 a[32:47], v[208:211], v[52:55], a[32:47]
    v_mfma_f32_32x32x16_bf16 a[48:63], v[212:215], v[52:55], a[48:63]
    v_mfma_f32_32x32x16_bf16 a[0:15], v[200:203], v[52:55], a[0:15]
    s_waitcnt vmcnt(4) lgkmcnt(0)
    s_barrier
    v_mfma_f32_32x32x16_bf16 a[16:31], v[92:95], v[56:59], a[16:31]
    ds_read_b64_tr_b16 v[156:157], v3 offset:20480
    ds_read_b64_tr_b16 v[158:159], v3 offset:21504
    ds_read_b64_tr_b16 v[160:161], v4 offset:20480
    v_mfma_f32_32x32x16_bf16 a[32:47], v[96:99], v[56:59], a[32:47]
    ds_read_b64_tr_b16 v[162:163], v4 offset:21504
    ds_read_b64_tr_b16 v[164:165], v5 offset:20480
    ds_read_b64_tr_b16 v[166:167], v5 offset:21504
    v_mfma_f32_32x32x16_bf16 a[48:63], v[100:103], v[56:59], a[48:63]
    ds_read_b64_tr_b16 v[152:153], v2 offset:20480
    ds_read_b64_tr_b16 v[154:155], v2 offset:21504
    v_mfma_f32_32x32x16_bf16 a[0:15], v[88:91], v[56:59], a[0:15]
    ds_read_b64_tr_b16 v[172:173], v3 offset:53248
    ds_read_b64_tr_b16 v[174:175], v3 offset:54272
    ds_read_b64_tr_b16 v[176:177], v4 offset:53248
    v_mfma_f32_32x32x16_bf16 a[16:31], v[108:111], v[60:63], a[16:31]
    ds_read_b64_tr_b16 v[178:179], v4 offset:54272
    ds_read_b64_tr_b16 v[180:181], v5 offset:53248
    ds_read_b64_tr_b16 v[182:183], v5 offset:54272
    v_mfma_f32_32x32x16_bf16 a[32:47], v[112:115], v[60:63], a[32:47]
    ds_read_b64_tr_b16 v[168:169], v2 offset:53248
    ds_read_b64_tr_b16 v[170:171], v2 offset:54272
    v_mfma_f32_32x32x16_bf16 a[48:63], v[116:119], v[60:63], a[48:63]
    ds_read_b64_tr_b16 v[188:189], v7 offset:20480
    ds_read_b64_tr_b16 v[190:191], v7 offset:21504
    ds_read_b64_tr_b16 v[192:193], v8 offset:20480
    v_mfma_f32_32x32x16_bf16 a[0:15], v[104:107], v[60:63], a[0:15]
    ds_read_b64_tr_b16 v[194:195], v8 offset:21504
    ds_read_b64_tr_b16 v[196:197], v9 offset:20480
    ds_read_b64_tr_b16 v[198:199], v9 offset:21504
    v_mfma_f32_32x32x16_bf16 a[16:31], v[124:127], v[64:67], a[16:31]
    ds_read_b64_tr_b16 v[184:185], v6 offset:20480
    ds_read_b64_tr_b16 v[186:187], v6 offset:21504
    v_mfma_f32_32x32x16_bf16 a[32:47], v[128:131], v[64:67], a[32:47]
    ds_read_b64_tr_b16 v[204:205], v7 offset:53248
    ds_read_b64_tr_b16 v[206:207], v7 offset:54272
    ds_read_b64_tr_b16 v[208:209], v8 offset:53248
    v_mfma_f32_32x32x16_bf16 a[48:63], v[132:135], v[64:67], a[48:63]
    ds_read_b64_tr_b16 v[210:211], v8 offset:54272
    ds_read_b64_tr_b16 v[212:213], v9 offset:53248
    ds_read_b64_tr_b16 v[214:215], v9 offset:54272
    v_mfma_f32_32x32x16_bf16 a[0:15], v[120:123], v[64:67], a[0:15]
    ds_read_b64_tr_b16 v[200:201], v6 offset:53248
    ds_read_b64_tr_b16 v[202:203], v6 offset:54272
    v_mfma_f32_32x32x16_bf16 a[16:31], v[140:143], v[68:71], a[16:31]
    v_mfma_f32_32x32x16_bf16 a[32:47], v[144:147], v[68:71], a[32:47]
    v_mfma_f32_32x32x16_bf16 a[48:63], v[148:151], v[68:71], a[48:63]
    v_mfma_f32_32x32x16_bf16 a[0:15], v[136:139], v[68:71], a[0:15]
    s_waitcnt vmcnt(0) lgkmcnt(0)
    v_mfma_f32_32x32x16_bf16 a[16:31], v[156:159], v[72:75], a[16:31]
    v_mfma_f32_32x32x16_bf16 a[32:47], v[160:163], v[72:75], a[32:47]
    v_mfma_f32_32x32x16_bf16 a[48:63], v[164:167], v[72:75], a[48:63]
    v_mfma_f32_32x32x16_bf16 a[0:15], v[152:155], v[72:75], a[0:15]
    v_mfma_f32_32x32x16_bf16 a[16:31], v[172:175], v[76:79], a[16:31]
    v_mfma_f32_32x32x16_bf16 a[32:47], v[176:179], v[76:79], a[32:47]
    v_mfma_f32_32x32x16_bf16 a[48:63], v[180:183], v[76:79], a[48:63]
    v_mfma_f32_32x32x16_bf16 a[0:15], v[168:171], v[76:79], a[0:15]
    v_mfma_f32_32x32x16_bf16 a[16:31], v[188:191], v[80:83], a[16:31]
    v_mfma_f32_32x32x16_bf16 a[32:47], v[192:195], v[80:83], a[32:47]
    v_mfma_f32_32x32x16_bf16 a[48:63], v[196:199], v[80:83], a[48:63]
    v_mfma_f32_32x32x16_bf16 a[0:15], v[184:187], v[80:83], a[0:15]
    v_mfma_f32_32x32x16_bf16 a[16:31], v[204:207], v[84:87], a[16:31]
    v_mfma_f32_32x32x16_bf16 a[32:47], v[208:211], v[84:87], a[32:47]
    v_mfma_f32_32x32x16_bf16 a[48:63], v[212:215], v[84:87], a[48:63]
    v_mfma_f32_32x32x16_bf16 a[0:15], v[200:203], v[84:87], a[0:15]
    s_and_b32 s3, s2, 3
    s_xor_b32 s33, s3, 1
    s_mul_i32 s33, s33, 49152
    s_add_u32 s33, s33, s55
    s_add_u32 s33, s33, 0
    v_accvgpr_read_b32 v104, a16
    v_accvgpr_read_b32 v105, a17
    v_accvgpr_read_b32 v106, a18
    v_accvgpr_read_b32 v107, a19
    v_accvgpr_read_b32 v108, a20
    v_accvgpr_read_b32 v109, a21
    v_accvgpr_read_b32 v110, a22
    v_accvgpr_read_b32 v111, a23
    v_accvgpr_read_b32 v112, a24
    v_accvgpr_read_b32 v113, a25
    v_accvgpr_read_b32 v114, a26
    v_accvgpr_read_b32 v115, a27
    v_accvgpr_read_b32 v116, a28
    v_accvgpr_read_b32 v117, a29
    v_accvgpr_read_b32 v118, a30
    v_accvgpr_read_b32 v119, a31
    v_cvt_pk_bf16_f32 v104, v104, v105
    v_cvt_pk_bf16_f32 v105, v106, v107
    v_cvt_pk_bf16_f32 v106, v108, v109
    v_cvt_pk_bf16_f32 v107, v110, v111
    v_cvt_pk_bf16_f32 v108, v112, v113
    v_cvt_pk_bf16_f32 v109, v114, v115
    v_cvt_pk_bf16_f32 v110, v116, v117
    v_cvt_pk_bf16_f32 v111, v118, v119
    buffer_store_dwordx4 v[104:107], v0, s[4:7], s33 offen offset:0 sc1
    buffer_store_dwordx4 v[108:111], v0, s[4:7], s33 offen offset:1024 sc1
    s_xor_b32 s33, s3, 2
    s_mul_i32 s33, s33, 49152
    s_add_u32 s33, s33, s55
    s_add_u32 s33, s33, 16384
    v_accvgpr_read_b32 v120, a32
    v_accvgpr_read_b32 v121, a33
    v_accvgpr_read_b32 v122, a34
    v_accvgpr_read_b32 v123, a35
    v_accvgpr_read_b32 v124, a36
    v_accvgpr_read_b32 v125, a37
    v_accvgpr_read_b32 v126, a38
    v_accvgpr_read_b32 v127, a39
    v_accvgpr_read_b32 v128, a40
    v_accvgpr_read_b32 v129, a41
    v_accvgpr_read_b32 v130, a42
    v_accvgpr_read_b32 v131, a43
    v_accvgpr_read_b32 v132, a44
    v_accvgpr_read_b32 v133, a45
    v_accvgpr_read_b32 v134, a46
    v_accvgpr_read_b32 v135, a47
    v_cvt_pk_bf16_f32 v120, v120, v121
    v_cvt_pk_bf16_f32 v121, v122, v123
    v_cvt_pk_bf16_f32 v122, v124, v125
    v_cvt_pk_bf16_f32 v123, v126, v127
    v_cvt_pk_bf16_f32 v124, v128, v129
    v_cvt_pk_bf16_f32 v125, v130, v131
    v_cvt_pk_bf16_f32 v126, v132, v133
    v_cvt_pk_bf16_f32 v127, v134, v135
    buffer_store_dwordx4 v[120:123], v0, s[4:7], s33 offen offset:0 sc1
    buffer_store_dwordx4 v[124:127], v0, s[4:7], s33 offen offset:1024 sc1
    s_xor_b32 s33, s3, 3
    s_mul_i32 s33, s33, 49152
    s_add_u32 s33, s33, s55
    s_add_u32 s33, s33, 32768
    v_accvgpr_read_b32 v136, a48
    v_accvgpr_read_b32 v137, a49
    v_accvgpr_read_b32 v138, a50
    v_accvgpr_read_b32 v139, a51
    v_accvgpr_read_b32 v140, a52
    v_accvgpr_read_b32 v141, a53
    v_accvgpr_read_b32 v142, a54
    v_accvgpr_read_b32 v143, a55
    v_accvgpr_read_b32 v144, a56
    v_accvgpr_read_b32 v145, a57
    v_accvgpr_read_b32 v146, a58
    v_accvgpr_read_b32 v147, a59
    v_accvgpr_read_b32 v148, a60
    v_accvgpr_read_b32 v149, a61
    v_accvgpr_read_b32 v150, a62
    v_accvgpr_read_b32 v151, a63
    v_cvt_pk_bf16_f32 v136, v136, v137
    v_cvt_pk_bf16_f32 v137, v138, v139
    v_cvt_pk_bf16_f32 v138, v140, v141
    v_cvt_pk_bf16_f32 v139, v142, v143
    v_cvt_pk_bf16_f32 v140, v144, v145
    v_cvt_pk_bf16_f32 v141, v146, v147
    v_cvt_pk_bf16_f32 v142, v148, v149
    v_cvt_pk_bf16_f32 v143, v150, v151
    buffer_store_dwordx4 v[136:139], v0, s[4:7], s33 offen offset:0 sc1
    buffer_store_dwordx4 v[140:143], v0, s[4:7], s33 offen offset:1024 sc1
    s_mul_i32 s46, s3, 124
    s_add_u32 s46, s46, s54
    s_mul_i32 s3, s3, 49152
    s_add_u32 s55, s55, s3
    buffer_load_dword v1, v15, s[92:95], s46 offen sc1
    s_waitcnt vmcnt(1)
    s_mov_b64 exec, 15
    buffer_store_dword v252, v253, s[92:95], s54 offen sc1
    s_mov_b64 exec, -1
    s_nop 0
    s_waitcnt vmcnt(1)
    v_cmp_ne_u32 vcc, s52, v1
    s_cbranch_vccz POLMD
    s_mov_b32 s47, 30000
    s_branch POLMB
POLM:
POLMB:
    buffer_load_dword v1, v15, s[92:95], s46 offen sc1
    s_sub_u32 s47, s47, 1
    s_cbranch_scc1 POLMD
POLMC:
    s_waitcnt vmcnt(0)
    v_cmp_ne_u32 vcc, s52, v1
    s_cbranch_vccnz POLM
POLMD:
    buffer_load_dwordx4 v[40:43], v0, s[4:7], s55 offen offset:0 sc1
    buffer_load_dwordx4 v[44:47], v0, s[4:7], s55 offen offset:1024 sc1
    s_add_u32 s55, s55, 16384
    buffer_load_dwordx4 v[48:51], v0, s[4:7], s55 offen offset:0 sc1
    buffer_load_dwordx4 v[52:55], v0, s[4:7], s55 offen offset:1024 sc1
    s_add_u32 s55, s55, 16384
    buffer_load_dwordx4 v[56:59], v0, s[4:7], s55 offen offset:0 sc1
    buffer_load_dwordx4 v[60:63], v0, s[4:7], s55 offen offset:1024 sc1
    s_waitcnt vmcnt(5)
    v_mfma_f32_32x32x16_bf16 a[0:15], v[240:243], v[40:43], a[0:15]
    s_waitcnt vmcnt(4)
    v_mfma_f32_32x32x16_bf16 a[0:15], v[244:247], v[44:47], a[0:15]
    s_waitcnt vmcnt(3)
    v_mfma_f32_32x32x16_bf16 a[0:15], v[240:243], v[48:51], a[0:15]
    s_waitcnt vmcnt(2)
    v_mfma_f32_32x32x16_bf16 a[0:15], v[244:247], v[52:55], a[0:15]
    s_waitcnt vmcnt(1)
    v_mfma_f32_32x32x16_bf16 a[0:15], v[240:243], v[56:59], a[0:15]
    s_waitcnt vmcnt(0)
    v_mfma_f32_32x32x16_bf16 a[0:15], v[244:247], v[60:63], a[0:15]
    s_nop 7
    s_nop 3
    v_accvgpr_read_b32 v24, a0
    v_accvgpr_read_b32 v25, a1
    v_accvgpr_read_b32 v26, a2
    v_accvgpr_read_b32 v27, a3
    v_accvgpr_read_b32 v28, a4
    v_accvgpr_read_b32 v29, a5
    v_accvgpr_read_b32 v30, a6
    v_accvgpr_read_b32 v31, a7
    v_accvgpr_read_b32 v32, a8
    v_accvgpr_read_b32 v33, a9
    v_accvgpr_read_b32 v34, a10
    v_accvgpr_read_b32 v35, a11
    v_accvgpr_read_b32 v36, a12
    v_accvgpr_read_b32 v37, a13
    v_accvgpr_read_b32 v38, a14
    v_accvgpr_read_b32 v39, a15
    v_cvt_pk_bf16_f32 v88, v24, v25
    v_cvt_pk_bf16_f32 v89, v26, v27
    v_cvt_pk_bf16_f32 v90, v28, v29
    v_cvt_pk_bf16_f32 v91, v30, v31
    v_cvt_pk_bf16_f32 v92, v32, v33
    v_cvt_pk_bf16_f32 v93, v34, v35
    v_cvt_pk_bf16_f32 v94, v36, v37
    v_cvt_pk_bf16_f32 v95, v38, v39
    buffer_store_dwordx4 v[88:91], v11, s[16:19], s44 offen offset:0
    buffer_store_dwordx4 v[92:95], v11, s[16:19], s44 offen offset:32
    s_branch K1_FIN
NOTILE:
    s_cmp_eq_u32 s2, 255
    s_cbranch_scc0 K1_FIN
    s_cmp_eq_u32 s24, 0
    s_cbranch_scc0 K1_FIN
    s_mov_b32 s47, 30000
    v_lshlrev_b32 v24, 6, v0
GPOLL:
    s_mov_b32 s34, 8
GDW:
    s_nop 15
    s_sub_u32 s34, s34, 1
    s_cbranch_scc0 GDW
    buffer_load_dwordx4 v[16:19], v24, s[92:95], 0 offen offset:640 sc1
    buffer_load_dwordx4 v[20:23], v24, s[92:95], 0 offen offset:656 sc1
    s_sub_u32 s47, s47, 1
    s_cbranch_scc1 GDONE
    s_waitcnt vmcnt(0)
    v_xor_b32 v16, s52, v16
    v_xor_b32 v17, s52, v17
    v_xor_b32 v18, s52, v18
    v_xor_b32 v19, s52, v19
    v_xor_b32 v20, s52, v20
    v_xor_b32 v21, s52, v21
    v_xor_b32 v22, s52, v22
    v_xor_b32 v23, s52, v23
    v_or3_b32 v16, v16, v17, v18
    v_or3_b32 v19, v19, v20, v21
    v_or3_b32 v16, v16, v22, v23
    v_or_b32 v16, v16, v19
    v_cmp_ne_u32 vcc, 0, v16
    s_cbranch_vccnz GPOLL
GDONE:
    s_waitcnt vmcnt(0)
    v_mov_b32 v17, s52
    v_mov_b32 v16, 196608
    s_mov_b64 exec, 1
    buffer_store_dword v17, v16, s[92:95], 0 offen sc1
    s_mov_b64 exec, -1
    s_branch K1_FIN
SLOW0:
    s_nop 7
    s_nop 7
    v_max3_f32 v16, v48, v49, v50
    v_max3_f32 v17, v51, v52, v53
    v_max3_f32 v16, v16, v54, v55
    v_max3_f32 v17, v17, v56, v57
    v_max3_f32 v16, v16, v58, v59
    v_max3_f32 v17, v17, v60, v61
    v_max3_f32 v16, v16, v62, v63
    v_max_f32 v16, v16, v17
    v_mov_b32 v17, v16
    s_nop 1
    v_permlane32_swap_b32 v16, v17
    s_nop 0
    v_max_f32 v16, v16, v17
    v_max_f32 v16, 0, v16
    v_exp_f32 v18, -v16
    v_sub_f32 v17, v96, v16
    v_mov_b32 v96, v17
    v_mov_b32 v97, v17
    v_mov_b32 v98, v17
    v_mov_b32 v99, v17
    v_mov_b32 v100, v17
    v_mov_b32 v101, v17
    v_mov_b32 v102, v17
    v_mov_b32 v103, v17
    v_mov_b32 v104, v17
    v_mov_b32 v105, v17
    v_mov_b32 v106, v17
    v_mov_b32 v107, v17
    v_mov_b32 v108, v17
    v_mov_b32 v109, v17
    v_mov_b32 v110, v17
    v_mov_b32 v111, v17
    v_sub_f32 v48, v48, v16
    v_sub_f32 v49, v49, v16
    v_sub_f32 v50, v50, v16
    v_sub_f32 v51, v51, v16
    v_sub_f32 v52, v52, v16
    v_sub_f32 v53, v53, v16
    v_sub_f32 v54, v54, v16
    v_sub_f32 v55, v55, v16
    v_sub_f32 v56, v56, v16
    v_sub_f32 v57, v57, v16
    v_sub_f32 v58, v58, v16
    v_sub_f32 v59, v59, v16
    v_sub_f32 v60, v60, v16
    v_sub_f32 v61, v61, v16
    v_sub_f32 v62, v62, v16
    v_sub_f32 v63, v63, v16
    v_mul_f32 v8, v8, v18
    v_accvgpr_read_b32 v20, a0
    v_accvgpr_read_b32 v21, a1
    v_accvgpr_read_b32 v22, a2
    v_accvgpr_read_b32 v23, a3
    v_mul_f32 v20, v20, v18
    v_mul_f32 v21, v21, v18
    v_mul_f32 v22, v22, v18
    v_mul_f32 v23, v23, v18
    v_accvgpr_write_b32 a0, v20
    v_accvgpr_write_b32 a1, v21
    v_accvgpr_write_b32 a2, v22
    v_accvgpr_write_b32 a3, v23
    v_accvgpr_read_b32 v20, a4
    v_accvgpr_read_b32 v21, a5
    v_accvgpr_read_b32 v22, a6
    v_accvgpr_read_b32 v23, a7
    v_mul_f32 v20, v20, v18
    v_mul_f32 v21, v21, v18
    v_mul_f32 v22, v22, v18
    v_mul_f32 v23, v23, v18
    v_accvgpr_write_b32 a4, v20
    v_accvgpr_write_b32 a5, v21
    v_accvgpr_write_b32 a6, v22
    v_accvgpr_write_b32 a7, v23
    v_accvgpr_read_b32 v20, a8
    v_accvgpr_read_b32 v21, a9
    v_accvgpr_read_b32 v22, a10
    v_accvgpr_read_b32 v23, a11
    v_mul_f32 v20, v20, v18
    v_mul_f32 v21, v21, v18
    v_mul_f32 v22, v22, v18
    v_mul_f32 v23, v23, v18
    v_accvgpr_write_b32 a8, v20
    v_accvgpr_write_b32 a9, v21
    v_accvgpr_write_b32 a10, v22
    v_accvgpr_write_b32 a11, v23
    v_accvgpr_read_b32 v20, a12
    v_accvgpr_read_b32 v21, a13
    v_accvgpr_read_b32 v22, a14
    v_accvgpr_read_b32 v23, a15
    v_mul_f32 v20, v20, v18
    v_mul_f32 v21, v21, v18
    v_mul_f32 v22, v22, v18
    v_mul_f32 v23, v23, v18
    v_accvgpr_write_b32 a12, v20
    v_accvgpr_write_b32 a13, v21
    v_accvgpr_write_b32 a14, v22
    v_accvgpr_write_b32 a15, v23
    v_accvgpr_read_b32 v20, a48
    v_accvgpr_read_b32 v21, a49
    v_accvgpr_read_b32 v22, a50
    v_accvgpr_read_b32 v23, a51
    v_mul_f32 v20, v20, v18
    v_mul_f32 v21, v21, v18
    v_mul_f32 v22, v22, v18
    v_mul_f32 v23, v23, v18
    v_accvgpr_write_b32 a48, v20
    v_accvgpr_write_b32 a49, v21
    v_accvgpr_write_b32 a50, v22
    v_accvgpr_write_b32 a51, v23
    v_accvgpr_read_b32 v20, a52
    v_accvgpr_read_b32 v21, a53
    v_accvgpr_read_b32 v22, a54
    v_accvgpr_read_b32 v23, a55
    v_mul_f32 v20, v20, v18
    v_mul_f32 v21, v21, v18
    v_mul_f32 v22, v22, v18
    v_mul_f32 v23, v23, v18
    v_accvgpr_write_b32 a52, v20
    v_accvgpr_write_b32 a53, v21
    v_accvgpr_write_b32 a54, v22
    v_accvgpr_write_b32 a55, v23
    v_accvgpr_read_b32 v20, a56
    v_accvgpr_read_b32 v21, a57
    v_accvgpr_read_b32 v22, a58
    v_accvgpr_read_b32 v23, a59
    v_mul_f32 v20, v20, v18
    v_mul_f32 v21, v21, v18
    v_mul_f32 v22, v22, v18
    v_mul_f32 v23, v23, v18
    v_accvgpr_write_b32 a56, v20
    v_accvgpr_write_b32 a57, v21
    v_accvgpr_write_b32 a58, v22
    v_accvgpr_write_b32 a59, v23
    v_accvgpr_read_b32 v20, a60
    v_accvgpr_read_b32 v21, a61
    v_accvgpr_read_b32 v22, a62
    v_accvgpr_read_b32 v23, a63
    v_mul_f32 v20, v20, v18
    v_mul_f32 v21, v21, v18
    v_mul_f32 v22, v22, v18
    v_mul_f32 v23, v23, v18
    v_accvgpr_write_b32 a60, v20
    v_accvgpr_write_b32 a61, v21
    v_accvgpr_write_b32 a62, v22
    v_accvgpr_write_b32 a63, v23
    v_accvgpr_read_b32 v20, a96
    v_accvgpr_read_b32 v21, a97
    v_accvgpr_read_b32 v22, a98
    v_accvgpr_read_b32 v23, a99
    v_mul_f32 v20, v20, v18
    v_mul_f32 v21, v21, v18
    v_mul_f32 v22, v22, v18
    v_mul_f32 v23, v23, v18
    v_accvgpr_write_b32 a96, v20
    v_accvgpr_write_b32 a97, v21
    v_accvgpr_write_b32 a98, v22
    v_accvgpr_write_b32 a99, v23
    v_accvgpr_read_b32 v20, a100
    v_accvgpr_read_b32 v21, a101
    v_accvgpr_read_b32 v22, a102
    v_accvgpr_read_b32 v23, a103
    v_mul_f32 v20, v20, v18
    v_mul_f32 v21, v21, v18
    v_mul_f32 v22, v22, v18
    v_mul_f32 v23, v23, v18
    v_accvgpr_write_b32 a100, v20
    v_accvgpr_write_b32 a101, v21
    v_accvgpr_write_b32 a102, v22
    v_accvgpr_write_b32 a103, v23
    v_accvgpr_read_b32 v20, a104
    v_accvgpr_read_b32 v21, a105
    v_accvgpr_read_b32 v22, a106
    v_accvgpr_read_b32 v23, a107
    v_mul_f32 v20, v20, v18
    v_mul_f32 v21, v21, v18
    v_mul_f32 v22, v22, v18
    v_mul_f32 v23, v23, v18
    v_accvgpr_write_b32 a104, v20
    v_accvgpr_write_b32 a105, v21
    v_accvgpr_write_b32 a106, v22
    v_accvgpr_write_b32 a107, v23
    v_accvgpr_read_b32 v20, a108
    v_accvgpr_read_b32 v21, a109
    v_accvgpr_read_b32 v22, a110
    v_accvgpr_read_b32 v23, a111
    v_mul_f32 v20, v20, v18
    v_mul_f32 v21, v21, v18
    v_mul_f32 v22, v22, v18
    v_mul_f32 v23, v23, v18
    v_accvgpr_write_b32 a108, v20
    v_accvgpr_write_b32 a109, v21
    v_accvgpr_write_b32 a110, v22
    v_accvgpr_write_b32 a111, v23
    v_accvgpr_read_b32 v20, a144
    v_accvgpr_read_b32 v21, a145
    v_accvgpr_read_b32 v22, a146
    v_accvgpr_read_b32 v23, a147
    v_mul_f32 v20, v20, v18
    v_mul_f32 v21, v21, v18
    v_mul_f32 v22, v22, v18
    v_mul_f32 v23, v23, v18
    v_accvgpr_write_b32 a144, v20
    v_accvgpr_write_b32 a145, v21
    v_accvgpr_write_b32 a146, v22
    v_accvgpr_write_b32 a147, v23
    v_accvgpr_read_b32 v20, a148
    v_accvgpr_read_b32 v21, a149
    v_accvgpr_read_b32 v22, a150
    v_accvgpr_read_b32 v23, a151
    v_mul_f32 v20, v20, v18
    v_mul_f32 v21, v21, v18
    v_mul_f32 v22, v22, v18
    v_mul_f32 v23, v23, v18
    v_accvgpr_write_b32 a148, v20
    v_accvgpr_write_b32 a149, v21
    v_accvgpr_write_b32 a150, v22
    v_accvgpr_write_b32 a151, v23
    v_accvgpr_read_b32 v20, a152
    v_accvgpr_read_b32 v21, a153
    v_accvgpr_read_b32 v22, a154
    v_accvgpr_read_b32 v23, a155
    v_mul_f32 v20, v20, v18
    v_mul_f32 v21, v21, v18
    v_mul_f32 v22, v22, v18
    v_mul_f32 v23, v23, v18
    v_accvgpr_write_b32 a152, v20
    v_accvgpr_write_b32 a153, v21
    v_accvgpr_write_b32 a154, v22
    v_accvgpr_write_b32 a155, v23
    v_accvgpr_read_b32 v20, a156
    v_accvgpr_read_b32 v21, a157
    v_accvgpr_read_b32 v22, a158
    v_accvgpr_read_b32 v23, a159
    v_mul_f32 v20, v20, v18
    v_mul_f32 v21, v21, v18
    v_mul_f32 v22, v22, v18
    v_mul_f32 v23, v23, v18
    v_accvgpr_write_b32 a156, v20
    v_accvgpr_write_b32 a157, v21
    v_accvgpr_write_b32 a158, v22
    v_accvgpr_write_b32 a159, v23
    v_exp_f32 v16, v48
    v_exp_f32 v17, v49
    v_exp_f32 v18, v50
    v_exp_f32 v19, v51
    v_add_f32 v11, v16, v17
    v_cvt_pk_bf16_f32 v24, v16, v17
    v_exp_f32 v20, v52
    v_add_f32 v11, v11, v18
    v_exp_f32 v21, v53
    v_add_f32 v11, v11, v19
    v_cvt_pk_bf16_f32 v25, v18, v19
    v_exp_f32 v22, v54
    v_add_f32 v11, v11, v20
    v_exp_f32 v23, v55
    v_add_f32 v11, v11, v21
    v_cvt_pk_bf16_f32 v26, v20, v21
    v_exp_f32 v16, v56
    v_add_f32 v11, v11, v22
    v_exp_f32 v17, v57
    v_add_f32 v11, v11, v23
    v_cvt_pk_bf16_f32 v27, v22, v23
    v_exp_f32 v18, v58
    v_add_f32 v11, v11, v16
    v_exp_f32 v19, v59
    v_add_f32 v11, v11, v17
    v_cvt_pk_bf16_f32 v28, v16, v17
    v_exp_f32 v20, v60
    v_add_f32 v11, v11, v18
    v_exp_f32 v21, v61
    v_add_f32 v11, v11, v19
    v_cvt_pk_bf16_f32 v29, v18, v19
    v_exp_f32 v22, v62
    v_add_f32 v11, v11, v20
    v_exp_f32 v23, v63
    v_add_f32 v11, v11, v21
    v_cvt_pk_bf16_f32 v30, v20, v21
    v_add_f32 v11, v11, v22
    v_add_f32 v11, v11, v23
    v_cvt_pk_bf16_f32 v31, v22, v23
    s_nop 3
    s_branch BACK0
SLOW1:
    s_nop 7
    s_nop 7
    v_max3_f32 v16, v64, v65, v66
    v_max3_f32 v17, v67, v68, v69
    v_max3_f32 v16, v16, v70, v71
    v_max3_f32 v17, v17, v72, v73
    v_max3_f32 v16, v16, v74, v75
    v_max3_f32 v17, v17, v76, v77
    v_max3_f32 v16, v16, v78, v79
    v_max_f32 v16, v16, v17
    v_mov_b32 v17, v16
    s_nop 1
    v_permlane32_swap_b32 v16, v17
    s_nop 0
    v_max_f32 v16, v16, v17
    v_max_f32 v16, 0, v16
    v_exp_f32 v18, -v16
    v_sub_f32 v17, v112, v16
    v_mov_b32 v112, v17
    v_mov_b32 v113, v17
    v_mov_b32 v114, v17
    v_mov_b32 v115, v17
    v_mov_b32 v116, v17
    v_mov_b32 v117, v17
    v_mov_b32 v118, v17
    v_mov_b32 v119, v17
    v_mov_b32 v120, v17
    v_mov_b32 v121, v17
    v_mov_b32 v122, v17
    v_mov_b32 v123, v17
    v_mov_b32 v124, v17
    v_mov_b32 v125, v17
    v_mov_b32 v126, v17
    v_mov_b32 v127, v17
    v_sub_f32 v64, v64, v16
    v_sub_f32 v65, v65, v16
    v_sub_f32 v66, v66, v16
    v_sub_f32 v67, v67, v16
    v_sub_f32 v68, v68, v16
    v_sub_f32 v69, v69, v16
    v_sub_f32 v70, v70, v16
    v_sub_f32 v71, v71, v16
    v_sub_f32 v72, v72, v16
    v_sub_f32 v73, v73, v16
    v_sub_f32 v74, v74, v16
    v_sub_f32 v75, v75, v16
    v_sub_f32 v76, v76, v16
    v_sub_f32 v77, v77, v16
    v_sub_f32 v78, v78, v16
    v_sub_f32 v79, v79, v16
    v_mul_f32 v9, v9, v18
    v_accvgpr_read_b32 v20, a16
    v_accvgpr_read_b32 v21, a17
    v_accvgpr_read_b32 v22, a18
    v_accvgpr_read_b32 v23, a19
    v_mul_f32 v20, v20, v18
    v_mul_f32 v21, v21, v18
    v_mul_f32 v22, v22, v18
    v_mul_f32 v23, v23, v18
    v_accvgpr_write_b32 a16, v20
    v_accvgpr_write_b32 a17, v21
    v_accvgpr_write_b32 a18, v22
    v_accvgpr_write_b32 a19, v23
    v_accvgpr_read_b32 v20, a20
    v_accvgpr_read_b32 v21, a21
    v_accvgpr_read_b32 v22, a22
    v_accvgpr_read_b32 v23, a23
    v_mul_f32 v20, v20, v18
    v_mul_f32 v21, v21, v18
    v_mul_f32 v22, v22, v18
    v_mul_f32 v23, v23, v18
    v_accvgpr_write_b32 a20, v20
    v_accvgpr_write_b32 a21, v21
    v_accvgpr_write_b32 a22, v22
    v_accvgpr_write_b32 a23, v23
    v_accvgpr_read_b32 v20, a24
    v_accvgpr_read_b32 v21, a25
    v_accvgpr_read_b32 v22, a26
    v_accvgpr_read_b32 v23, a27
    v_mul_f32 v20, v20, v18
    v_mul_f32 v21, v21, v18
    v_mul_f32 v22, v22, v18
    v_mul_f32 v23, v23, v18
    v_accvgpr_write_b32 a24, v20
    v_accvgpr_write_b32 a25, v21
    v_accvgpr_write_b32 a26, v22
    v_accvgpr_write_b32 a27, v23
    v_accvgpr_read_b32 v20, a28
    v_accvgpr_read_b32 v21, a29
    v_accvgpr_read_b32 v22, a30
    v_accvgpr_read_b32 v23, a31
    v_mul_f32 v20, v20, v18
    v_mul_f32 v21, v21, v18
    v_mul_f32 v22, v22, v18
    v_mul_f32 v23, v23, v18
    v_accvgpr_write_b32 a28, v20
    v_accvgpr_write_b32 a29, v21
    v_accvgpr_write_b32 a30, v22
    v_accvgpr_write_b32 a31, v23
    v_accvgpr_read_b32 v20, a64
    v_accvgpr_read_b32 v21, a65
    v_accvgpr_read_b32 v22, a66
    v_accvgpr_read_b32 v23, a67
    v_mul_f32 v20, v20, v18
    v_mul_f32 v21, v21, v18
    v_mul_f32 v22, v22, v18
    v_mul_f32 v23, v23, v18
    v_accvgpr_write_b32 a64, v20
    v_accvgpr_write_b32 a65, v21
    v_accvgpr_write_b32 a66, v22
    v_accvgpr_write_b32 a67, v23
    v_accvgpr_read_b32 v20, a68
    v_accvgpr_read_b32 v21, a69
    v_accvgpr_read_b32 v22, a70
    v_accvgpr_read_b32 v23, a71
    v_mul_f32 v20, v20, v18
    v_mul_f32 v21, v21, v18
    v_mul_f32 v22, v22, v18
    v_mul_f32 v23, v23, v18
    v_accvgpr_write_b32 a68, v20
    v_accvgpr_write_b32 a69, v21
    v_accvgpr_write_b32 a70, v22
    v_accvgpr_write_b32 a71, v23
    v_accvgpr_read_b32 v20, a72
    v_accvgpr_read_b32 v21, a73
    v_accvgpr_read_b32 v22, a74
    v_accvgpr_read_b32 v23, a75
    v_mul_f32 v20, v20, v18
    v_mul_f32 v21, v21, v18
    v_mul_f32 v22, v22, v18
    v_mul_f32 v23, v23, v18
    v_accvgpr_write_b32 a72, v20
    v_accvgpr_write_b32 a73, v21
    v_accvgpr_write_b32 a74, v22
    v_accvgpr_write_b32 a75, v23
    v_accvgpr_read_b32 v20, a76
    v_accvgpr_read_b32 v21, a77
    v_accvgpr_read_b32 v22, a78
    v_accvgpr_read_b32 v23, a79
    v_mul_f32 v20, v20, v18
    v_mul_f32 v21, v21, v18
    v_mul_f32 v22, v22, v18
    v_mul_f32 v23, v23, v18
    v_accvgpr_write_b32 a76, v20
    v_accvgpr_write_b32 a77, v21
    v_accvgpr_write_b32 a78, v22
    v_accvgpr_write_b32 a79, v23
    v_accvgpr_read_b32 v20, a112
    v_accvgpr_read_b32 v21, a113
    v_accvgpr_read_b32 v22, a114
    v_accvgpr_read_b32 v23, a115
    v_mul_f32 v20, v20, v18
    v_mul_f32 v21, v21, v18
    v_mul_f32 v22, v22, v18
    v_mul_f32 v23, v23, v18
    v_accvgpr_write_b32 a112, v20
    v_accvgpr_write_b32 a113, v21
    v_accvgpr_write_b32 a114, v22
    v_accvgpr_write_b32 a115, v23
    v_accvgpr_read_b32 v20, a116
    v_accvgpr_read_b32 v21, a117
    v_accvgpr_read_b32 v22, a118
    v_accvgpr_read_b32 v23, a119
    v_mul_f32 v20, v20, v18
    v_mul_f32 v21, v21, v18
    v_mul_f32 v22, v22, v18
    v_mul_f32 v23, v23, v18
    v_accvgpr_write_b32 a116, v20
    v_accvgpr_write_b32 a117, v21
    v_accvgpr_write_b32 a118, v22
    v_accvgpr_write_b32 a119, v23
    v_accvgpr_read_b32 v20, a120
    v_accvgpr_read_b32 v21, a121
    v_accvgpr_read_b32 v22, a122
    v_accvgpr_read_b32 v23, a123
    v_mul_f32 v20, v20, v18
    v_mul_f32 v21, v21, v18
    v_mul_f32 v22, v22, v18
    v_mul_f32 v23, v23, v18
    v_accvgpr_write_b32 a120, v20
    v_accvgpr_write_b32 a121, v21
    v_accvgpr_write_b32 a122, v22
    v_accvgpr_write_b32 a123, v23
    v_accvgpr_read_b32 v20, a124
    v_accvgpr_read_b32 v21, a125
    v_accvgpr_read_b32 v22, a126
    v_accvgpr_read_b32 v23, a127
    v_mul_f32 v20, v20, v18
    v_mul_f32 v21, v21, v18
    v_mul_f32 v22, v22, v18
    v_mul_f32 v23, v23, v18
    v_accvgpr_write_b32 a124, v20
    v_accvgpr_write_b32 a125, v21
    v_accvgpr_write_b32 a126, v22
    v_accvgpr_write_b32 a127, v23
    v_accvgpr_read_b32 v20, a160
    v_accvgpr_read_b32 v21, a161
    v_accvgpr_read_b32 v22, a162
    v_accvgpr_read_b32 v23, a163
    v_mul_f32 v20, v20, v18
    v_mul_f32 v21, v21, v18
    v_mul_f32 v22, v22, v18
    v_mul_f32 v23, v23, v18
    v_accvgpr_write_b32 a160, v20
    v_accvgpr_write_b32 a161, v21
    v_accvgpr_write_b32 a162, v22
    v_accvgpr_write_b32 a163, v23
    v_accvgpr_read_b32 v20, a164
    v_accvgpr_read_b32 v21, a165
    v_accvgpr_read_b32 v22, a166
    v_accvgpr_read_b32 v23, a167
    v_mul_f32 v20, v20, v18
    v_mul_f32 v21, v21, v18
    v_mul_f32 v22, v22, v18
    v_mul_f32 v23, v23, v18
    v_accvgpr_write_b32 a164, v20
    v_accvgpr_write_b32 a165, v21
    v_accvgpr_write_b32 a166, v22
    v_accvgpr_write_b32 a167, v23
    v_accvgpr_read_b32 v20, a168
    v_accvgpr_read_b32 v21, a169
    v_accvgpr_read_b32 v22, a170
    v_accvgpr_read_b32 v23, a171
    v_mul_f32 v20, v20, v18
    v_mul_f32 v21, v21, v18
    v_mul_f32 v22, v22, v18
    v_mul_f32 v23, v23, v18
    v_accvgpr_write_b32 a168, v20
    v_accvgpr_write_b32 a169, v21
    v_accvgpr_write_b32 a170, v22
    v_accvgpr_write_b32 a171, v23
    v_accvgpr_read_b32 v20, a172
    v_accvgpr_read_b32 v21, a173
    v_accvgpr_read_b32 v22, a174
    v_accvgpr_read_b32 v23, a175
    v_mul_f32 v20, v20, v18
    v_mul_f32 v21, v21, v18
    v_mul_f32 v22, v22, v18
    v_mul_f32 v23, v23, v18
    v_accvgpr_write_b32 a172, v20
    v_accvgpr_write_b32 a173, v21
    v_accvgpr_write_b32 a174, v22
    v_accvgpr_write_b32 a175, v23
    v_exp_f32 v16, v64
    v_exp_f32 v17, v65
    v_exp_f32 v18, v66
    v_exp_f32 v19, v67
    v_add_f32 v11, v16, v17
    v_cvt_pk_bf16_f32 v32, v16, v17
    v_exp_f32 v20, v68
    v_add_f32 v11, v11, v18
    v_exp_f32 v21, v69
    v_add_f32 v11, v11, v19
    v_cvt_pk_bf16_f32 v33, v18, v19
    v_exp_f32 v22, v70
    v_add_f32 v11, v11, v20
    v_exp_f32 v23, v71
    v_add_f32 v11, v11, v21
    v_cvt_pk_bf16_f32 v34, v20, v21
    v_exp_f32 v16, v72
    v_add_f32 v11, v11, v22
    v_exp_f32 v17, v73
    v_add_f32 v11, v11, v23
    v_cvt_pk_bf16_f32 v35, v22, v23
    v_exp_f32 v18, v74
    v_add_f32 v11, v11, v16
    v_exp_f32 v19, v75
    v_add_f32 v11, v11, v17
    v_cvt_pk_bf16_f32 v36, v16, v17
    v_exp_f32 v20, v76
    v_add_f32 v11, v11, v18
    v_exp_f32 v21, v77
    v_add_f32 v11, v11, v19
    v_cvt_pk_bf16_f32 v37, v18, v19
    v_exp_f32 v22, v78
    v_add_f32 v11, v11, v20
    v_exp_f32 v23, v79
    v_add_f32 v11, v11, v21
    v_cvt_pk_bf16_f32 v38, v20, v21
    v_add_f32 v11, v11, v22
    v_add_f32 v11, v11, v23
    v_cvt_pk_bf16_f32 v39, v22, v23
    s_nop 3
    s_branch BACK1
SLOW2:
    s_nop 7
    s_nop 7
    v_max3_f32 v16, v80, v81, v82
    v_max3_f32 v17, v83, v84, v85
    v_max3_f32 v16, v16, v86, v87
    v_max3_f32 v17, v17, v88, v89
    v_max3_f32 v16, v16, v90, v91
    v_max3_f32 v17, v17, v92, v93
    v_max3_f32 v16, v16, v94, v95
    v_max_f32 v16, v16, v17
    v_mov_b32 v17, v16
    s_nop 1
    v_permlane32_swap_b32 v16, v17
    s_nop 0
    v_max_f32 v16, v16, v17
    v_max_f32 v16, 0, v16
    v_exp_f32 v18, -v16
    v_sub_f32 v17, v128, v16
    v_mov_b32 v128, v17
    v_mov_b32 v129, v17
    v_mov_b32 v130, v17
    v_mov_b32 v131, v17
    v_mov_b32 v132, v17
    v_mov_b32 v133, v17
    v_mov_b32 v134, v17
    v_mov_b32 v135, v17
    v_mov_b32 v136, v17
    v_mov_b32 v137, v17
    v_mov_b32 v138, v17
    v_mov_b32 v139, v17
    v_mov_b32 v140, v17
    v_mov_b32 v141, v17
    v_mov_b32 v142, v17
    v_mov_b32 v143, v17
    v_sub_f32 v80, v80, v16
    v_sub_f32 v81, v81, v16
    v_sub_f32 v82, v82, v16
    v_sub_f32 v83, v83, v16
    v_sub_f32 v84, v84, v16
    v_sub_f32 v85, v85, v16
    v_sub_f32 v86, v86, v16
    v_sub_f32 v87, v87, v16
    v_sub_f32 v88, v88, v16
    v_sub_f32 v89, v89, v16
    v_sub_f32 v90, v90, v16
    v_sub_f32 v91, v91, v16
    v_sub_f32 v92, v92, v16
    v_sub_f32 v93, v93, v16
    v_sub_f32 v94, v94, v16
    v_sub_f32 v95, v95, v16
    v_mul_f32 v10, v10, v18
    v_accvgpr_read_b32 v20, a32
    v_accvgpr_read_b32 v21, a33
    v_accvgpr_read_b32 v22, a34
    v_accvgpr_read_b32 v23, a35
    v_mul_f32 v20, v20, v18
    v_mul_f32 v21, v21, v18
    v_mul_f32 v22, v22, v18
    v_mul_f32 v23, v23, v18
    v_accvgpr_write_b32 a32, v20
    v_accvgpr_write_b32 a33, v21
    v_accvgpr_write_b32 a34, v22
    v_accvgpr_write_b32 a35, v23
    v_accvgpr_read_b32 v20, a36
    v_accvgpr_read_b32 v21, a37
    v_accvgpr_read_b32 v22, a38
    v_accvgpr_read_b32 v23, a39
    v_mul_f32 v20, v20, v18
    v_mul_f32 v21, v21, v18
    v_mul_f32 v22, v22, v18
    v_mul_f32 v23, v23, v18
    v_accvgpr_write_b32 a36, v20
    v_accvgpr_write_b32 a37, v21
    v_accvgpr_write_b32 a38, v22
    v_accvgpr_write_b32 a39, v23
    v_accvgpr_read_b32 v20, a40
    v_accvgpr_read_b32 v21, a41
    v_accvgpr_read_b32 v22, a42
    v_accvgpr_read_b32 v23, a43
    v_mul_f32 v20, v20, v18
    v_mul_f32 v21, v21, v18
    v_mul_f32 v22, v22, v18
    v_mul_f32 v23, v23, v18
    v_accvgpr_write_b32 a40, v20
    v_accvgpr_write_b32 a41, v21
    v_accvgpr_write_b32 a42, v22
    v_accvgpr_write_b32 a43, v23
    v_accvgpr_read_b32 v20, a44
    v_accvgpr_read_b32 v21, a45
    v_accvgpr_read_b32 v22, a46
    v_accvgpr_read_b32 v23, a47
    v_mul_f32 v20, v20, v18
    v_mul_f32 v21, v21, v18
    v_mul_f32 v22, v22, v18
    v_mul_f32 v23, v23, v18
    v_accvgpr_write_b32 a44, v20
    v_accvgpr_write_b32 a45, v21
    v_accvgpr_write_b32 a46, v22
    v_accvgpr_write_b32 a47, v23
    v_accvgpr_read_b32 v20, a80
    v_accvgpr_read_b32 v21, a81
    v_accvgpr_read_b32 v22, a82
    v_accvgpr_read_b32 v23, a83
    v_mul_f32 v20, v20, v18
    v_mul_f32 v21, v21, v18
    v_mul_f32 v22, v22, v18
    v_mul_f32 v23, v23, v18
    v_accvgpr_write_b32 a80, v20
    v_accvgpr_write_b32 a81, v21
    v_accvgpr_write_b32 a82, v22
    v_accvgpr_write_b32 a83, v23
    v_accvgpr_read_b32 v20, a84
    v_accvgpr_read_b32 v21, a85
    v_accvgpr_read_b32 v22, a86
    v_accvgpr_read_b32 v23, a87
    v_mul_f32 v20, v20, v18
    v_mul_f32 v21, v21, v18
    v_mul_f32 v22, v22, v18
    v_mul_f32 v23, v23, v18
    v_accvgpr_write_b32 a84, v20
    v_accvgpr_write_b32 a85, v21
    v_accvgpr_write_b32 a86, v22
    v_accvgpr_write_b32 a87, v23
    v_accvgpr_read_b32 v20, a88
    v_accvgpr_read_b32 v21, a89
    v_accvgpr_read_b32 v22, a90
    v_accvgpr_read_b32 v23, a91
    v_mul_f32 v20, v20, v18
    v_mul_f32 v21, v21, v18
    v_mul_f32 v22, v22, v18
    v_mul_f32 v23, v23, v18
    v_accvgpr_write_b32 a88, v20
    v_accvgpr_write_b32 a89, v21
    v_accvgpr_write_b32 a90, v22
    v_accvgpr_write_b32 a91, v23
    v_accvgpr_read_b32 v20, a92
    v_accvgpr_read_b32 v21, a93
    v_accvgpr_read_b32 v22, a94
    v_accvgpr_read_b32 v23, a95
    v_mul_f32 v20, v20, v18
    v_mul_f32 v21, v21, v18
    v_mul_f32 v22, v22, v18
    v_mul_f32 v23, v23, v18
    v_accvgpr_write_b32 a92, v20
    v_accvgpr_write_b32 a93, v21
    v_accvgpr_write_b32 a94, v22
    v_accvgpr_write_b32 a95, v23
    v_accvgpr_read_b32 v20, a128
    v_accvgpr_read_b32 v21, a129
    v_accvgpr_read_b32 v22, a130
    v_accvgpr_read_b32 v23, a131
    v_mul_f32 v20, v20, v18
    v_mul_f32 v21, v21, v18
    v_mul_f32 v22, v22, v18
    v_mul_f32 v23, v23, v18
    v_accvgpr_write_b32 a128, v20
    v_accvgpr_write_b32 a129, v21
    v_accvgpr_write_b32 a130, v22
    v_accvgpr_write_b32 a131, v23
    v_accvgpr_read_b32 v20, a132
    v_accvgpr_read_b32 v21, a133
    v_accvgpr_read_b32 v22, a134
    v_accvgpr_read_b32 v23, a135
    v_mul_f32 v20, v20, v18
    v_mul_f32 v21, v21, v18
    v_mul_f32 v22, v22, v18
    v_mul_f32 v23, v23, v18
    v_accvgpr_write_b32 a132, v20
    v_accvgpr_write_b32 a133, v21
    v_accvgpr_write_b32 a134, v22
    v_accvgpr_write_b32 a135, v23
    v_accvgpr_read_b32 v20, a136
    v_accvgpr_read_b32 v21, a137
    v_accvgpr_read_b32 v22, a138
    v_accvgpr_read_b32 v23, a139
    v_mul_f32 v20, v20, v18
    v_mul_f32 v21, v21, v18
    v_mul_f32 v22, v22, v18
    v_mul_f32 v23, v23, v18
    v_accvgpr_write_b32 a136, v20
    v_accvgpr_write_b32 a137, v21
    v_accvgpr_write_b32 a138, v22
    v_accvgpr_write_b32 a139, v23
    v_accvgpr_read_b32 v20, a140
    v_accvgpr_read_b32 v21, a141
    v_accvgpr_read_b32 v22, a142
    v_accvgpr_read_b32 v23, a143
    v_mul_f32 v20, v20, v18
    v_mul_f32 v21, v21, v18
    v_mul_f32 v22, v22, v18
    v_mul_f32 v23, v23, v18
    v_accvgpr_write_b32 a140, v20
    v_accvgpr_write_b32 a141, v21
    v_accvgpr_write_b32 a142, v22
    v_accvgpr_write_b32 a143, v23
    v_accvgpr_read_b32 v20, a176
    v_accvgpr_read_b32 v21, a177
    v_accvgpr_read_b32 v22, a178
    v_accvgpr_read_b32 v23, a179
    v_mul_f32 v20, v20, v18
    v_mul_f32 v21, v21, v18
    v_mul_f32 v22, v22, v18
    v_mul_f32 v23, v23, v18
    v_accvgpr_write_b32 a176, v20
    v_accvgpr_write_b32 a177, v21
    v_accvgpr_write_b32 a178, v22
    v_accvgpr_write_b32 a179, v23
    v_accvgpr_read_b32 v20, a180
    v_accvgpr_read_b32 v21, a181
    v_accvgpr_read_b32 v22, a182
    v_accvgpr_read_b32 v23, a183
    v_mul_f32 v20, v20, v18
    v_mul_f32 v21, v21, v18
    v_mul_f32 v22, v22, v18
    v_mul_f32 v23, v23, v18
    v_accvgpr_write_b32 a180, v20
    v_accvgpr_write_b32 a181, v21
    v_accvgpr_write_b32 a182, v22
    v_accvgpr_write_b32 a183, v23
    v_accvgpr_read_b32 v20, a184
    v_accvgpr_read_b32 v21, a185
    v_accvgpr_read_b32 v22, a186
    v_accvgpr_read_b32 v23, a187
    v_mul_f32 v20, v20, v18
    v_mul_f32 v21, v21, v18
    v_mul_f32 v22, v22, v18
    v_mul_f32 v23, v23, v18
    v_accvgpr_write_b32 a184, v20
    v_accvgpr_write_b32 a185, v21
    v_accvgpr_write_b32 a186, v22
    v_accvgpr_write_b32 a187, v23
    v_accvgpr_read_b32 v20, a188
    v_accvgpr_read_b32 v21, a189
    v_accvgpr_read_b32 v22, a190
    v_accvgpr_read_b32 v23, a191
    v_mul_f32 v20, v20, v18
    v_mul_f32 v21, v21, v18
    v_mul_f32 v22, v22, v18
    v_mul_f32 v23, v23, v18
    v_accvgpr_write_b32 a188, v20
    v_accvgpr_write_b32 a189, v21
    v_accvgpr_write_b32 a190, v22
    v_accvgpr_write_b32 a191, v23
    v_exp_f32 v16, v80
    v_exp_f32 v17, v81
    v_exp_f32 v18, v82
    v_exp_f32 v19, v83
    v_add_f32 v11, v16, v17
    v_cvt_pk_bf16_f32 v40, v16, v17
    v_exp_f32 v20, v84
    v_add_f32 v11, v11, v18
    v_exp_f32 v21, v85
    v_add_f32 v11, v11, v19
    v_cvt_pk_bf16_f32 v41, v18, v19
    v_exp_f32 v22, v86
    v_add_f32 v11, v11, v20
    v_exp_f32 v23, v87
    v_add_f32 v11, v11, v21
    v_cvt_pk_bf16_f32 v42, v20, v21
    v_exp_f32 v16, v88
    v_add_f32 v11, v11, v22
    v_exp_f32 v17, v89
    v_add_f32 v11, v11, v23
    v_cvt_pk_bf16_f32 v43, v22, v23
    v_exp_f32 v18, v90
    v_add_f32 v11, v11, v16
    v_exp_f32 v19, v91
    v_add_f32 v11, v11, v17
    v_cvt_pk_bf16_f32 v44, v16, v17
    v_exp_f32 v20, v92
    v_add_f32 v11, v11, v18
    v_exp_f32 v21, v93
    v_add_f32 v11, v11, v19
    v_cvt_pk_bf16_f32 v45, v18, v19
    v_exp_f32 v22, v94
    v_add_f32 v11, v11, v20
    v_exp_f32 v23, v95
    v_add_f32 v11, v11, v21
    v_cvt_pk_bf16_f32 v46, v20, v21
    v_add_f32 v11, v11, v22
    v_add_f32 v11, v11, v23
    v_cvt_pk_bf16_f32 v47, v22, v23
    s_nop 3
    s_branch BACK2
SLOW0_14:
    s_nop 7
    s_nop 7
    v_max3_f32 v16, v48, v49, v50
    v_max3_f32 v17, v51, v52, v53
    v_max3_f32 v16, v16, v54, v55
    v_max3_f32 v17, v17, v56, v57
    v_max3_f32 v16, v16, v58, v59
    v_max3_f32 v17, v17, v60, v61
    v_max3_f32 v16, v16, v62, v63
    v_max_f32 v16, v16, v17
    v_mov_b32 v17, v16
    s_nop 1
    v_permlane32_swap_b32 v16, v17
    s_nop 0
    v_max_f32 v16, v16, v17
    v_max_f32 v16, 0, v16
    v_exp_f32 v18, -v16
    v_sub_f32 v17, v96, v16
    v_mov_b32 v96, v17
    v_mov_b32 v97, v17
    v_mov_b32 v98, v17
    v_mov_b32 v99, v17
    v_mov_b32 v100, v17
    v_mov_b32 v101, v17
    v_mov_b32 v102, v17
    v_mov_b32 v103, v17
    v_mov_b32 v104, v17
    v_mov_b32 v105, v17
    v_mov_b32 v106, v17
    v_mov_b32 v107, v17
    v_mov_b32 v108, v17
    v_mov_b32 v109, v17
    v_mov_b32 v110, v17
    v_mov_b32 v111, v17
    v_sub_f32 v48, v48, v16
    v_sub_f32 v49, v49, v16
    v_sub_f32 v50, v50, v16
    v_sub_f32 v51, v51, v16
    v_sub_f32 v52, v52, v16
    v_sub_f32 v53, v53, v16
    v_sub_f32 v54, v54, v16
    v_sub_f32 v55, v55, v16
    v_sub_f32 v56, v56, v16
    v_sub_f32 v57, v57, v16
    v_sub_f32 v58, v58, v16
    v_sub_f32 v59, v59, v16
    v_sub_f32 v60, v60, v16
    v_sub_f32 v61, v61, v16
    v_sub_f32 v62, v62, v16
    v_sub_f32 v63, v63, v16
    v_mul_f32 v8, v8, v18
    v_accvgpr_read_b32 v20, a0
    v_accvgpr_read_b32 v21, a1
    v_accvgpr_read_b32 v22, a2
    v_accvgpr_read_b32 v23, a3
    v_mul_f32 v20, v20, v18
    v_mul_f32 v21, v21, v18
    v_mul_f32 v22, v22, v18
    v_mul_f32 v23, v23, v18
    v_accvgpr_write_b32 a0, v20
    v_accvgpr_write_b32 a1, v21
    v_accvgpr_write_b32 a2, v22
    v_accvgpr_write_b32 a3, v23
    v_accvgpr_read_b32 v20, a4
    v_accvgpr_read_b32 v21, a5
    v_accvgpr_read_b32 v22, a6
    v_accvgpr_read_b32 v23, a7
    v_mul_f32 v20, v20, v18
    v_mul_f32 v21, v21, v18
    v_mul_f32 v22, v22, v18
    v_mul_f32 v23, v23, v18
    v_accvgpr_write_b32 a4, v20
    v_accvgpr_write_b32 a5, v21
    v_accvgpr_write_b32 a6, v22
    v_accvgpr_write_b32 a7, v23
    v_accvgpr_read_b32 v20, a8
    v_accvgpr_read_b32 v21, a9
    v_accvgpr_read_b32 v22, a10
    v_accvgpr_read_b32 v23, a11
    v_mul_f32 v20, v20, v18
    v_mul_f32 v21, v21, v18
    v_mul_f32 v22, v22, v18
    v_mul_f32 v23, v23, v18
    v_accvgpr_write_b32 a8, v20
    v_accvgpr_write_b32 a9, v21
    v_accvgpr_write_b32 a10, v22
    v_accvgpr_write_b32 a11, v23
    v_accvgpr_read_b32 v20, a12
    v_accvgpr_read_b32 v21, a13
    v_accvgpr_read_b32 v22, a14
    v_accvgpr_read_b32 v23, a15
    v_mul_f32 v20, v20, v18
    v_mul_f32 v21, v21, v18
    v_mul_f32 v22, v22, v18
    v_mul_f32 v23, v23, v18
    v_accvgpr_write_b32 a12, v20
    v_accvgpr_write_b32 a13, v21
    v_accvgpr_write_b32 a14, v22
    v_accvgpr_write_b32 a15, v23
    v_accvgpr_read_b32 v20, a48
    v_accvgpr_read_b32 v21, a49
    v_accvgpr_read_b32 v22, a50
    v_accvgpr_read_b32 v23, a51
    v_mul_f32 v20, v20, v18
    v_mul_f32 v21, v21, v18
    v_mul_f32 v22, v22, v18
    v_mul_f32 v23, v23, v18
    v_accvgpr_write_b32 a48, v20
    v_accvgpr_write_b32 a49, v21
    v_accvgpr_write_b32 a50, v22
    v_accvgpr_write_b32 a51, v23
    v_accvgpr_read_b32 v20, a52
    v_accvgpr_read_b32 v21, a53
    v_accvgpr_read_b32 v22, a54
    v_accvgpr_read_b32 v23, a55
    v_mul_f32 v20, v20, v18
    v_mul_f32 v21, v21, v18
    v_mul_f32 v22, v22, v18
    v_mul_f32 v23, v23, v18
    v_accvgpr_write_b32 a52, v20
    v_accvgpr_write_b32 a53, v21
    v_accvgpr_write_b32 a54, v22
    v_accvgpr_write_b32 a55, v23
    v_accvgpr_read_b32 v20, a56
    v_accvgpr_read_b32 v21, a57
    v_accvgpr_read_b32 v22, a58
    v_accvgpr_read_b32 v23, a59
    v_mul_f32 v20, v20, v18
    v_mul_f32 v21, v21, v18
    v_mul_f32 v22, v22, v18
    v_mul_f32 v23, v23, v18
    v_accvgpr_write_b32 a56, v20
    v_accvgpr_write_b32 a57, v21
    v_accvgpr_write_b32 a58, v22
    v_accvgpr_write_b32 a59, v23
    v_accvgpr_read_b32 v20, a60
    v_accvgpr_read_b32 v21, a61
    v_accvgpr_read_b32 v22, a62
    v_accvgpr_read_b32 v23, a63
    v_mul_f32 v20, v20, v18
    v_mul_f32 v21, v21, v18
    v_mul_f32 v22, v22, v18
    v_mul_f32 v23, v23, v18
    v_accvgpr_write_b32 a60, v20
    v_accvgpr_write_b32 a61, v21
    v_accvgpr_write_b32 a62, v22
    v_accvgpr_write_b32 a63, v23
    v_accvgpr_read_b32 v20, a96
    v_accvgpr_read_b32 v21, a97
    v_accvgpr_read_b32 v22, a98
    v_accvgpr_read_b32 v23, a99
    v_mul_f32 v20, v20, v18
    v_mul_f32 v21, v21, v18
    v_mul_f32 v22, v22, v18
    v_mul_f32 v23, v23, v18
    v_accvgpr_write_b32 a96, v20
    v_accvgpr_write_b32 a97, v21
    v_accvgpr_write_b32 a98, v22
    v_accvgpr_write_b32 a99, v23
    v_accvgpr_read_b32 v20, a100
    v_accvgpr_read_b32 v21, a101
    v_accvgpr_read_b32 v22, a102
    v_accvgpr_read_b32 v23, a103
    v_mul_f32 v20, v20, v18
    v_mul_f32 v21, v21, v18
    v_mul_f32 v22, v22, v18
    v_mul_f32 v23, v23, v18
    v_accvgpr_write_b32 a100, v20
    v_accvgpr_write_b32 a101, v21
    v_accvgpr_write_b32 a102, v22
    v_accvgpr_write_b32 a103, v23
    v_accvgpr_read_b32 v20, a104
    v_accvgpr_read_b32 v21, a105
    v_accvgpr_read_b32 v22, a106
    v_accvgpr_read_b32 v23, a107
    v_mul_f32 v20, v20, v18
    v_mul_f32 v21, v21, v18
    v_mul_f32 v22, v22, v18
    v_mul_f32 v23, v23, v18
    v_accvgpr_write_b32 a104, v20
    v_accvgpr_write_b32 a105, v21
    v_accvgpr_write_b32 a106, v22
    v_accvgpr_write_b32 a107, v23
    v_accvgpr_read_b32 v20, a108
    v_accvgpr_read_b32 v21, a109
    v_accvgpr_read_b32 v22, a110
    v_accvgpr_read_b32 v23, a111
    v_mul_f32 v20, v20, v18
    v_mul_f32 v21, v21, v18
    v_mul_f32 v22, v22, v18
    v_mul_f32 v23, v23, v18
    v_accvgpr_write_b32 a108, v20
    v_accvgpr_write_b32 a109, v21
    v_accvgpr_write_b32 a110, v22
    v_accvgpr_write_b32 a111, v23
    v_accvgpr_read_b32 v20, a144
    v_accvgpr_read_b32 v21, a145
    v_accvgpr_read_b32 v22, a146
    v_accvgpr_read_b32 v23, a147
    v_mul_f32 v20, v20, v18
    v_mul_f32 v21, v21, v18
    v_mul_f32 v22, v22, v18
    v_mul_f32 v23, v23, v18
    v_accvgpr_write_b32 a144, v20
    v_accvgpr_write_b32 a145, v21
    v_accvgpr_write_b32 a146, v22
    v_accvgpr_write_b32 a147, v23
    v_accvgpr_read_b32 v20, a148
    v_accvgpr_read_b32 v21, a149
    v_accvgpr_read_b32 v22, a150
    v_accvgpr_read_b32 v23, a151
    v_mul_f32 v20, v20, v18
    v_mul_f32 v21, v21, v18
    v_mul_f32 v22, v22, v18
    v_mul_f32 v23, v23, v18
    v_accvgpr_write_b32 a148, v20
    v_accvgpr_write_b32 a149, v21
    v_accvgpr_write_b32 a150, v22
    v_accvgpr_write_b32 a151, v23
    v_accvgpr_read_b32 v20, a152
    v_accvgpr_read_b32 v21, a153
    v_accvgpr_read_b32 v22, a154
    v_accvgpr_read_b32 v23, a155
    v_mul_f32 v20, v20, v18
    v_mul_f32 v21, v21, v18
    v_mul_f32 v22, v22, v18
    v_mul_f32 v23, v23, v18
    v_accvgpr_write_b32 a152, v20
    v_accvgpr_write_b32 a153, v21
    v_accvgpr_write_b32 a154, v22
    v_accvgpr_write_b32 a155, v23
    v_accvgpr_read_b32 v20, a156
    v_accvgpr_read_b32 v21, a157
    v_accvgpr_read_b32 v22, a158
    v_accvgpr_read_b32 v23, a159
    v_mul_f32 v20, v20, v18
    v_mul_f32 v21, v21, v18
    v_mul_f32 v22, v22, v18
    v_mul_f32 v23, v23, v18
    v_accvgpr_write_b32 a156, v20
    v_accvgpr_write_b32 a157, v21
    v_accvgpr_write_b32 a158, v22
    v_accvgpr_write_b32 a159, v23
    v_exp_f32 v16, v48
    v_exp_f32 v17, v49
    v_exp_f32 v18, v50
    v_exp_f32 v19, v51
    v_add_f32 v11, v16, v17
    v_cvt_pk_bf16_f32 v24, v16, v17
    v_exp_f32 v20, v52
    v_add_f32 v11, v11, v18
    v_exp_f32 v21, v53
    v_add_f32 v11, v11, v19
    v_cvt_pk_bf16_f32 v25, v18, v19
    v_exp_f32 v22, v54
    v_add_f32 v11, v11, v20
    v_exp_f32 v23, v55
    v_add_f32 v11, v11, v21
    v_cvt_pk_bf16_f32 v26, v20, v21
    v_exp_f32 v16, v56
    v_add_f32 v11, v11, v22
    v_exp_f32 v17, v57
    v_add_f32 v11, v11, v23
    v_cvt_pk_bf16_f32 v27, v22, v23
    v_exp_f32 v18, v58
    v_add_f32 v11, v11, v16
    v_exp_f32 v19, v59
    v_add_f32 v11, v11, v17
    v_cvt_pk_bf16_f32 v28, v16, v17
    v_exp_f32 v20, v60
    v_add_f32 v11, v11, v18
    v_exp_f32 v21, v61
    v_add_f32 v11, v11, v19
    v_cvt_pk_bf16_f32 v29, v18, v19
    v_exp_f32 v22, v62
    v_add_f32 v11, v11, v20
    v_exp_f32 v23, v63
    v_add_f32 v11, v11, v21
    v_cvt_pk_bf16_f32 v30, v20, v21
    v_add_f32 v11, v11, v22
    v_add_f32 v11, v11, v23
    v_cvt_pk_bf16_f32 v31, v22, v23
    s_nop 3
    s_branch BACK0_14
SLOW1_14:
    s_nop 7
    s_nop 7
    v_max3_f32 v16, v64, v65, v66
    v_max3_f32 v17, v67, v68, v69
    v_max3_f32 v16, v16, v70, v71
    v_max3_f32 v17, v17, v72, v73
    v_max3_f32 v16, v16, v74, v75
    v_max3_f32 v17, v17, v76, v77
    v_max3_f32 v16, v16, v78, v79
    v_max_f32 v16, v16, v17
    v_mov_b32 v17, v16
    s_nop 1
    v_permlane32_swap_b32 v16, v17
    s_nop 0
    v_max_f32 v16, v16, v17
    v_max_f32 v16, 0, v16
    v_exp_f32 v18, -v16
    v_sub_f32 v17, v112, v16
    v_mov_b32 v112, v17
    v_mov_b32 v113, v17
    v_mov_b32 v114, v17
    v_mov_b32 v115, v17
    v_mov_b32 v116, v17
    v_mov_b32 v117, v17
    v_mov_b32 v118, v17
    v_mov_b32 v119, v17
    v_mov_b32 v120, v17
    v_mov_b32 v121, v17
    v_mov_b32 v122, v17
    v_mov_b32 v123, v17
    v_mov_b32 v124, v17
    v_mov_b32 v125, v17
    v_mov_b32 v126, v17
    v_mov_b32 v127, v17
    v_sub_f32 v64, v64, v16
    v_sub_f32 v65, v65, v16
    v_sub_f32 v66, v66, v16
    v_sub_f32 v67, v67, v16
    v_sub_f32 v68, v68, v16
    v_sub_f32 v69, v69, v16
    v_sub_f32 v70, v70, v16
    v_sub_f32 v71, v71, v16
    v_sub_f32 v72, v72, v16
    v_sub_f32 v73, v73, v16
    v_sub_f32 v74, v74, v16
    v_sub_f32 v75, v75, v16
    v_sub_f32 v76, v76, v16
    v_sub_f32 v77, v77, v16
    v_sub_f32 v78, v78, v16
    v_sub_f32 v79, v79, v16
    v_mul_f32 v9, v9, v18
    v_accvgpr_read_b32 v20, a16
    v_accvgpr_read_b32 v21, a17
    v_accvgpr_read_b32 v22, a18
    v_accvgpr_read_b32 v23, a19
    v_mul_f32 v20, v20, v18
    v_mul_f32 v21, v21, v18
    v_mul_f32 v22, v22, v18
    v_mul_f32 v23, v23, v18
    v_accvgpr_write_b32 a16, v20
    v_accvgpr_write_b32 a17, v21
    v_accvgpr_write_b32 a18, v22
    v_accvgpr_write_b32 a19, v23
    v_accvgpr_read_b32 v20, a20
    v_accvgpr_read_b32 v21, a21
    v_accvgpr_read_b32 v22, a22
    v_accvgpr_read_b32 v23, a23
    v_mul_f32 v20, v20, v18
    v_mul_f32 v21, v21, v18
    v_mul_f32 v22, v22, v18
    v_mul_f32 v23, v23, v18
    v_accvgpr_write_b32 a20, v20
    v_accvgpr_write_b32 a21, v21
    v_accvgpr_write_b32 a22, v22
    v_accvgpr_write_b32 a23, v23
    v_accvgpr_read_b32 v20, a24
    v_accvgpr_read_b32 v21, a25
    v_accvgpr_read_b32 v22, a26
    v_accvgpr_read_b32 v23, a27
    v_mul_f32 v20, v20, v18
    v_mul_f32 v21, v21, v18
    v_mul_f32 v22, v22, v18
    v_mul_f32 v23, v23, v18
    v_accvgpr_write_b32 a24, v20
    v_accvgpr_write_b32 a25, v21
    v_accvgpr_write_b32 a26, v22
    v_accvgpr_write_b32 a27, v23
    v_accvgpr_read_b32 v20, a28
    v_accvgpr_read_b32 v21, a29
    v_accvgpr_read_b32 v22, a30
    v_accvgpr_read_b32 v23, a31
    v_mul_f32 v20, v20, v18
    v_mul_f32 v21, v21, v18
    v_mul_f32 v22, v22, v18
    v_mul_f32 v23, v23, v18
    v_accvgpr_write_b32 a28, v20
    v_accvgpr_write_b32 a29, v21
    v_accvgpr_write_b32 a30, v22
    v_accvgpr_write_b32 a31, v23
    v_accvgpr_read_b32 v20, a64
    v_accvgpr_read_b32 v21, a65
    v_accvgpr_read_b32 v22, a66
    v_accvgpr_read_b32 v23, a67
    v_mul_f32 v20, v20, v18
    v_mul_f32 v21, v21, v18
    v_mul_f32 v22, v22, v18
    v_mul_f32 v23, v23, v18
    v_accvgpr_write_b32 a64, v20
    v_accvgpr_write_b32 a65, v21
    v_accvgpr_write_b32 a66, v22
    v_accvgpr_write_b32 a67, v23
    v_accvgpr_read_b32 v20, a68
    v_accvgpr_read_b32 v21, a69
    v_accvgpr_read_b32 v22, a70
    v_accvgpr_read_b32 v23, a71
    v_mul_f32 v20, v20, v18
    v_mul_f32 v21, v21, v18
    v_mul_f32 v22, v22, v18
    v_mul_f32 v23, v23, v18
    v_accvgpr_write_b32 a68, v20
    v_accvgpr_write_b32 a69, v21
    v_accvgpr_write_b32 a70, v22
    v_accvgpr_write_b32 a71, v23
    v_accvgpr_read_b32 v20, a72
    v_accvgpr_read_b32 v21, a73
    v_accvgpr_read_b32 v22, a74
    v_accvgpr_read_b32 v23, a75
    v_mul_f32 v20, v20, v18
    v_mul_f32 v21, v21, v18
    v_mul_f32 v22, v22, v18
    v_mul_f32 v23, v23, v18
    v_accvgpr_write_b32 a72, v20
    v_accvgpr_write_b32 a73, v21
    v_accvgpr_write_b32 a74, v22
    v_accvgpr_write_b32 a75, v23
    v_accvgpr_read_b32 v20, a76
    v_accvgpr_read_b32 v21, a77
    v_accvgpr_read_b32 v22, a78
    v_accvgpr_read_b32 v23, a79
    v_mul_f32 v20, v20, v18
    v_mul_f32 v21, v21, v18
    v_mul_f32 v22, v22, v18
    v_mul_f32 v23, v23, v18
    v_accvgpr_write_b32 a76, v20
    v_accvgpr_write_b32 a77, v21
    v_accvgpr_write_b32 a78, v22
    v_accvgpr_write_b32 a79, v23
    v_accvgpr_read_b32 v20, a112
    v_accvgpr_read_b32 v21, a113
    v_accvgpr_read_b32 v22, a114
    v_accvgpr_read_b32 v23, a115
    v_mul_f32 v20, v20, v18
    v_mul_f32 v21, v21, v18
    v_mul_f32 v22, v22, v18
    v_mul_f32 v23, v23, v18
    v_accvgpr_write_b32 a112, v20
    v_accvgpr_write_b32 a113, v21
    v_accvgpr_write_b32 a114, v22
    v_accvgpr_write_b32 a115, v23
    v_accvgpr_read_b32 v20, a116
    v_accvgpr_read_b32 v21, a117
    v_accvgpr_read_b32 v22, a118
    v_accvgpr_read_b32 v23, a119
    v_mul_f32 v20, v20, v18
    v_mul_f32 v21, v21, v18
    v_mul_f32 v22, v22, v18
    v_mul_f32 v23, v23, v18
    v_accvgpr_write_b32 a116, v20
    v_accvgpr_write_b32 a117, v21
    v_accvgpr_write_b32 a118, v22
    v_accvgpr_write_b32 a119, v23
    v_accvgpr_read_b32 v20, a120
    v_accvgpr_read_b32 v21, a121
    v_accvgpr_read_b32 v22, a122
    v_accvgpr_read_b32 v23, a123
    v_mul_f32 v20, v20, v18
    v_mul_f32 v21, v21, v18
    v_mul_f32 v22, v22, v18
    v_mul_f32 v23, v23, v18
    v_accvgpr_write_b32 a120, v20
    v_accvgpr_write_b32 a121, v21
    v_accvgpr_write_b32 a122, v22
    v_accvgpr_write_b32 a123, v23
    v_accvgpr_read_b32 v20, a124
    v_accvgpr_read_b32 v21, a125
    v_accvgpr_read_b32 v22, a126
    v_accvgpr_read_b32 v23, a127
    v_mul_f32 v20, v20, v18
    v_mul_f32 v21, v21, v18
    v_mul_f32 v22, v22, v18
    v_mul_f32 v23, v23, v18
    v_accvgpr_write_b32 a124, v20
    v_accvgpr_write_b32 a125, v21
    v_accvgpr_write_b32 a126, v22
    v_accvgpr_write_b32 a127, v23
    v_accvgpr_read_b32 v20, a160
    v_accvgpr_read_b32 v21, a161
    v_accvgpr_read_b32 v22, a162
    v_accvgpr_read_b32 v23, a163
    v_mul_f32 v20, v20, v18
    v_mul_f32 v21, v21, v18
    v_mul_f32 v22, v22, v18
    v_mul_f32 v23, v23, v18
    v_accvgpr_write_b32 a160, v20
    v_accvgpr_write_b32 a161, v21
    v_accvgpr_write_b32 a162, v22
    v_accvgpr_write_b32 a163, v23
    v_accvgpr_read_b32 v20, a164
    v_accvgpr_read_b32 v21, a165
    v_accvgpr_read_b32 v22, a166
    v_accvgpr_read_b32 v23, a167
    v_mul_f32 v20, v20, v18
    v_mul_f32 v21, v21, v18
    v_mul_f32 v22, v22, v18
    v_mul_f32 v23, v23, v18
    v_accvgpr_write_b32 a164, v20
    v_accvgpr_write_b32 a165, v21
    v_accvgpr_write_b32 a166, v22
    v_accvgpr_write_b32 a167, v23
    v_accvgpr_read_b32 v20, a168
    v_accvgpr_read_b32 v21, a169
    v_accvgpr_read_b32 v22, a170
    v_accvgpr_read_b32 v23, a171
    v_mul_f32 v20, v20, v18
    v_mul_f32 v21, v21, v18
    v_mul_f32 v22, v22, v18
    v_mul_f32 v23, v23, v18
    v_accvgpr_write_b32 a168, v20
    v_accvgpr_write_b32 a169, v21
    v_accvgpr_write_b32 a170, v22
    v_accvgpr_write_b32 a171, v23
    v_accvgpr_read_b32 v20, a172
    v_accvgpr_read_b32 v21, a173
    v_accvgpr_read_b32 v22, a174
    v_accvgpr_read_b32 v23, a175
    v_mul_f32 v20, v20, v18
    v_mul_f32 v21, v21, v18
    v_mul_f32 v22, v22, v18
    v_mul_f32 v23, v23, v18
    v_accvgpr_write_b32 a172, v20
    v_accvgpr_write_b32 a173, v21
    v_accvgpr_write_b32 a174, v22
    v_accvgpr_write_b32 a175, v23
    v_exp_f32 v16, v64
    v_exp_f32 v17, v65
    v_exp_f32 v18, v66
    v_exp_f32 v19, v67
    v_add_f32 v11, v16, v17
    v_cvt_pk_bf16_f32 v32, v16, v17
    v_exp_f32 v20, v68
    v_add_f32 v11, v11, v18
    v_exp_f32 v21, v69
    v_add_f32 v11, v11, v19
    v_cvt_pk_bf16_f32 v33, v18, v19
    v_exp_f32 v22, v70
    v_add_f32 v11, v11, v20
    v_exp_f32 v23, v71
    v_add_f32 v11, v11, v21
    v_cvt_pk_bf16_f32 v34, v20, v21
    v_exp_f32 v16, v72
    v_add_f32 v11, v11, v22
    v_exp_f32 v17, v73
    v_add_f32 v11, v11, v23
    v_cvt_pk_bf16_f32 v35, v22, v23
    v_exp_f32 v18, v74
    v_add_f32 v11, v11, v16
    v_exp_f32 v19, v75
    v_add_f32 v11, v11, v17
    v_cvt_pk_bf16_f32 v36, v16, v17
    v_exp_f32 v20, v76
    v_add_f32 v11, v11, v18
    v_exp_f32 v21, v77
    v_add_f32 v11, v11, v19
    v_cvt_pk_bf16_f32 v37, v18, v19
    v_exp_f32 v22, v78
    v_add_f32 v11, v11, v20
    v_exp_f32 v23, v79
    v_add_f32 v11, v11, v21
    v_cvt_pk_bf16_f32 v38, v20, v21
    v_add_f32 v11, v11, v22
    v_add_f32 v11, v11, v23
    v_cvt_pk_bf16_f32 v39, v22, v23
    s_nop 3
    s_branch BACK1_14
SLOW2_14:
    s_nop 7
    s_nop 7
    v_max3_f32 v16, v80, v81, v82
    v_max3_f32 v17, v83, v84, v85
    v_max3_f32 v16, v16, v86, v87
    v_max3_f32 v17, v17, v88, v89
    v_max3_f32 v16, v16, v90, v91
    v_max3_f32 v17, v17, v92, v93
    v_max3_f32 v16, v16, v94, v95
    v_max_f32 v16, v16, v17
    v_mov_b32 v17, v16
    s_nop 1
    v_permlane32_swap_b32 v16, v17
    s_nop 0
    v_max_f32 v16, v16, v17
    v_max_f32 v16, 0, v16
    v_exp_f32 v18, -v16
    v_sub_f32 v17, v128, v16
    v_mov_b32 v128, v17
    v_mov_b32 v129, v17
    v_mov_b32 v130, v17
    v_mov_b32 v131, v17
    v_mov_b32 v132, v17
    v_mov_b32 v133, v17
    v_mov_b32 v134, v17
    v_mov_b32 v135, v17
    v_mov_b32 v136, v17
    v_mov_b32 v137, v17
    v_mov_b32 v138, v17
    v_mov_b32 v139, v17
    v_mov_b32 v140, v17
    v_mov_b32 v141, v17
    v_mov_b32 v142, v17
    v_mov_b32 v143, v17
    v_sub_f32 v80, v80, v16
    v_sub_f32 v81, v81, v16
    v_sub_f32 v82, v82, v16
    v_sub_f32 v83, v83, v16
    v_sub_f32 v84, v84, v16
    v_sub_f32 v85, v85, v16
    v_sub_f32 v86, v86, v16
    v_sub_f32 v87, v87, v16
    v_sub_f32 v88, v88, v16
    v_sub_f32 v89, v89, v16
    v_sub_f32 v90, v90, v16
    v_sub_f32 v91, v91, v16
    v_sub_f32 v92, v92, v16
    v_sub_f32 v93, v93, v16
    v_sub_f32 v94, v94, v16
    v_sub_f32 v95, v95, v16
    v_mul_f32 v10, v10, v18
    v_accvgpr_read_b32 v20, a32
    v_accvgpr_read_b32 v21, a33
    v_accvgpr_read_b32 v22, a34
    v_accvgpr_read_b32 v23, a35
    v_mul_f32 v20, v20, v18
    v_mul_f32 v21, v21, v18
    v_mul_f32 v22, v22, v18
    v_mul_f32 v23, v23, v18
    v_accvgpr_write_b32 a32, v20
    v_accvgpr_write_b32 a33, v21
    v_accvgpr_write_b32 a34, v22
    v_accvgpr_write_b32 a35, v23
    v_accvgpr_read_b32 v20, a36
    v_accvgpr_read_b32 v21, a37
    v_accvgpr_read_b32 v22, a38
    v_accvgpr_read_b32 v23, a39
    v_mul_f32 v20, v20, v18
    v_mul_f32 v21, v21, v18
    v_mul_f32 v22, v22, v18
    v_mul_f32 v23, v23, v18
    v_accvgpr_write_b32 a36, v20
    v_accvgpr_write_b32 a37, v21
    v_accvgpr_write_b32 a38, v22
    v_accvgpr_write_b32 a39, v23
    v_accvgpr_read_b32 v20, a40
    v_accvgpr_read_b32 v21, a41
    v_accvgpr_read_b32 v22, a42
    v_accvgpr_read_b32 v23, a43
    v_mul_f32 v20, v20, v18
    v_mul_f32 v21, v21, v18
    v_mul_f32 v22, v22, v18
    v_mul_f32 v23, v23, v18
    v_accvgpr_write_b32 a40, v20
    v_accvgpr_write_b32 a41, v21
    v_accvgpr_write_b32 a42, v22
    v_accvgpr_write_b32 a43, v23
    v_accvgpr_read_b32 v20, a44
    v_accvgpr_read_b32 v21, a45
    v_accvgpr_read_b32 v22, a46
    v_accvgpr_read_b32 v23, a47
    v_mul_f32 v20, v20, v18
    v_mul_f32 v21, v21, v18
    v_mul_f32 v22, v22, v18
    v_mul_f32 v23, v23, v18
    v_accvgpr_write_b32 a44, v20
    v_accvgpr_write_b32 a45, v21
    v_accvgpr_write_b32 a46, v22
    v_accvgpr_write_b32 a47, v23
    v_accvgpr_read_b32 v20, a80
    v_accvgpr_read_b32 v21, a81
    v_accvgpr_read_b32 v22, a82
    v_accvgpr_read_b32 v23, a83
    v_mul_f32 v20, v20, v18
    v_mul_f32 v21, v21, v18
    v_mul_f32 v22, v22, v18
    v_mul_f32 v23, v23, v18
    v_accvgpr_write_b32 a80, v20
    v_accvgpr_write_b32 a81, v21
    v_accvgpr_write_b32 a82, v22
    v_accvgpr_write_b32 a83, v23
    v_accvgpr_read_b32 v20, a84
    v_accvgpr_read_b32 v21, a85
    v_accvgpr_read_b32 v22, a86
    v_accvgpr_read_b32 v23, a87
    v_mul_f32 v20, v20, v18
    v_mul_f32 v21, v21, v18
    v_mul_f32 v22, v22, v18
    v_mul_f32 v23, v23, v18
    v_accvgpr_write_b32 a84, v20
    v_accvgpr_write_b32 a85, v21
    v_accvgpr_write_b32 a86, v22
    v_accvgpr_write_b32 a87, v23
    v_accvgpr_read_b32 v20, a88
    v_accvgpr_read_b32 v21, a89
    v_accvgpr_read_b32 v22, a90
    v_accvgpr_read_b32 v23, a91
    v_mul_f32 v20, v20, v18
    v_mul_f32 v21, v21, v18
    v_mul_f32 v22, v22, v18
    v_mul_f32 v23, v23, v18
    v_accvgpr_write_b32 a88, v20
    v_accvgpr_write_b32 a89, v21
    v_accvgpr_write_b32 a90, v22
    v_accvgpr_write_b32 a91, v23
    v_accvgpr_read_b32 v20, a92
    v_accvgpr_read_b32 v21, a93
    v_accvgpr_read_b32 v22, a94
    v_accvgpr_read_b32 v23, a95
    v_mul_f32 v20, v20, v18
    v_mul_f32 v21, v21, v18
    v_mul_f32 v22, v22, v18
    v_mul_f32 v23, v23, v18
    v_accvgpr_write_b32 a92, v20
    v_accvgpr_write_b32 a93, v21
    v_accvgpr_write_b32 a94, v22
    v_accvgpr_write_b32 a95, v23
    v_accvgpr_read_b32 v20, a128
    v_accvgpr_read_b32 v21, a129
    v_accvgpr_read_b32 v22, a130
    v_accvgpr_read_b32 v23, a131
    v_mul_f32 v20, v20, v18
    v_mul_f32 v21, v21, v18
    v_mul_f32 v22, v22, v18
    v_mul_f32 v23, v23, v18
    v_accvgpr_write_b32 a128, v20
    v_accvgpr_write_b32 a129, v21
    v_accvgpr_write_b32 a130, v22
    v_accvgpr_write_b32 a131, v23
    v_accvgpr_read_b32 v20, a132
    v_accvgpr_read_b32 v21, a133
    v_accvgpr_read_b32 v22, a134
    v_accvgpr_read_b32 v23, a135
    v_mul_f32 v20, v20, v18
    v_mul_f32 v21, v21, v18
    v_mul_f32 v22, v22, v18
    v_mul_f32 v23, v23, v18
    v_accvgpr_write_b32 a132, v20
    v_accvgpr_write_b32 a133, v21
    v_accvgpr_write_b32 a134, v22
    v_accvgpr_write_b32 a135, v23
    v_accvgpr_read_b32 v20, a136
    v_accvgpr_read_b32 v21, a137
    v_accvgpr_read_b32 v22, a138
    v_accvgpr_read_b32 v23, a139
    v_mul_f32 v20, v20, v18
    v_mul_f32 v21, v21, v18
    v_mul_f32 v22, v22, v18
    v_mul_f32 v23, v23, v18
    v_accvgpr_write_b32 a136, v20
    v_accvgpr_write_b32 a137, v21
    v_accvgpr_write_b32 a138, v22
    v_accvgpr_write_b32 a139, v23
    v_accvgpr_read_b32 v20, a140
    v_accvgpr_read_b32 v21, a141
    v_accvgpr_read_b32 v22, a142
    v_accvgpr_read_b32 v23, a143
    v_mul_f32 v20, v20, v18
    v_mul_f32 v21, v21, v18
    v_mul_f32 v22, v22, v18
    v_mul_f32 v23, v23, v18
    v_accvgpr_write_b32 a140, v20
    v_accvgpr_write_b32 a141, v21
    v_accvgpr_write_b32 a142, v22
    v_accvgpr_write_b32 a143, v23
    v_accvgpr_read_b32 v20, a176
    v_accvgpr_read_b32 v21, a177
    v_accvgpr_read_b32 v22, a178
    v_accvgpr_read_b32 v23, a179
    v_mul_f32 v20, v20, v18
    v_mul_f32 v21, v21, v18
    v_mul_f32 v22, v22, v18
    v_mul_f32 v23, v23, v18
    v_accvgpr_write_b32 a176, v20
    v_accvgpr_write_b32 a177, v21
    v_accvgpr_write_b32 a178, v22
    v_accvgpr_write_b32 a179, v23
    v_accvgpr_read_b32 v20, a180
    v_accvgpr_read_b32 v21, a181
    v_accvgpr_read_b32 v22, a182
    v_accvgpr_read_b32 v23, a183
    v_mul_f32 v20, v20, v18
    v_mul_f32 v21, v21, v18
    v_mul_f32 v22, v22, v18
    v_mul_f32 v23, v23, v18
    v_accvgpr_write_b32 a180, v20
    v_accvgpr_write_b32 a181, v21
    v_accvgpr_write_b32 a182, v22
    v_accvgpr_write_b32 a183, v23
    v_accvgpr_read_b32 v20, a184
    v_accvgpr_read_b32 v21, a185
    v_accvgpr_read_b32 v22, a186
    v_accvgpr_read_b32 v23, a187
    v_mul_f32 v20, v20, v18
    v_mul_f32 v21, v21, v18
    v_mul_f32 v22, v22, v18
    v_mul_f32 v23, v23, v18
    v_accvgpr_write_b32 a184, v20
    v_accvgpr_write_b32 a185, v21
    v_accvgpr_write_b32 a186, v22
    v_accvgpr_write_b32 a187, v23
    v_accvgpr_read_b32 v20, a188
    v_accvgpr_read_b32 v21, a189
    v_accvgpr_read_b32 v22, a190
    v_accvgpr_read_b32 v23, a191
    v_mul_f32 v20, v20, v18
    v_mul_f32 v21, v21, v18
    v_mul_f32 v22, v22, v18
    v_mul_f32 v23, v23, v18
    v_accvgpr_write_b32 a188, v20
    v_accvgpr_write_b32 a189, v21
    v_accvgpr_write_b32 a190, v22
    v_accvgpr_write_b32 a191, v23
    v_exp_f32 v16, v80
    v_exp_f32 v17, v81
    v_exp_f32 v18, v82
    v_exp_f32 v19, v83
    v_add_f32 v11, v16, v17
    v_cvt_pk_bf16_f32 v40, v16, v17
    v_exp_f32 v20, v84
    v_add_f32 v11, v11, v18
    v_exp_f32 v21, v85
    v_add_f32 v11, v11, v19
    v_cvt_pk_bf16_f32 v41, v18, v19
    v_exp_f32 v22, v86
    v_add_f32 v11, v11, v20
    v_exp_f32 v23, v87
    v_add_f32 v11, v11, v21
    v_cvt_pk_bf16_f32 v42, v20, v21
    v_exp_f32 v16, v88
    v_add_f32 v11, v11, v22
    v_exp_f32 v17, v89
    v_add_f32 v11, v11, v23
    v_cvt_pk_bf16_f32 v43, v22, v23
    v_exp_f32 v18, v90
    v_add_f32 v11, v11, v16
    v_exp_f32 v19, v91
    v_add_f32 v11, v11, v17
    v_cvt_pk_bf16_f32 v44, v16, v17
    v_exp_f32 v20, v92
    v_add_f32 v11, v11, v18
    v_exp_f32 v21, v93
    v_add_f32 v11, v11, v19
    v_cvt_pk_bf16_f32 v45, v18, v19
    v_exp_f32 v22, v94
    v_add_f32 v11, v11, v20
    v_exp_f32 v23, v95
    v_add_f32 v11, v11, v21
    v_cvt_pk_bf16_f32 v46, v20, v21
    v_add_f32 v11, v11, v22
    v_add_f32 v11, v11, v23
    v_cvt_pk_bf16_f32 v47, v22, v23
    s_nop 3
    s_branch BACK2_14
SLOW0_15:
    s_nop 7
    s_nop 7
    v_max3_f32 v16, v48, v49, v50
    v_max3_f32 v17, v51, v52, v53
    v_max3_f32 v16, v16, v54, v55
    v_max3_f32 v17, v17, v56, v57
    v_max3_f32 v16, v16, v58, v59
    v_max3_f32 v17, v17, v60, v61
    v_max3_f32 v16, v16, v62, v63
    v_max_f32 v16, v16, v17
    v_mov_b32 v17, v16
    s_nop 1
    v_permlane32_swap_b32 v16, v17
    s_nop 0
    v_max_f32 v16, v16, v17
    v_max_f32 v16, 0, v16
    v_exp_f32 v18, -v16
    v_sub_f32 v17, v96, v16
    v_mov_b32 v96, v17
    v_mov_b32 v97, v17
    v_mov_b32 v98, v17
    v_mov_b32 v99, v17
    v_mov_b32 v100, v17
    v_mov_b32 v101, v17
    v_mov_b32 v102, v17
    v_mov_b32 v103, v17
    v_mov_b32 v104, v17
    v_mov_b32 v105, v17
    v_mov_b32 v106, v17
    v_mov_b32 v107, v17
    v_mov_b32 v108, v17
    v_mov_b32 v109, v17
    v_mov_b32 v110, v17
    v_mov_b32 v111, v17
    v_sub_f32 v48, v48, v16
    v_sub_f32 v49, v49, v16
    v_sub_f32 v50, v50, v16
    v_sub_f32 v51, v51, v16
    v_sub_f32 v52, v52, v16
    v_sub_f32 v53, v53, v16
    v_sub_f32 v54, v54, v16
    v_sub_f32 v55, v55, v16
    v_sub_f32 v56, v56, v16
    v_sub_f32 v57, v57, v16
    v_sub_f32 v58, v58, v16
    v_sub_f32 v59, v59, v16
    v_sub_f32 v60, v60, v16
    v_sub_f32 v61, v61, v16
    v_sub_f32 v62, v62, v16
    v_sub_f32 v63, v63, v16
    v_mul_f32 v8, v8, v18
    v_accvgpr_read_b32 v20, a0
    v_accvgpr_read_b32 v21, a1
    v_accvgpr_read_b32 v22, a2
    v_accvgpr_read_b32 v23, a3
    v_mul_f32 v20, v20, v18
    v_mul_f32 v21, v21, v18
    v_mul_f32 v22, v22, v18
    v_mul_f32 v23, v23, v18
    v_accvgpr_write_b32 a0, v20
    v_accvgpr_write_b32 a1, v21
    v_accvgpr_write_b32 a2, v22
    v_accvgpr_write_b32 a3, v23
    v_accvgpr_read_b32 v20, a4
    v_accvgpr_read_b32 v21, a5
    v_accvgpr_read_b32 v22, a6
    v_accvgpr_read_b32 v23, a7
    v_mul_f32 v20, v20, v18
    v_mul_f32 v21, v21, v18
    v_mul_f32 v22, v22, v18
    v_mul_f32 v23, v23, v18
    v_accvgpr_write_b32 a4, v20
    v_accvgpr_write_b32 a5, v21
    v_accvgpr_write_b32 a6, v22
    v_accvgpr_write_b32 a7, v23
    v_accvgpr_read_b32 v20, a8
    v_accvgpr_read_b32 v21, a9
    v_accvgpr_read_b32 v22, a10
    v_accvgpr_read_b32 v23, a11
    v_mul_f32 v20, v20, v18
    v_mul_f32 v21, v21, v18
    v_mul_f32 v22, v22, v18
    v_mul_f32 v23, v23, v18
    v_accvgpr_write_b32 a8, v20
    v_accvgpr_write_b32 a9, v21
    v_accvgpr_write_b32 a10, v22
    v_accvgpr_write_b32 a11, v23
    v_accvgpr_read_b32 v20, a12
    v_accvgpr_read_b32 v21, a13
    v_accvgpr_read_b32 v22, a14
    v_accvgpr_read_b32 v23, a15
    v_mul_f32 v20, v20, v18
    v_mul_f32 v21, v21, v18
    v_mul_f32 v22, v22, v18
    v_mul_f32 v23, v23, v18
    v_accvgpr_write_b32 a12, v20
    v_accvgpr_write_b32 a13, v21
    v_accvgpr_write_b32 a14, v22
    v_accvgpr_write_b32 a15, v23
    v_accvgpr_read_b32 v20, a48
    v_accvgpr_read_b32 v21, a49
    v_accvgpr_read_b32 v22, a50
    v_accvgpr_read_b32 v23, a51
    v_mul_f32 v20, v20, v18
    v_mul_f32 v21, v21, v18
    v_mul_f32 v22, v22, v18
    v_mul_f32 v23, v23, v18
    v_accvgpr_write_b32 a48, v20
    v_accvgpr_write_b32 a49, v21
    v_accvgpr_write_b32 a50, v22
    v_accvgpr_write_b32 a51, v23
    v_accvgpr_read_b32 v20, a52
    v_accvgpr_read_b32 v21, a53
    v_accvgpr_read_b32 v22, a54
    v_accvgpr_read_b32 v23, a55
    v_mul_f32 v20, v20, v18
    v_mul_f32 v21, v21, v18
    v_mul_f32 v22, v22, v18
    v_mul_f32 v23, v23, v18
    v_accvgpr_write_b32 a52, v20
    v_accvgpr_write_b32 a53, v21
    v_accvgpr_write_b32 a54, v22
    v_accvgpr_write_b32 a55, v23
    v_accvgpr_read_b32 v20, a56
    v_accvgpr_read_b32 v21, a57
    v_accvgpr_read_b32 v22, a58
    v_accvgpr_read_b32 v23, a59
    v_mul_f32 v20, v20, v18
    v_mul_f32 v21, v21, v18
    v_mul_f32 v22, v22, v18
    v_mul_f32 v23, v23, v18
    v_accvgpr_write_b32 a56, v20
    v_accvgpr_write_b32 a57, v21
    v_accvgpr_write_b32 a58, v22
    v_accvgpr_write_b32 a59, v23
    v_accvgpr_read_b32 v20, a60
    v_accvgpr_read_b32 v21, a61
    v_accvgpr_read_b32 v22, a62
    v_accvgpr_read_b32 v23, a63
    v_mul_f32 v20, v20, v18
    v_mul_f32 v21, v21, v18
    v_mul_f32 v22, v22, v18
    v_mul_f32 v23, v23, v18
    v_accvgpr_write_b32 a60, v20
    v_accvgpr_write_b32 a61, v21
    v_accvgpr_write_b32 a62, v22
    v_accvgpr_write_b32 a63, v23
    v_accvgpr_read_b32 v20, a96
    v_accvgpr_read_b32 v21, a97
    v_accvgpr_read_b32 v22, a98
    v_accvgpr_read_b32 v23, a99
    v_mul_f32 v20, v20, v18
    v_mul_f32 v21, v21, v18
    v_mul_f32 v22, v22, v18
    v_mul_f32 v23, v23, v18
    v_accvgpr_write_b32 a96, v20
    v_accvgpr_write_b32 a97, v21
    v_accvgpr_write_b32 a98, v22
    v_accvgpr_write_b32 a99, v23
    v_accvgpr_read_b32 v20, a100
    v_accvgpr_read_b32 v21, a101
    v_accvgpr_read_b32 v22, a102
    v_accvgpr_read_b32 v23, a103
    v_mul_f32 v20, v20, v18
    v_mul_f32 v21, v21, v18
    v_mul_f32 v22, v22, v18
    v_mul_f32 v23, v23, v18
    v_accvgpr_write_b32 a100, v20
    v_accvgpr_write_b32 a101, v21
    v_accvgpr_write_b32 a102, v22
    v_accvgpr_write_b32 a103, v23
    v_accvgpr_read_b32 v20, a104
    v_accvgpr_read_b32 v21, a105
    v_accvgpr_read_b32 v22, a106
    v_accvgpr_read_b32 v23, a107
    v_mul_f32 v20, v20, v18
    v_mul_f32 v21, v21, v18
    v_mul_f32 v22, v22, v18
    v_mul_f32 v23, v23, v18
    v_accvgpr_write_b32 a104, v20
    v_accvgpr_write_b32 a105, v21
    v_accvgpr_write_b32 a106, v22
    v_accvgpr_write_b32 a107, v23
    v_accvgpr_read_b32 v20, a108
    v_accvgpr_read_b32 v21, a109
    v_accvgpr_read_b32 v22, a110
    v_accvgpr_read_b32 v23, a111
    v_mul_f32 v20, v20, v18
    v_mul_f32 v21, v21, v18
    v_mul_f32 v22, v22, v18
    v_mul_f32 v23, v23, v18
    v_accvgpr_write_b32 a108, v20
    v_accvgpr_write_b32 a109, v21
    v_accvgpr_write_b32 a110, v22
    v_accvgpr_write_b32 a111, v23
    v_accvgpr_read_b32 v20, a144
    v_accvgpr_read_b32 v21, a145
    v_accvgpr_read_b32 v22, a146
    v_accvgpr_read_b32 v23, a147
    v_mul_f32 v20, v20, v18
    v_mul_f32 v21, v21, v18
    v_mul_f32 v22, v22, v18
    v_mul_f32 v23, v23, v18
    v_accvgpr_write_b32 a144, v20
    v_accvgpr_write_b32 a145, v21
    v_accvgpr_write_b32 a146, v22
    v_accvgpr_write_b32 a147, v23
    v_accvgpr_read_b32 v20, a148
    v_accvgpr_read_b32 v21, a149
    v_accvgpr_read_b32 v22, a150
    v_accvgpr_read_b32 v23, a151
    v_mul_f32 v20, v20, v18
    v_mul_f32 v21, v21, v18
    v_mul_f32 v22, v22, v18
    v_mul_f32 v23, v23, v18
    v_accvgpr_write_b32 a148, v20
    v_accvgpr_write_b32 a149, v21
    v_accvgpr_write_b32 a150, v22
    v_accvgpr_write_b32 a151, v23
    v_accvgpr_read_b32 v20, a152
    v_accvgpr_read_b32 v21, a153
    v_accvgpr_read_b32 v22, a154
    v_accvgpr_read_b32 v23, a155
    v_mul_f32 v20, v20, v18
    v_mul_f32 v21, v21, v18
    v_mul_f32 v22, v22, v18
    v_mul_f32 v23, v23, v18
    v_accvgpr_write_b32 a152, v20
    v_accvgpr_write_b32 a153, v21
    v_accvgpr_write_b32 a154, v22
    v_accvgpr_write_b32 a155, v23
    v_accvgpr_read_b32 v20, a156
    v_accvgpr_read_b32 v21, a157
    v_accvgpr_read_b32 v22, a158
    v_accvgpr_read_b32 v23, a159
    v_mul_f32 v20, v20, v18
    v_mul_f32 v21, v21, v18
    v_mul_f32 v22, v22, v18
    v_mul_f32 v23, v23, v18
    v_accvgpr_write_b32 a156, v20
    v_accvgpr_write_b32 a157, v21
    v_accvgpr_write_b32 a158, v22
    v_accvgpr_write_b32 a159, v23
    v_exp_f32 v16, v48
    v_exp_f32 v17, v49
    v_exp_f32 v18, v50
    v_exp_f32 v19, v51
    v_add_f32 v11, v16, v17
    v_cvt_pk_bf16_f32 v24, v16, v17
    v_exp_f32 v20, v52
    v_add_f32 v11, v11, v18
    v_exp_f32 v21, v53
    v_add_f32 v11, v11, v19
    v_cvt_pk_bf16_f32 v25, v18, v19
    v_exp_f32 v22, v54
    v_add_f32 v11, v11, v20
    v_exp_f32 v23, v55
    v_add_f32 v11, v11, v21
    v_cvt_pk_bf16_f32 v26, v20, v21
    v_exp_f32 v16, v56
    v_add_f32 v11, v11, v22
    v_exp_f32 v17, v57
    v_add_f32 v11, v11, v23
    v_cvt_pk_bf16_f32 v27, v22, v23
    v_exp_f32 v18, v58
    v_add_f32 v11, v11, v16
    v_exp_f32 v19, v59
    v_add_f32 v11, v11, v17
    v_cvt_pk_bf16_f32 v28, v16, v17
    v_exp_f32 v20, v60
    v_add_f32 v11, v11, v18
    v_exp_f32 v21, v61
    v_add_f32 v11, v11, v19
    v_cvt_pk_bf16_f32 v29, v18, v19
    v_exp_f32 v22, v62
    v_add_f32 v11, v11, v20
    v_exp_f32 v23, v63
    v_add_f32 v11, v11, v21
    v_cvt_pk_bf16_f32 v30, v20, v21
    v_add_f32 v11, v11, v22
    v_add_f32 v11, v11, v23
    v_cvt_pk_bf16_f32 v31, v22, v23
    s_nop 3
    s_branch BACK0_15
SLOW1_15:
    s_nop 7
    s_nop 7
    v_max3_f32 v16, v64, v65, v66
    v_max3_f32 v17, v67, v68, v69
    v_max3_f32 v16, v16, v70, v71
    v_max3_f32 v17, v17, v72, v73
    v_max3_f32 v16, v16, v74, v75
    v_max3_f32 v17, v17, v76, v77
    v_max3_f32 v16, v16, v78, v79
    v_max_f32 v16, v16, v17
    v_mov_b32 v17, v16
    s_nop 1
    v_permlane32_swap_b32 v16, v17
    s_nop 0
    v_max_f32 v16, v16, v17
    v_max_f32 v16, 0, v16
    v_exp_f32 v18, -v16
    v_sub_f32 v17, v112, v16
    v_mov_b32 v112, v17
    v_mov_b32 v113, v17
    v_mov_b32 v114, v17
    v_mov_b32 v115, v17
    v_mov_b32 v116, v17
    v_mov_b32 v117, v17
    v_mov_b32 v118, v17
    v_mov_b32 v119, v17
    v_mov_b32 v120, v17
    v_mov_b32 v121, v17
    v_mov_b32 v122, v17
    v_mov_b32 v123, v17
    v_mov_b32 v124, v17
    v_mov_b32 v125, v17
    v_mov_b32 v126, v17
    v_mov_b32 v127, v17
    v_sub_f32 v64, v64, v16
    v_sub_f32 v65, v65, v16
    v_sub_f32 v66, v66, v16
    v_sub_f32 v67, v67, v16
    v_sub_f32 v68, v68, v16
    v_sub_f32 v69, v69, v16
    v_sub_f32 v70, v70, v16
    v_sub_f32 v71, v71, v16
    v_sub_f32 v72, v72, v16
    v_sub_f32 v73, v73, v16
    v_sub_f32 v74, v74, v16
    v_sub_f32 v75, v75, v16
    v_sub_f32 v76, v76, v16
    v_sub_f32 v77, v77, v16
    v_sub_f32 v78, v78, v16
    v_sub_f32 v79, v79, v16
    v_mul_f32 v9, v9, v18
    v_accvgpr_read_b32 v20, a16
    v_accvgpr_read_b32 v21, a17
    v_accvgpr_read_b32 v22, a18
    v_accvgpr_read_b32 v23, a19
    v_mul_f32 v20, v20, v18
    v_mul_f32 v21, v21, v18
    v_mul_f32 v22, v22, v18
    v_mul_f32 v23, v23, v18
    v_accvgpr_write_b32 a16, v20
    v_accvgpr_write_b32 a17, v21
    v_accvgpr_write_b32 a18, v22
    v_accvgpr_write_b32 a19, v23
    v_accvgpr_read_b32 v20, a20
    v_accvgpr_read_b32 v21, a21
    v_accvgpr_read_b32 v22, a22
    v_accvgpr_read_b32 v23, a23
    v_mul_f32 v20, v20, v18
    v_mul_f32 v21, v21, v18
    v_mul_f32 v22, v22, v18
    v_mul_f32 v23, v23, v18
    v_accvgpr_write_b32 a20, v20
    v_accvgpr_write_b32 a21, v21
    v_accvgpr_write_b32 a22, v22
    v_accvgpr_write_b32 a23, v23
    v_accvgpr_read_b32 v20, a24
    v_accvgpr_read_b32 v21, a25
    v_accvgpr_read_b32 v22, a26
    v_accvgpr_read_b32 v23, a27
    v_mul_f32 v20, v20, v18
    v_mul_f32 v21, v21, v18
    v_mul_f32 v22, v22, v18
    v_mul_f32 v23, v23, v18
    v_accvgpr_write_b32 a24, v20
    v_accvgpr_write_b32 a25, v21
    v_accvgpr_write_b32 a26, v22
    v_accvgpr_write_b32 a27, v23
    v_accvgpr_read_b32 v20, a28
    v_accvgpr_read_b32 v21, a29
    v_accvgpr_read_b32 v22, a30
    v_accvgpr_read_b32 v23, a31
    v_mul_f32 v20, v20, v18
    v_mul_f32 v21, v21, v18
    v_mul_f32 v22, v22, v18
    v_mul_f32 v23, v23, v18
    v_accvgpr_write_b32 a28, v20
    v_accvgpr_write_b32 a29, v21
    v_accvgpr_write_b32 a30, v22
    v_accvgpr_write_b32 a31, v23
    v_accvgpr_read_b32 v20, a64
    v_accvgpr_read_b32 v21, a65
    v_accvgpr_read_b32 v22, a66
    v_accvgpr_read_b32 v23, a67
    v_mul_f32 v20, v20, v18
    v_mul_f32 v21, v21, v18
    v_mul_f32 v22, v22, v18
    v_mul_f32 v23, v23, v18
    v_accvgpr_write_b32 a64, v20
    v_accvgpr_write_b32 a65, v21
    v_accvgpr_write_b32 a66, v22
    v_accvgpr_write_b32 a67, v23
    v_accvgpr_read_b32 v20, a68
    v_accvgpr_read_b32 v21, a69
    v_accvgpr_read_b32 v22, a70
    v_accvgpr_read_b32 v23, a71
    v_mul_f32 v20, v20, v18
    v_mul_f32 v21, v21, v18
    v_mul_f32 v22, v22, v18
    v_mul_f32 v23, v23, v18
    v_accvgpr_write_b32 a68, v20
    v_accvgpr_write_b32 a69, v21
    v_accvgpr_write_b32 a70, v22
    v_accvgpr_write_b32 a71, v23
    v_accvgpr_read_b32 v20, a72
    v_accvgpr_read_b32 v21, a73
    v_accvgpr_read_b32 v22, a74
    v_accvgpr_read_b32 v23, a75
    v_mul_f32 v20, v20, v18
    v_mul_f32 v21, v21, v18
    v_mul_f32 v22, v22, v18
    v_mul_f32 v23, v23, v18
    v_accvgpr_write_b32 a72, v20
    v_accvgpr_write_b32 a73, v21
    v_accvgpr_write_b32 a74, v22
    v_accvgpr_write_b32 a75, v23
    v_accvgpr_read_b32 v20, a76
    v_accvgpr_read_b32 v21, a77
    v_accvgpr_read_b32 v22, a78
    v_accvgpr_read_b32 v23, a79
    v_mul_f32 v20, v20, v18
    v_mul_f32 v21, v21, v18
    v_mul_f32 v22, v22, v18
    v_mul_f32 v23, v23, v18
    v_accvgpr_write_b32 a76, v20
    v_accvgpr_write_b32 a77, v21
    v_accvgpr_write_b32 a78, v22
    v_accvgpr_write_b32 a79, v23
    v_accvgpr_read_b32 v20, a112
    v_accvgpr_read_b32 v21, a113
    v_accvgpr_read_b32 v22, a114
    v_accvgpr_read_b32 v23, a115
    v_mul_f32 v20, v20, v18
    v_mul_f32 v21, v21, v18
    v_mul_f32 v22, v22, v18
    v_mul_f32 v23, v23, v18
    v_accvgpr_write_b32 a112, v20
    v_accvgpr_write_b32 a113, v21
    v_accvgpr_write_b32 a114, v22
    v_accvgpr_write_b32 a115, v23
    v_accvgpr_read_b32 v20, a116
    v_accvgpr_read_b32 v21, a117
    v_accvgpr_read_b32 v22, a118
    v_accvgpr_read_b32 v23, a119
    v_mul_f32 v20, v20, v18
    v_mul_f32 v21, v21, v18
    v_mul_f32 v22, v22, v18
    v_mul_f32 v23, v23, v18
    v_accvgpr_write_b32 a116, v20
    v_accvgpr_write_b32 a117, v21
    v_accvgpr_write_b32 a118, v22
    v_accvgpr_write_b32 a119, v23
    v_accvgpr_read_b32 v20, a120
    v_accvgpr_read_b32 v21, a121
    v_accvgpr_read_b32 v22, a122
    v_accvgpr_read_b32 v23, a123
    v_mul_f32 v20, v20, v18
    v_mul_f32 v21, v21, v18
    v_mul_f32 v22, v22, v18
    v_mul_f32 v23, v23, v18
    v_accvgpr_write_b32 a120, v20
    v_accvgpr_write_b32 a121, v21
    v_accvgpr_write_b32 a122, v22
    v_accvgpr_write_b32 a123, v23
    v_accvgpr_read_b32 v20, a124
    v_accvgpr_read_b32 v21, a125
    v_accvgpr_read_b32 v22, a126
    v_accvgpr_read_b32 v23, a127
    v_mul_f32 v20, v20, v18
    v_mul_f32 v21, v21, v18
    v_mul_f32 v22, v22, v18
    v_mul_f32 v23, v23, v18
    v_accvgpr_write_b32 a124, v20
    v_accvgpr_write_b32 a125, v21
    v_accvgpr_write_b32 a126, v22
    v_accvgpr_write_b32 a127, v23
    v_accvgpr_read_b32 v20, a160
    v_accvgpr_read_b32 v21, a161
    v_accvgpr_read_b32 v22, a162
    v_accvgpr_read_b32 v23, a163
    v_mul_f32 v20, v20, v18
    v_mul_f32 v21, v21, v18
    v_mul_f32 v22, v22, v18
    v_mul_f32 v23, v23, v18
    v_accvgpr_write_b32 a160, v20
    v_accvgpr_write_b32 a161, v21
    v_accvgpr_write_b32 a162, v22
    v_accvgpr_write_b32 a163, v23
    v_accvgpr_read_b32 v20, a164
    v_accvgpr_read_b32 v21, a165
    v_accvgpr_read_b32 v22, a166
    v_accvgpr_read_b32 v23, a167
    v_mul_f32 v20, v20, v18
    v_mul_f32 v21, v21, v18
    v_mul_f32 v22, v22, v18
    v_mul_f32 v23, v23, v18
    v_accvgpr_write_b32 a164, v20
    v_accvgpr_write_b32 a165, v21
    v_accvgpr_write_b32 a166, v22
    v_accvgpr_write_b32 a167, v23
    v_accvgpr_read_b32 v20, a168
    v_accvgpr_read_b32 v21, a169
    v_accvgpr_read_b32 v22, a170
    v_accvgpr_read_b32 v23, a171
    v_mul_f32 v20, v20, v18
    v_mul_f32 v21, v21, v18
    v_mul_f32 v22, v22, v18
    v_mul_f32 v23, v23, v18
    v_accvgpr_write_b32 a168, v20
    v_accvgpr_write_b32 a169, v21
    v_accvgpr_write_b32 a170, v22
    v_accvgpr_write_b32 a171, v23
    v_accvgpr_read_b32 v20, a172
    v_accvgpr_read_b32 v21, a173
    v_accvgpr_read_b32 v22, a174
    v_accvgpr_read_b32 v23, a175
    v_mul_f32 v20, v20, v18
    v_mul_f32 v21, v21, v18
    v_mul_f32 v22, v22, v18
    v_mul_f32 v23, v23, v18
    v_accvgpr_write_b32 a172, v20
    v_accvgpr_write_b32 a173, v21
    v_accvgpr_write_b32 a174, v22
    v_accvgpr_write_b32 a175, v23
    v_exp_f32 v16, v64
    v_exp_f32 v17, v65
    v_exp_f32 v18, v66
    v_exp_f32 v19, v67
    v_add_f32 v11, v16, v17
    v_cvt_pk_bf16_f32 v32, v16, v17
    v_exp_f32 v20, v68
    v_add_f32 v11, v11, v18
    v_exp_f32 v21, v69
    v_add_f32 v11, v11, v19
    v_cvt_pk_bf16_f32 v33, v18, v19
    v_exp_f32 v22, v70
    v_add_f32 v11, v11, v20
    v_exp_f32 v23, v71
    v_add_f32 v11, v11, v21
    v_cvt_pk_bf16_f32 v34, v20, v21
    v_exp_f32 v16, v72
    v_add_f32 v11, v11, v22
    v_exp_f32 v17, v73
    v_add_f32 v11, v11, v23
    v_cvt_pk_bf16_f32 v35, v22, v23
    v_exp_f32 v18, v74
    v_add_f32 v11, v11, v16
    v_exp_f32 v19, v75
    v_add_f32 v11, v11, v17
    v_cvt_pk_bf16_f32 v36, v16, v17
    v_exp_f32 v20, v76
    v_add_f32 v11, v11, v18
    v_exp_f32 v21, v77
    v_add_f32 v11, v11, v19
    v_cvt_pk_bf16_f32 v37, v18, v19
    v_exp_f32 v22, v78
    v_add_f32 v11, v11, v20
    v_exp_f32 v23, v79
    v_add_f32 v11, v11, v21
    v_cvt_pk_bf16_f32 v38, v20, v21
    v_add_f32 v11, v11, v22
    v_add_f32 v11, v11, v23
    v_cvt_pk_bf16_f32 v39, v22, v23
    s_nop 3
    s_branch BACK1_15
SLOW2_15:
    s_nop 7
    s_nop 7
    v_max3_f32 v16, v80, v81, v82
    v_max3_f32 v17, v83, v84, v85
    v_max3_f32 v16, v16, v86, v87
    v_max3_f32 v17, v17, v88, v89
    v_max3_f32 v16, v16, v90, v91
    v_max3_f32 v17, v17, v92, v93
    v_max3_f32 v16, v16, v94, v95
    v_max_f32 v16, v16, v17
    v_mov_b32 v17, v16
    s_nop 1
    v_permlane32_swap_b32 v16, v17
    s_nop 0
    v_max_f32 v16, v16, v17
    v_max_f32 v16, 0, v16
    v_exp_f32 v18, -v16
    v_sub_f32 v17, v128, v16
    v_mov_b32 v128, v17
    v_mov_b32 v129, v17
    v_mov_b32 v130, v17
    v_mov_b32 v131, v17
    v_mov_b32 v132, v17
    v_mov_b32 v133, v17
    v_mov_b32 v134, v17
    v_mov_b32 v135, v17
    v_mov_b32 v136, v17
    v_mov_b32 v137, v17
    v_mov_b32 v138, v17
    v_mov_b32 v139, v17
    v_mov_b32 v140, v17
    v_mov_b32 v141, v17
    v_mov_b32 v142, v17
    v_mov_b32 v143, v17
    v_sub_f32 v80, v80, v16
    v_sub_f32 v81, v81, v16
    v_sub_f32 v82, v82, v16
    v_sub_f32 v83, v83, v16
    v_sub_f32 v84, v84, v16
    v_sub_f32 v85, v85, v16
    v_sub_f32 v86, v86, v16
    v_sub_f32 v87, v87, v16
    v_sub_f32 v88, v88, v16
    v_sub_f32 v89, v89, v16
    v_sub_f32 v90, v90, v16
    v_sub_f32 v91, v91, v16
    v_sub_f32 v92, v92, v16
    v_sub_f32 v93, v93, v16
    v_sub_f32 v94, v94, v16
    v_sub_f32 v95, v95, v16
    v_mul_f32 v10, v10, v18
    v_accvgpr_read_b32 v20, a32
    v_accvgpr_read_b32 v21, a33
    v_accvgpr_read_b32 v22, a34
    v_accvgpr_read_b32 v23, a35
    v_mul_f32 v20, v20, v18
    v_mul_f32 v21, v21, v18
    v_mul_f32 v22, v22, v18
    v_mul_f32 v23, v23, v18
    v_accvgpr_write_b32 a32, v20
    v_accvgpr_write_b32 a33, v21
    v_accvgpr_write_b32 a34, v22
    v_accvgpr_write_b32 a35, v23
    v_accvgpr_read_b32 v20, a36
    v_accvgpr_read_b32 v21, a37
    v_accvgpr_read_b32 v22, a38
    v_accvgpr_read_b32 v23, a39
    v_mul_f32 v20, v20, v18
    v_mul_f32 v21, v21, v18
    v_mul_f32 v22, v22, v18
    v_mul_f32 v23, v23, v18
    v_accvgpr_write_b32 a36, v20
    v_accvgpr_write_b32 a37, v21
    v_accvgpr_write_b32 a38, v22
    v_accvgpr_write_b32 a39, v23
    v_accvgpr_read_b32 v20, a40
    v_accvgpr_read_b32 v21, a41
    v_accvgpr_read_b32 v22, a42
    v_accvgpr_read_b32 v23, a43
    v_mul_f32 v20, v20, v18
    v_mul_f32 v21, v21, v18
    v_mul_f32 v22, v22, v18
    v_mul_f32 v23, v23, v18
    v_accvgpr_write_b32 a40, v20
    v_accvgpr_write_b32 a41, v21
    v_accvgpr_write_b32 a42, v22
    v_accvgpr_write_b32 a43, v23
    v_accvgpr_read_b32 v20, a44
    v_accvgpr_read_b32 v21, a45
    v_accvgpr_read_b32 v22, a46
    v_accvgpr_read_b32 v23, a47
    v_mul_f32 v20, v20, v18
    v_mul_f32 v21, v21, v18
    v_mul_f32 v22, v22, v18
    v_mul_f32 v23, v23, v18
    v_accvgpr_write_b32 a44, v20
    v_accvgpr_write_b32 a45, v21
    v_accvgpr_write_b32 a46, v22
    v_accvgpr_write_b32 a47, v23
    v_accvgpr_read_b32 v20, a80
    v_accvgpr_read_b32 v21, a81
    v_accvgpr_read_b32 v22, a82
    v_accvgpr_read_b32 v23, a83
    v_mul_f32 v20, v20, v18
    v_mul_f32 v21, v21, v18
    v_mul_f32 v22, v22, v18
    v_mul_f32 v23, v23, v18
    v_accvgpr_write_b32 a80, v20
    v_accvgpr_write_b32 a81, v21
    v_accvgpr_write_b32 a82, v22
    v_accvgpr_write_b32 a83, v23
    v_accvgpr_read_b32 v20, a84
    v_accvgpr_read_b32 v21, a85
    v_accvgpr_read_b32 v22, a86
    v_accvgpr_read_b32 v23, a87
    v_mul_f32 v20, v20, v18
    v_mul_f32 v21, v21, v18
    v_mul_f32 v22, v22, v18
    v_mul_f32 v23, v23, v18
    v_accvgpr_write_b32 a84, v20
    v_accvgpr_write_b32 a85, v21
    v_accvgpr_write_b32 a86, v22
    v_accvgpr_write_b32 a87, v23
    v_accvgpr_read_b32 v20, a88
    v_accvgpr_read_b32 v21, a89
    v_accvgpr_read_b32 v22, a90
    v_accvgpr_read_b32 v23, a91
    v_mul_f32 v20, v20, v18
    v_mul_f32 v21, v21, v18
    v_mul_f32 v22, v22, v18
    v_mul_f32 v23, v23, v18
    v_accvgpr_write_b32 a88, v20
    v_accvgpr_write_b32 a89, v21
    v_accvgpr_write_b32 a90, v22
    v_accvgpr_write_b32 a91, v23
    v_accvgpr_read_b32 v20, a92
    v_accvgpr_read_b32 v21, a93
    v_accvgpr_read_b32 v22, a94
    v_accvgpr_read_b32 v23, a95
    v_mul_f32 v20, v20, v18
    v_mul_f32 v21, v21, v18
    v_mul_f32 v22, v22, v18
    v_mul_f32 v23, v23, v18
    v_accvgpr_write_b32 a92, v20
    v_accvgpr_write_b32 a93, v21
    v_accvgpr_write_b32 a94, v22
    v_accvgpr_write_b32 a95, v23
    v_accvgpr_read_b32 v20, a128
    v_accvgpr_read_b32 v21, a129
    v_accvgpr_read_b32 v22, a130
    v_accvgpr_read_b32 v23, a131
    v_mul_f32 v20, v20, v18
    v_mul_f32 v21, v21, v18
    v_mul_f32 v22, v22, v18
    v_mul_f32 v23, v23, v18
    v_accvgpr_write_b32 a128, v20
    v_accvgpr_write_b32 a129, v21
    v_accvgpr_write_b32 a130, v22
    v_accvgpr_write_b32 a131, v23
    v_accvgpr_read_b32 v20, a132
    v_accvgpr_read_b32 v21, a133
    v_accvgpr_read_b32 v22, a134
    v_accvgpr_read_b32 v23, a135
    v_mul_f32 v20, v20, v18
    v_mul_f32 v21, v21, v18
    v_mul_f32 v22, v22, v18
    v_mul_f32 v23, v23, v18
    v_accvgpr_write_b32 a132, v20
    v_accvgpr_write_b32 a133, v21
    v_accvgpr_write_b32 a134, v22
    v_accvgpr_write_b32 a135, v23
    v_accvgpr_read_b32 v20, a136
    v_accvgpr_read_b32 v21, a137
    v_accvgpr_read_b32 v22, a138
    v_accvgpr_read_b32 v23, a139
    v_mul_f32 v20, v20, v18
    v_mul_f32 v21, v21, v18
    v_mul_f32 v22, v22, v18
    v_mul_f32 v23, v23, v18
    v_accvgpr_write_b32 a136, v20
    v_accvgpr_write_b32 a137, v21
    v_accvgpr_write_b32 a138, v22
    v_accvgpr_write_b32 a139, v23
    v_accvgpr_read_b32 v20, a140
    v_accvgpr_read_b32 v21, a141
    v_accvgpr_read_b32 v22, a142
    v_accvgpr_read_b32 v23, a143
    v_mul_f32 v20, v20, v18
    v_mul_f32 v21, v21, v18
    v_mul_f32 v22, v22, v18
    v_mul_f32 v23, v23, v18
    v_accvgpr_write_b32 a140, v20
    v_accvgpr_write_b32 a141, v21
    v_accvgpr_write_b32 a142, v22
    v_accvgpr_write_b32 a143, v23
    v_accvgpr_read_b32 v20, a176
    v_accvgpr_read_b32 v21, a177
    v_accvgpr_read_b32 v22, a178
    v_accvgpr_read_b32 v23, a179
    v_mul_f32 v20, v20, v18
    v_mul_f32 v21, v21, v18
    v_mul_f32 v22, v22, v18
    v_mul_f32 v23, v23, v18
    v_accvgpr_write_b32 a176, v20
    v_accvgpr_write_b32 a177, v21
    v_accvgpr_write_b32 a178, v22
    v_accvgpr_write_b32 a179, v23
    v_accvgpr_read_b32 v20, a180
    v_accvgpr_read_b32 v21, a181
    v_accvgpr_read_b32 v22, a182
    v_accvgpr_read_b32 v23, a183
    v_mul_f32 v20, v20, v18
    v_mul_f32 v21, v21, v18
    v_mul_f32 v22, v22, v18
    v_mul_f32 v23, v23, v18
    v_accvgpr_write_b32 a180, v20
    v_accvgpr_write_b32 a181, v21
    v_accvgpr_write_b32 a182, v22
    v_accvgpr_write_b32 a183, v23
    v_accvgpr_read_b32 v20, a184
    v_accvgpr_read_b32 v21, a185
    v_accvgpr_read_b32 v22, a186
    v_accvgpr_read_b32 v23, a187
    v_mul_f32 v20, v20, v18
    v_mul_f32 v21, v21, v18
    v_mul_f32 v22, v22, v18
    v_mul_f32 v23, v23, v18
    v_accvgpr_write_b32 a184, v20
    v_accvgpr_write_b32 a185, v21
    v_accvgpr_write_b32 a186, v22
    v_accvgpr_write_b32 a187, v23
    v_accvgpr_read_b32 v20, a188
    v_accvgpr_read_b32 v21, a189
    v_accvgpr_read_b32 v22, a190
    v_accvgpr_read_b32 v23, a191
    v_mul_f32 v20, v20, v18
    v_mul_f32 v21, v21, v18
    v_mul_f32 v22, v22, v18
    v_mul_f32 v23, v23, v18
    v_accvgpr_write_b32 a188, v20
    v_accvgpr_write_b32 a189, v21
    v_accvgpr_write_b32 a190, v22
    v_accvgpr_write_b32 a191, v23
    v_exp_f32 v16, v80
    v_exp_f32 v17, v81
    v_exp_f32 v18, v82
    v_exp_f32 v19, v83
    v_add_f32 v11, v16, v17
    v_cvt_pk_bf16_f32 v40, v16, v17
    v_exp_f32 v20, v84
    v_add_f32 v11, v11, v18
    v_exp_f32 v21, v85
    v_add_f32 v11, v11, v19
    v_cvt_pk_bf16_f32 v41, v18, v19
    v_exp_f32 v22, v86
    v_add_f32 v11, v11, v20
    v_exp_f32 v23, v87
    v_add_f32 v11, v11, v21
    v_cvt_pk_bf16_f32 v42, v20, v21
    v_exp_f32 v16, v88
    v_add_f32 v11, v11, v22
    v_exp_f32 v17, v89
    v_add_f32 v11, v11, v23
    v_cvt_pk_bf16_f32 v43, v22, v23
    v_exp_f32 v18, v90
    v_add_f32 v11, v11, v16
    v_exp_f32 v19, v91
    v_add_f32 v11, v11, v17
    v_cvt_pk_bf16_f32 v44, v16, v17
    v_exp_f32 v20, v92
    v_add_f32 v11, v11, v18
    v_exp_f32 v21, v93
    v_add_f32 v11, v11, v19
    v_cvt_pk_bf16_f32 v45, v18, v19
    v_exp_f32 v22, v94
    v_add_f32 v11, v11, v20
    v_exp_f32 v23, v95
    v_add_f32 v11, v11, v21
    v_cvt_pk_bf16_f32 v46, v20, v21
    v_add_f32 v11, v11, v22
    v_add_f32 v11, v11, v23
    v_cvt_pk_bf16_f32 v47, v22, v23
    s_nop 3
    s_branch BACK2_15
FSLOW0A:
    s_nop 7
    s_nop 7
    v_max3_f32 v16, v48, v49, v50
    v_max3_f32 v17, v51, v52, v53
    v_max3_f32 v16, v16, v54, v55
    v_max3_f32 v17, v17, v56, v57
    v_max3_f32 v16, v16, v58, v59
    v_max3_f32 v17, v17, v60, v61
    v_max3_f32 v16, v16, v62, v63
    v_max_f32 v16, v16, v17
    v_mov_b32 v17, v16
    s_nop 1
    v_permlane32_swap_b32 v16, v17
    s_nop 0
    v_max_f32 v16, v16, v17
    v_sub_f32 v48, v48, v16
    v_sub_f32 v49, v49, v16
    v_sub_f32 v50, v50, v16
    v_sub_f32 v51, v51, v16
    v_sub_f32 v52, v52, v16
    v_sub_f32 v53, v53, v16
    v_sub_f32 v54, v54, v16
    v_sub_f32 v55, v55, v16
    v_sub_f32 v56, v56, v16
    v_sub_f32 v57, v57, v16
    v_sub_f32 v58, v58, v16
    v_sub_f32 v59, v59, v16
    v_sub_f32 v60, v60, v16
    v_sub_f32 v61, v61, v16
    v_sub_f32 v62, v62, v16
    v_sub_f32 v63, v63, v16
    v_sub_f32 v96, 0, v16
    v_sub_f32 v97, 0, v16
    v_sub_f32 v98, 0, v16
    v_sub_f32 v99, 0, v16
    v_sub_f32 v100, 0, v16
    v_sub_f32 v101, 0, v16
    v_sub_f32 v102, 0, v16
    v_sub_f32 v103, 0, v16
    v_sub_f32 v104, 0, v16
    v_sub_f32 v105, 0, v16
    v_sub_f32 v106, 0, v16
    v_sub_f32 v107, 0, v16
    v_sub_f32 v108, 0, v16
    v_sub_f32 v109, 0, v16
    v_sub_f32 v110, 0, v16
    v_sub_f32 v111, 0, v16
    v_exp_f32 v16, v48
    v_exp_f32 v17, v49
    v_exp_f32 v18, v50
    v_exp_f32 v19, v51
    v_add_f32 v11, v16, v17
    v_cvt_pk_bf16_f32 v24, v16, v17
    v_exp_f32 v20, v52
    v_add_f32 v11, v11, v18
    v_exp_f32 v21, v53
    v_add_f32 v11, v11, v19
    v_cvt_pk_bf16_f32 v25, v18, v19
    v_exp_f32 v22, v54
    v_add_f32 v11, v11, v20
    v_exp_f32 v23, v55
    v_add_f32 v11, v11, v21
    v_cvt_pk_bf16_f32 v26, v20, v21
    v_exp_f32 v16, v56
    v_add_f32 v11, v11, v22
    v_exp_f32 v17, v57
    v_add_f32 v11, v11, v23
    v_cvt_pk_bf16_f32 v27, v22, v23
    v_exp_f32 v18, v58
    v_add_f32 v11, v11, v16
    v_exp_f32 v19, v59
    v_add_f32 v11, v11, v17
    v_cvt_pk_bf16_f32 v28, v16, v17
    v_exp_f32 v20, v60
    v_add_f32 v11, v11, v18
    v_exp_f32 v21, v61
    v_add_f32 v11, v11, v19
    v_cvt_pk_bf16_f32 v29, v18, v19
    v_exp_f32 v22, v62
    v_add_f32 v11, v11, v20
    v_exp_f32 v23, v63
    v_add_f32 v11, v11, v21
    v_cvt_pk_bf16_f32 v30, v20, v21
    v_add_f32 v11, v11, v22
    v_add_f32 v11, v11, v23
    v_cvt_pk_bf16_f32 v31, v22, v23
    s_nop 3
    s_branch FBACK0A
FSLOW1A:
    s_nop 7
    s_nop 7
    v_max3_f32 v16, v64, v65, v66
    v_max3_f32 v17, v67, v68, v69
    v_max3_f32 v16, v16, v70, v71
    v_max3_f32 v17, v17, v72, v73
    v_max3_f32 v16, v16, v74, v75
    v_max3_f32 v17, v17, v76, v77
    v_max3_f32 v16, v16, v78, v79
    v_max_f32 v16, v16, v17
    v_mov_b32 v17, v16
    s_nop 1
    v_permlane32_swap_b32 v16, v17
    s_nop 0
    v_max_f32 v16, v16, v17
    v_sub_f32 v64, v64, v16
    v_sub_f32 v65, v65, v16
    v_sub_f32 v66, v66, v16
    v_sub_f32 v67, v67, v16
    v_sub_f32 v68, v68, v16
    v_sub_f32 v69, v69, v16
    v_sub_f32 v70, v70, v16
    v_sub_f32 v71, v71, v16
    v_sub_f32 v72, v72, v16
    v_sub_f32 v73, v73, v16
    v_sub_f32 v74, v74, v16
    v_sub_f32 v75, v75, v16
    v_sub_f32 v76, v76, v16
    v_sub_f32 v77, v77, v16
    v_sub_f32 v78, v78, v16
    v_sub_f32 v79, v79, v16
    v_sub_f32 v112, 0, v16
    v_sub_f32 v113, 0, v16
    v_sub_f32 v114, 0, v16
    v_sub_f32 v115, 0, v16
    v_sub_f32 v116, 0, v16
    v_sub_f32 v117, 0, v16
    v_sub_f32 v118, 0, v16
    v_sub_f32 v119, 0, v16
    v_sub_f32 v120, 0, v16
    v_sub_f32 v121, 0, v16
    v_sub_f32 v122, 0, v16
    v_sub_f32 v123, 0, v16
    v_sub_f32 v124, 0, v16
    v_sub_f32 v125, 0, v16
    v_sub_f32 v126, 0, v16
    v_sub_f32 v127, 0, v16
    v_exp_f32 v16, v64
    v_exp_f32 v17, v65
    v_exp_f32 v18, v66
    v_exp_f32 v19, v67
    v_add_f32 v11, v16, v17
    v_cvt_pk_bf16_f32 v32, v16, v17
    v_exp_f32 v20, v68
    v_add_f32 v11, v11, v18
    v_exp_f32 v21, v69
    v_add_f32 v11, v11, v19
    v_cvt_pk_bf16_f32 v33, v18, v19
    v_exp_f32 v22, v70
    v_add_f32 v11, v11, v20
    v_exp_f32 v23, v71
    v_add_f32 v11, v11, v21
    v_cvt_pk_bf16_f32 v34, v20, v21
    v_exp_f32 v16, v72
    v_add_f32 v11, v11, v22
    v_exp_f32 v17, v73
    v_add_f32 v11, v11, v23
    v_cvt_pk_bf16_f32 v35, v22, v23
    v_exp_f32 v18, v74
    v_add_f32 v11, v11, v16
    v_exp_f32 v19, v75
    v_add_f32 v11, v11, v17
    v_cvt_pk_bf16_f32 v36, v16, v17
    v_exp_f32 v20, v76
    v_add_f32 v11, v11, v18
    v_exp_f32 v21, v77
    v_add_f32 v11, v11, v19
    v_cvt_pk_bf16_f32 v37, v18, v19
    v_exp_f32 v22, v78
    v_add_f32 v11, v11, v20
    v_exp_f32 v23, v79
    v_add_f32 v11, v11, v21
    v_cvt_pk_bf16_f32 v38, v20, v21
    v_add_f32 v11, v11, v22
    v_add_f32 v11, v11, v23
    v_cvt_pk_bf16_f32 v39, v22, v23
    s_nop 3
    s_branch FBACK1A
FSLOW2A:
    s_nop 7
    s_nop 7
    v_max3_f32 v16, v80, v81, v82
    v_max3_f32 v17, v83, v84, v85
    v_max3_f32 v16, v16, v86, v87
    v_max3_f32 v17, v17, v88, v89
    v_max3_f32 v16, v16, v90, v91
    v_max3_f32 v17, v17, v92, v93
    v_max3_f32 v16, v16, v94, v95
    v_max_f32 v16, v16, v17
    v_mov_b32 v17, v16
    s_nop 1
    v_permlane32_swap_b32 v16, v17
    s_nop 0
    v_max_f32 v16, v16, v17
    v_sub_f32 v80, v80, v16
    v_sub_f32 v81, v81, v16
    v_sub_f32 v82, v82, v16
    v_sub_f32 v83, v83, v16
    v_sub_f32 v84, v84, v16
    v_sub_f32 v85, v85, v16
    v_sub_f32 v86, v86, v16
    v_sub_f32 v87, v87, v16
    v_sub_f32 v88, v88, v16
    v_sub_f32 v89, v89, v16
    v_sub_f32 v90, v90, v16
    v_sub_f32 v91, v91, v16
    v_sub_f32 v92, v92, v16
    v_sub_f32 v93, v93, v16
    v_sub_f32 v94, v94, v16
    v_sub_f32 v95, v95, v16
    v_sub_f32 v128, 0, v16
    v_sub_f32 v129, 0, v16
    v_sub_f32 v130, 0, v16
    v_sub_f32 v131, 0, v16
    v_sub_f32 v132, 0, v16
    v_sub_f32 v133, 0, v16
    v_sub_f32 v134, 0, v16
    v_sub_f32 v135, 0, v16
    v_sub_f32 v136, 0, v16
    v_sub_f32 v137, 0, v16
    v_sub_f32 v138, 0, v16
    v_sub_f32 v139, 0, v16
    v_sub_f32 v140, 0, v16
    v_sub_f32 v141, 0, v16
    v_sub_f32 v142, 0, v16
    v_sub_f32 v143, 0, v16
    v_exp_f32 v16, v80
    v_exp_f32 v17, v81
    v_exp_f32 v18, v82
    v_exp_f32 v19, v83
    v_add_f32 v11, v16, v17
    v_cvt_pk_bf16_f32 v40, v16, v17
    v_exp_f32 v20, v84
    v_add_f32 v11, v11, v18
    v_exp_f32 v21, v85
    v_add_f32 v11, v11, v19
    v_cvt_pk_bf16_f32 v41, v18, v19
    v_exp_f32 v22, v86
    v_add_f32 v11, v11, v20
    v_exp_f32 v23, v87
    v_add_f32 v11, v11, v21
    v_cvt_pk_bf16_f32 v42, v20, v21
    v_exp_f32 v16, v88
    v_add_f32 v11, v11, v22
    v_exp_f32 v17, v89
    v_add_f32 v11, v11, v23
    v_cvt_pk_bf16_f32 v43, v22, v23
    v_exp_f32 v18, v90
    v_add_f32 v11, v11, v16
    v_exp_f32 v19, v91
    v_add_f32 v11, v11, v17
    v_cvt_pk_bf16_f32 v44, v16, v17
    v_exp_f32 v20, v92
    v_add_f32 v11, v11, v18
    v_exp_f32 v21, v93
    v_add_f32 v11, v11, v19
    v_cvt_pk_bf16_f32 v45, v18, v19
    v_exp_f32 v22, v94
    v_add_f32 v11, v11, v20
    v_exp_f32 v23, v95
    v_add_f32 v11, v11, v21
    v_cvt_pk_bf16_f32 v46, v20, v21
    v_add_f32 v11, v11, v22
    v_add_f32 v11, v11, v23
    v_cvt_pk_bf16_f32 v47, v22, v23
    s_nop 3
    s_branch FBACK2A
FSLOW0B:
    s_nop 7
    s_nop 7
    v_max3_f32 v16, v48, v49, v50
    v_max3_f32 v17, v51, v52, v53
    v_max3_f32 v16, v16, v54, v55
    v_max3_f32 v17, v17, v56, v57
    v_max3_f32 v16, v16, v58, v59
    v_max3_f32 v17, v17, v60, v61
    v_max3_f32 v16, v16, v62, v63
    v_max_f32 v16, v16, v17
    v_mov_b32 v17, v16
    s_nop 1
    v_permlane32_swap_b32 v16, v17
    s_nop 0
    v_max_f32 v16, v16, v17
    v_sub_f32 v48, v48, v16
    v_sub_f32 v49, v49, v16
    v_sub_f32 v50, v50, v16
    v_sub_f32 v51, v51, v16
    v_sub_f32 v52, v52, v16
    v_sub_f32 v53, v53, v16
    v_sub_f32 v54, v54, v16
    v_sub_f32 v55, v55, v16
    v_sub_f32 v56, v56, v16
    v_sub_f32 v57, v57, v16
    v_sub_f32 v58, v58, v16
    v_sub_f32 v59, v59, v16
    v_sub_f32 v60, v60, v16
    v_sub_f32 v61, v61, v16
    v_sub_f32 v62, v62, v16
    v_sub_f32 v63, v63, v16
    v_sub_f32 v96, 0, v16
    v_sub_f32 v97, 0, v16
    v_sub_f32 v98, 0, v16
    v_sub_f32 v99, 0, v16
    v_sub_f32 v100, 0, v16
    v_sub_f32 v101, 0, v16
    v_sub_f32 v102, 0, v16
    v_sub_f32 v103, 0, v16
    v_sub_f32 v104, 0, v16
    v_sub_f32 v105, 0, v16
    v_sub_f32 v106, 0, v16
    v_sub_f32 v107, 0, v16
    v_sub_f32 v108, 0, v16
    v_sub_f32 v109, 0, v16
    v_sub_f32 v110, 0, v16
    v_sub_f32 v111, 0, v16
    v_exp_f32 v16, v48
    v_exp_f32 v17, v49
    v_exp_f32 v18, v50
    v_exp_f32 v19, v51
    v_add_f32 v11, v16, v17
    v_cvt_pk_bf16_f32 v24, v16, v17
    v_exp_f32 v20, v52
    v_add_f32 v11, v11, v18
    v_exp_f32 v21, v53
    v_add_f32 v11, v11, v19
    v_cvt_pk_bf16_f32 v25, v18, v19
    v_exp_f32 v22, v54
    v_add_f32 v11, v11, v20
    v_exp_f32 v23, v55
    v_add_f32 v11, v11, v21
    v_cvt_pk_bf16_f32 v26, v20, v21
    v_exp_f32 v16, v56
    v_add_f32 v11, v11, v22
    v_exp_f32 v17, v57
    v_add_f32 v11, v11, v23
    v_cvt_pk_bf16_f32 v27, v22, v23
    v_exp_f32 v18, v58
    v_add_f32 v11, v11, v16
    v_exp_f32 v19, v59
    v_add_f32 v11, v11, v17
    v_cvt_pk_bf16_f32 v28, v16, v17
    v_exp_f32 v20, v60
    v_add_f32 v11, v11, v18
    v_exp_f32 v21, v61
    v_add_f32 v11, v11, v19
    v_cvt_pk_bf16_f32 v29, v18, v19
    v_exp_f32 v22, v62
    v_add_f32 v11, v11, v20
    v_exp_f32 v23, v63
    v_add_f32 v11, v11, v21
    v_cvt_pk_bf16_f32 v30, v20, v21
    v_add_f32 v11, v11, v22
    v_add_f32 v11, v11, v23
    v_cvt_pk_bf16_f32 v31, v22, v23
    s_nop 3
    s_branch FBACK0B
FSLOW1B:
    s_nop 7
    s_nop 7
    v_max3_f32 v16, v64, v65, v66
    v_max3_f32 v17, v67, v68, v69
    v_max3_f32 v16, v16, v70, v71
    v_max3_f32 v17, v17, v72, v73
    v_max3_f32 v16, v16, v74, v75
    v_max3_f32 v17, v17, v76, v77
    v_max3_f32 v16, v16, v78, v79
    v_max_f32 v16, v16, v17
    v_mov_b32 v17, v16
    s_nop 1
    v_permlane32_swap_b32 v16, v17
    s_nop 0
    v_max_f32 v16, v16, v17
    v_sub_f32 v64, v64, v16
    v_sub_f32 v65, v65, v16
    v_sub_f32 v66, v66, v16
    v_sub_f32 v67, v67, v16
    v_sub_f32 v68, v68, v16
    v_sub_f32 v69, v69, v16
    v_sub_f32 v70, v70, v16
    v_sub_f32 v71, v71, v16
    v_sub_f32 v72, v72, v16
    v_sub_f32 v73, v73, v16
    v_sub_f32 v74, v74, v16
    v_sub_f32 v75, v75, v16
    v_sub_f32 v76, v76, v16
    v_sub_f32 v77, v77, v16
    v_sub_f32 v78, v78, v16
    v_sub_f32 v79, v79, v16
    v_sub_f32 v112, 0, v16
    v_sub_f32 v113, 0, v16
    v_sub_f32 v114, 0, v16
    v_sub_f32 v115, 0, v16
    v_sub_f32 v116, 0, v16
    v_sub_f32 v117, 0, v16
    v_sub_f32 v118, 0, v16
    v_sub_f32 v119, 0, v16
    v_sub_f32 v120, 0, v16
    v_sub_f32 v121, 0, v16
    v_sub_f32 v122, 0, v16
    v_sub_f32 v123, 0, v16
    v_sub_f32 v124, 0, v16
    v_sub_f32 v125, 0, v16
    v_sub_f32 v126, 0, v16
    v_sub_f32 v127, 0, v16
    v_exp_f32 v16, v64
    v_exp_f32 v17, v65
    v_exp_f32 v18, v66
    v_exp_f32 v19, v67
    v_add_f32 v11, v16, v17
    v_cvt_pk_bf16_f32 v32, v16, v17
    v_exp_f32 v20, v68
    v_add_f32 v11, v11, v18
    v_exp_f32 v21, v69
    v_add_f32 v11, v11, v19
    v_cvt_pk_bf16_f32 v33, v18, v19
    v_exp_f32 v22, v70
    v_add_f32 v11, v11, v20
    v_exp_f32 v23, v71
    v_add_f32 v11, v11, v21
    v_cvt_pk_bf16_f32 v34, v20, v21
    v_exp_f32 v16, v72
    v_add_f32 v11, v11, v22
    v_exp_f32 v17, v73
    v_add_f32 v11, v11, v23
    v_cvt_pk_bf16_f32 v35, v22, v23
    v_exp_f32 v18, v74
    v_add_f32 v11, v11, v16
    v_exp_f32 v19, v75
    v_add_f32 v11, v11, v17
    v_cvt_pk_bf16_f32 v36, v16, v17
    v_exp_f32 v20, v76
    v_add_f32 v11, v11, v18
    v_exp_f32 v21, v77
    v_add_f32 v11, v11, v19
    v_cvt_pk_bf16_f32 v37, v18, v19
    v_exp_f32 v22, v78
    v_add_f32 v11, v11, v20
    v_exp_f32 v23, v79
    v_add_f32 v11, v11, v21
    v_cvt_pk_bf16_f32 v38, v20, v21
    v_add_f32 v11, v11, v22
    v_add_f32 v11, v11, v23
    v_cvt_pk_bf16_f32 v39, v22, v23
    s_nop 3
    s_branch FBACK1B
FSLOW2B:
    s_nop 7
    s_nop 7
    v_max3_f32 v16, v80, v81, v82
    v_max3_f32 v17, v83, v84, v85
    v_max3_f32 v16, v16, v86, v87
    v_max3_f32 v17, v17, v88, v89
    v_max3_f32 v16, v16, v90, v91
    v_max3_f32 v17, v17, v92, v93
    v_max3_f32 v16, v16, v94, v95
    v_max_f32 v16, v16, v17
    v_mov_b32 v17, v16
    s_nop 1
    v_permlane32_swap_b32 v16, v17
    s_nop 0
    v_max_f32 v16, v16, v17
    v_sub_f32 v80, v80, v16
    v_sub_f32 v81, v81, v16
    v_sub_f32 v82, v82, v16
    v_sub_f32 v83, v83, v16
    v_sub_f32 v84, v84, v16
    v_sub_f32 v85, v85, v16
    v_sub_f32 v86, v86, v16
    v_sub_f32 v87, v87, v16
    v_sub_f32 v88, v88, v16
    v_sub_f32 v89, v89, v16
    v_sub_f32 v90, v90, v16
    v_sub_f32 v91, v91, v16
    v_sub_f32 v92, v92, v16
    v_sub_f32 v93, v93, v16
    v_sub_f32 v94, v94, v16
    v_sub_f32 v95, v95, v16
    v_sub_f32 v128, 0, v16
    v_sub_f32 v129, 0, v16
    v_sub_f32 v130, 0, v16
    v_sub_f32 v131, 0, v16
    v_sub_f32 v132, 0, v16
    v_sub_f32 v133, 0, v16
    v_sub_f32 v134, 0, v16
    v_sub_f32 v135, 0, v16
    v_sub_f32 v136, 0, v16
    v_sub_f32 v137, 0, v16
    v_sub_f32 v138, 0, v16
    v_sub_f32 v139, 0, v16
    v_sub_f32 v140, 0, v16
    v_sub_f32 v141, 0, v16
    v_sub_f32 v142, 0, v16
    v_sub_f32 v143, 0, v16
    v_exp_f32 v16, v80
    v_exp_f32 v17, v81
    v_exp_f32 v18, v82
    v_exp_f32 v19, v83
    v_add_f32 v11, v16, v17
    v_cvt_pk_bf16_f32 v40, v16, v17
    v_exp_f32 v20, v84
    v_add_f32 v11, v11, v18
    v_exp_f32 v21, v85
    v_add_f32 v11, v11, v19
    v_cvt_pk_bf16_f32 v41, v18, v19
    v_exp_f32 v22, v86
    v_add_f32 v11, v11, v20
    v_exp_f32 v23, v87
    v_add_f32 v11, v11, v21
    v_cvt_pk_bf16_f32 v42, v20, v21
    v_exp_f32 v16, v88
    v_add_f32 v11, v11, v22
    v_exp_f32 v17, v89
    v_add_f32 v11, v11, v23
    v_cvt_pk_bf16_f32 v43, v22, v23
    v_exp_f32 v18, v90
    v_add_f32 v11, v11, v16
    v_exp_f32 v19, v91
    v_add_f32 v11, v11, v17
    v_cvt_pk_bf16_f32 v44, v16, v17
    v_exp_f32 v20, v92
    v_add_f32 v11, v11, v18
    v_exp_f32 v21, v93
    v_add_f32 v11, v11, v19
    v_cvt_pk_bf16_f32 v45, v18, v19
    v_exp_f32 v22, v94
    v_add_f32 v11, v11, v20
    v_exp_f32 v23, v95
    v_add_f32 v11, v11, v21
    v_cvt_pk_bf16_f32 v46, v20, v21
    v_add_f32 v11, v11, v22
    v_add_f32 v11, v11, v23
    v_cvt_pk_bf16_f32 v47, v22, v23
    s_nop 3
    s_branch FBACK2B
SLOWC:
    ds_read_b128 v[120:123], v205 offset:24576
    ds_read_b128 v[124:127], v205 offset:26624
    ds_read_b128 v[128:131], v205 offset:28672
    s_waitcnt lgkmcnt(0)
    ds_read_b128 v[132:135], v205 offset:25600
    ds_read_b128 v[136:139], v205 offset:27648
    ds_read_b128 v[140:143], v205 offset:29696
    v_min3_f32 v22, v16, v176, v178
    v_min_f32 v22, v22, v180
    v_sub_f32 v16, v22, v16
    v_sub_f32 v176, v22, v176
    v_sub_f32 v178, v22, v178
    v_sub_f32 v180, v22, v180
    v_exp_f32 v16, v16
    v_exp_f32 v176, v176
    v_exp_f32 v178, v178
    v_exp_f32 v180, v180
    s_nop 0
    v_mul_f32 v17, v17, v16
    v_mul_f32 v177, v177, v176
    v_mul_f32 v179, v179, v178
    v_mul_f32 v181, v181, v180
    v_mul_f32 v24, v24, v16
    v_mul_f32 v25, v25, v16
    v_mul_f32 v26, v26, v16
    v_mul_f32 v27, v27, v16
    v_mul_f32 v28, v28, v16
    v_mul_f32 v29, v29, v16
    v_mul_f32 v30, v30, v16
    v_mul_f32 v31, v31, v16
    v_mul_f32 v32, v32, v16
    v_mul_f32 v33, v33, v16
    v_mul_f32 v34, v34, v16
    v_mul_f32 v35, v35, v16
    v_mul_f32 v36, v36, v16
    v_mul_f32 v37, v37, v16
    v_mul_f32 v38, v38, v16
    v_mul_f32 v39, v39, v16
    v_min3_f32 v22, v18, v182, v184
    v_min_f32 v22, v22, v186
    v_sub_f32 v18, v22, v18
    v_sub_f32 v182, v22, v182
    v_sub_f32 v184, v22, v184
    v_sub_f32 v186, v22, v186
    v_exp_f32 v18, v18
    v_exp_f32 v182, v182
    v_exp_f32 v184, v184
    v_exp_f32 v186, v186
    s_nop 0
    v_mul_f32 v19, v19, v18
    v_mul_f32 v183, v183, v182
    v_mul_f32 v185, v185, v184
    v_mul_f32 v187, v187, v186
    v_mul_f32 v40, v40, v18
    v_mul_f32 v41, v41, v18
    v_mul_f32 v42, v42, v18
    v_mul_f32 v43, v43, v18
    v_mul_f32 v44, v44, v18
    v_mul_f32 v45, v45, v18
    v_mul_f32 v46, v46, v18
    v_mul_f32 v47, v47, v18
    v_mul_f32 v48, v48, v18
    v_mul_f32 v49, v49, v18
    v_mul_f32 v50, v50, v18
    v_mul_f32 v51, v51, v18
    v_mul_f32 v52, v52, v18
    v_mul_f32 v53, v53, v18
    v_mul_f32 v54, v54, v18
    v_mul_f32 v55, v55, v18
    v_min3_f32 v22, v20, v188, v190
    v_min_f32 v22, v22, v192
    v_sub_f32 v20, v22, v20
    v_sub_f32 v188, v22, v188
    v_sub_f32 v190, v22, v190
    v_sub_f32 v192, v22, v192
    v_exp_f32 v20, v20
    v_exp_f32 v188, v188
    v_exp_f32 v190, v190
    v_exp_f32 v192, v192
    s_nop 0
    v_mul_f32 v21, v21, v20
    v_mul_f32 v189, v189, v188
    v_mul_f32 v191, v191, v190
    v_mul_f32 v193, v193, v192
    v_mul_f32 v56, v56, v20
    v_mul_f32 v57, v57, v20
    v_mul_f32 v58, v58, v20
    v_mul_f32 v59, v59, v20
    v_mul_f32 v60, v60, v20
    v_mul_f32 v61, v61, v20
    v_mul_f32 v62, v62, v20
    v_mul_f32 v63, v63, v20
    v_mul_f32 v64, v64, v20
    v_mul_f32 v65, v65, v20
    v_mul_f32 v66, v66, v20
    v_mul_f32 v67, v67, v20
    v_mul_f32 v68, v68, v20
    v_mul_f32 v69, v69, v20
    v_mul_f32 v70, v70, v20
    v_mul_f32 v71, v71, v20
    s_waitcnt lgkmcnt(0)
    v_lshlrev_b32 v22, 16, v72
    v_and_b32 v23, 0xffff0000, v72
    v_mul_f32 v22, v22, v176
    v_mul_f32 v23, v23, v176
    v_cvt_pk_bf16_f32 v72, v22, v23
    v_lshlrev_b32 v22, 16, v73
    v_and_b32 v23, 0xffff0000, v73
    v_mul_f32 v22, v22, v176
    v_mul_f32 v23, v23, v176
    v_cvt_pk_bf16_f32 v73, v22, v23
    v_lshlrev_b32 v22, 16, v74
    v_and_b32 v23, 0xffff0000, v74
    v_mul_f32 v22, v22, v176
    v_mul_f32 v23, v23, v176
    v_cvt_pk_bf16_f32 v74, v22, v23
    v_lshlrev_b32 v22, 16, v75
    v_and_b32 v23, 0xffff0000, v75
    v_mul_f32 v22, v22, v176
    v_mul_f32 v23, v23, v176
    v_cvt_pk_bf16_f32 v75, v22, v23
    v_lshlrev_b32 v22, 16, v76
    v_and_b32 v23, 0xffff0000, v76
    v_mul_f32 v22, v22, v182
    v_mul_f32 v23, v23, v182
    v_cvt_pk_bf16_f32 v76, v22, v23
    v_lshlrev_b32 v22, 16, v77
    v_and_b32 v23, 0xffff0000, v77
    v_mul_f32 v22, v22, v182
    v_mul_f32 v23, v23, v182
    v_cvt_pk_bf16_f32 v77, v22, v23
    v_lshlrev_b32 v22, 16, v78
    v_and_b32 v23, 0xffff0000, v78
    v_mul_f32 v22, v22, v182
    v_mul_f32 v23, v23, v182
    v_cvt_pk_bf16_f32 v78, v22, v23
    v_lshlrev_b32 v22, 16, v79
    v_and_b32 v23, 0xffff0000, v79
    v_mul_f32 v22, v22, v182
    v_mul_f32 v23, v23, v182
    v_cvt_pk_bf16_f32 v79, v22, v23
    v_lshlrev_b32 v22, 16, v80
    v_and_b32 v23, 0xffff0000, v80
    v_mul_f32 v22, v22, v188
    v_mul_f32 v23, v23, v188
    v_cvt_pk_bf16_f32 v80, v22, v23
    v_lshlrev_b32 v22, 16, v81
    v_and_b32 v23, 0xffff0000, v81
    v_mul_f32 v22, v22, v188
    v_mul_f32 v23, v23, v188
    v_cvt_pk_bf16_f32 v81, v22, v23
    v_lshlrev_b32 v22, 16, v82
    v_and_b32 v23, 0xffff0000, v82
    v_mul_f32 v22, v22, v188
    v_mul_f32 v23, v23, v188
    v_cvt_pk_bf16_f32 v82, v22, v23
    v_lshlrev_b32 v22, 16, v83
    v_and_b32 v23, 0xffff0000, v83
    v_mul_f32 v22, v22, v188
    v_mul_f32 v23, v23, v188
    v_cvt_pk_bf16_f32 v83, v22, v23
    v_lshlrev_b32 v22, 16, v84
    v_and_b32 v23, 0xffff0000, v84
    v_mul_f32 v22, v22, v176
    v_mul_f32 v23, v23, v176
    v_cvt_pk_bf16_f32 v84, v22, v23
    v_lshlrev_b32 v22, 16, v85
    v_and_b32 v23, 0xffff0000, v85
    v_mul_f32 v22, v22, v176
    v_mul_f32 v23, v23, v176
    v_cvt_pk_bf16_f32 v85, v22, v23
    v_lshlrev_b32 v22, 16, v86
    v_and_b32 v23, 0xffff0000, v86
    v_mul_f32 v22, v22, v176
    v_mul_f32 v23, v23, v176
    v_cvt_pk_bf16_f32 v86, v22, v23
    v_lshlrev_b32 v22, 16, v87
    v_and_b32 v23, 0xffff0000, v87
    v_mul_f32 v22, v22, v176
    v_mul_f32 v23, v23, v176
    v_cvt_pk_bf16_f32 v87, v22, v23
    v_lshlrev_b32 v22, 16, v88
    v_and_b32 v23, 0xffff0000, v88
    v_mul_f32 v22, v22, v182
    v_mul_f32 v23, v23, v182
    v_cvt_pk_bf16_f32 v88, v22, v23
    v_lshlrev_b32 v22, 16, v89
    v_and_b32 v23, 0xffff0000, v89
    v_mul_f32 v22, v22, v182
    v_mul_f32 v23, v23, v182
    v_cvt_pk_bf16_f32 v89, v22, v23
    v_lshlrev_b32 v22, 16, v90
    v_and_b32 v23, 0xffff0000, v90
    v_mul_f32 v22, v22, v182
    v_mul_f32 v23, v23, v182
    v_cvt_pk_bf16_f32 v90, v22, v23
    v_lshlrev_b32 v22, 16, v91
    v_and_b32 v23, 0xffff0000, v91
    v_mul_f32 v22, v22, v182
    v_mul_f32 v23, v23, v182
    v_cvt_pk_bf16_f32 v91, v22, v23
    v_lshlrev_b32 v22, 16, v92
    v_and_b32 v23, 0xffff0000, v92
    v_mul_f32 v22, v22, v188
    v_mul_f32 v23, v23, v188
    v_cvt_pk_bf16_f32 v92, v22, v23
    v_lshlrev_b32 v22, 16, v93
    v_and_b32 v23, 0xffff0000, v93
    v_mul_f32 v22, v22, v188
    v_mul_f32 v23, v23, v188
    v_cvt_pk_bf16_f32 v93, v22, v23
    v_lshlrev_b32 v22, 16, v94
    v_and_b32 v23, 0xffff0000, v94
    v_mul_f32 v22, v22, v188
    v_mul_f32 v23, v23, v188
    v_cvt_pk_bf16_f32 v94, v22, v23
    v_lshlrev_b32 v22, 16, v95
    v_and_b32 v23, 0xffff0000, v95
    v_mul_f32 v22, v22, v188
    v_mul_f32 v23, v23, v188
    v_cvt_pk_bf16_f32 v95, v22, v23
    v_lshlrev_b32 v22, 16, v96
    v_and_b32 v23, 0xffff0000, v96
    v_mul_f32 v22, v22, v178
    v_mul_f32 v23, v23, v178
    v_cvt_pk_bf16_f32 v96, v22, v23
    v_lshlrev_b32 v22, 16, v97
    v_and_b32 v23, 0xffff0000, v97
    v_mul_f32 v22, v22, v178
    v_mul_f32 v23, v23, v178
    v_cvt_pk_bf16_f32 v97, v22, v23
    v_lshlrev_b32 v22, 16, v98
    v_and_b32 v23, 0xffff0000, v98
    v_mul_f32 v22, v22, v178
    v_mul_f32 v23, v23, v178
    v_cvt_pk_bf16_f32 v98, v22, v23
    v_lshlrev_b32 v22, 16, v99
    v_and_b32 v23, 0xffff0000, v99
    v_mul_f32 v22, v22, v178
    v_mul_f32 v23, v23, v178
    v_cvt_pk_bf16_f32 v99, v22, v23
    v_lshlrev_b32 v22, 16, v100
    v_and_b32 v23, 0xffff0000, v100
    v_mul_f32 v22, v22, v184
    v_mul_f32 v23, v23, v184
    v_cvt_pk_bf16_f32 v100, v22, v23
    v_lshlrev_b32 v22, 16, v101
    v_and_b32 v23, 0xffff0000, v101
    v_mul_f32 v22, v22, v184
    v_mul_f32 v23, v23, v184
    v_cvt_pk_bf16_f32 v101, v22, v23
    v_lshlrev_b32 v22, 16, v102
    v_and_b32 v23, 0xffff0000, v102
    v_mul_f32 v22, v22, v184
    v_mul_f32 v23, v23, v184
    v_cvt_pk_bf16_f32 v102, v22, v23
    v_lshlrev_b32 v22, 16, v103
    v_and_b32 v23, 0xffff0000, v103
    v_mul_f32 v22, v22, v184
    v_mul_f32 v23, v23, v184
    v_cvt_pk_bf16_f32 v103, v22, v23
    v_lshlrev_b32 v22, 16, v104
    v_and_b32 v23, 0xffff0000, v104
    v_mul_f32 v22, v22, v190
    v_mul_f32 v23, v23, v190
    v_cvt_pk_bf16_f32 v104, v22, v23
    v_lshlrev_b32 v22, 16, v105
    v_and_b32 v23, 0xffff0000, v105
    v_mul_f32 v22, v22, v190
    v_mul_f32 v23, v23, v190
    v_cvt_pk_bf16_f32 v105, v22, v23
    v_lshlrev_b32 v22, 16, v106
    v_and_b32 v23, 0xffff0000, v106
    v_mul_f32 v22, v22, v190
    v_mul_f32 v23, v23, v190
    v_cvt_pk_bf16_f32 v106, v22, v23
    v_lshlrev_b32 v22, 16, v107
    v_and_b32 v23, 0xffff0000, v107
    v_mul_f32 v22, v22, v190
    v_mul_f32 v23, v23, v190
    v_cvt_pk_bf16_f32 v107, v22, v23
    v_lshlrev_b32 v22, 16, v108
    v_and_b32 v23, 0xffff0000, v108
    v_mul_f32 v22, v22, v178
    v_mul_f32 v23, v23, v178
    v_cvt_pk_bf16_f32 v108, v22, v23
    v_lshlrev_b32 v22, 16, v109
    v_and_b32 v23, 0xffff0000, v109
    v_mul_f32 v22, v22, v178
    v_mul_f32 v23, v23, v178
    v_cvt_pk_bf16_f32 v109, v22, v23
    v_lshlrev_b32 v22, 16, v110
    v_and_b32 v23, 0xffff0000, v110
    v_mul_f32 v22, v22, v178
    v_mul_f32 v23, v23, v178
    v_cvt_pk_bf16_f32 v110, v22, v23
    v_lshlrev_b32 v22, 16, v111
    v_and_b32 v23, 0xffff0000, v111
    v_mul_f32 v22, v22, v178
    v_mul_f32 v23, v23, v178
    v_cvt_pk_bf16_f32 v111, v22, v23
    v_lshlrev_b32 v22, 16, v112
    v_and_b32 v23, 0xffff0000, v112
    v_mul_f32 v22, v22, v184
    v_mul_f32 v23, v23, v184
    v_cvt_pk_bf16_f32 v112, v22, v23
    v_lshlrev_b32 v22, 16, v113
    v_and_b32 v23, 0xffff0000, v113
    v_mul_f32 v22, v22, v184
    v_mul_f32 v23, v23, v184
    v_cvt_pk_bf16_f32 v113, v22, v23
    v_lshlrev_b32 v22, 16, v114
    v_and_b32 v23, 0xffff0000, v114
    v_mul_f32 v22, v22, v184
    v_mul_f32 v23, v23, v184
    v_cvt_pk_bf16_f32 v114, v22, v23
    v_lshlrev_b32 v22, 16, v115
    v_and_b32 v23, 0xffff0000, v115
    v_mul_f32 v22, v22, v184
    v_mul_f32 v23, v23, v184
    v_cvt_pk_bf16_f32 v115, v22, v23
    v_lshlrev_b32 v22, 16, v116
    v_and_b32 v23, 0xffff0000, v116
    v_mul_f32 v22, v22, v190
    v_mul_f32 v23, v23, v190
    v_cvt_pk_bf16_f32 v116, v22, v23
    v_lshlrev_b32 v22, 16, v117
    v_and_b32 v23, 0xffff0000, v117
    v_mul_f32 v22, v22, v190
    v_mul_f32 v23, v23, v190
    v_cvt_pk_bf16_f32 v117, v22, v23
    v_lshlrev_b32 v22, 16, v118
    v_and_b32 v23, 0xffff0000, v118
    v_mul_f32 v22, v22, v190
    v_mul_f32 v23, v23, v190
    v_cvt_pk_bf16_f32 v118, v22, v23
    v_lshlrev_b32 v22, 16, v119
    v_and_b32 v23, 0xffff0000, v119
    v_mul_f32 v22, v22, v190
    v_mul_f32 v23, v23, v190
    v_cvt_pk_bf16_f32 v119, v22, v23
    v_lshlrev_b32 v22, 16, v120
    v_and_b32 v23, 0xffff0000, v120
    v_mul_f32 v22, v22, v180
    v_mul_f32 v23, v23, v180
    v_cvt_pk_bf16_f32 v120, v22, v23
    v_lshlrev_b32 v22, 16, v121
    v_and_b32 v23, 0xffff0000, v121
    v_mul_f32 v22, v22, v180
    v_mul_f32 v23, v23, v180
    v_cvt_pk_bf16_f32 v121, v22, v23
    v_lshlrev_b32 v22, 16, v122
    v_and_b32 v23, 0xffff0000, v122
    v_mul_f32 v22, v22, v180
    v_mul_f32 v23, v23, v180
    v_cvt_pk_bf16_f32 v122, v22, v23
    v_lshlrev_b32 v22, 16, v123
    v_and_b32 v23, 0xffff0000, v123
    v_mul_f32 v22, v22, v180
    v_mul_f32 v23, v23, v180
    v_cvt_pk_bf16_f32 v123, v22, v23
    v_lshlrev_b32 v22, 16, v124
    v_and_b32 v23, 0xffff0000, v124
    v_mul_f32 v22, v22, v186
    v_mul_f32 v23, v23, v186
    v_cvt_pk_bf16_f32 v124, v22, v23
    v_lshlrev_b32 v22, 16, v125
    v_and_b32 v23, 0xffff0000, v125
    v_mul_f32 v22, v22, v186
    v_mul_f32 v23, v23, v186
    v_cvt_pk_bf16_f32 v125, v22, v23
    v_lshlrev_b32 v22, 16, v126
    v_and_b32 v23, 0xffff0000, v126
    v_mul_f32 v22, v22, v186
    v_mul_f32 v23, v23, v186
    v_cvt_pk_bf16_f32 v126, v22, v23
    v_lshlrev_b32 v22, 16, v127
    v_and_b32 v23, 0xffff0000, v127
    v_mul_f32 v22, v22, v186
    v_mul_f32 v23, v23, v186
    v_cvt_pk_bf16_f32 v127, v22, v23
    v_lshlrev_b32 v22, 16, v128
    v_and_b32 v23, 0xffff0000, v128
    v_mul_f32 v22, v22, v192
    v_mul_f32 v23, v23, v192
    v_cvt_pk_bf16_f32 v128, v22, v23
    v_lshlrev_b32 v22, 16, v129
    v_and_b32 v23, 0xffff0000, v129
    v_mul_f32 v22, v22, v192
    v_mul_f32 v23, v23, v192
    v_cvt_pk_bf16_f32 v129, v22, v23
    v_lshlrev_b32 v22, 16, v130
    v_and_b32 v23, 0xffff0000, v130
    v_mul_f32 v22, v22, v192
    v_mul_f32 v23, v23, v192
    v_cvt_pk_bf16_f32 v130, v22, v23
    v_lshlrev_b32 v22, 16, v131
    v_and_b32 v23, 0xffff0000, v131
    v_mul_f32 v22, v22, v192
    v_mul_f32 v23, v23, v192
    v_cvt_pk_bf16_f32 v131, v22, v23
    v_lshlrev_b32 v22, 16, v132
    v_and_b32 v23, 0xffff0000, v132
    v_mul_f32 v22, v22, v180
    v_mul_f32 v23, v23, v180
    v_cvt_pk_bf16_f32 v132, v22, v23
    v_lshlrev_b32 v22, 16, v133
    v_and_b32 v23, 0xffff0000, v133
    v_mul_f32 v22, v22, v180
    v_mul_f32 v23, v23, v180
    v_cvt_pk_bf16_f32 v133, v22, v23
    v_lshlrev_b32 v22, 16, v134
    v_and_b32 v23, 0xffff0000, v134
    v_mul_f32 v22, v22, v180
    v_mul_f32 v23, v23, v180
    v_cvt_pk_bf16_f32 v134, v22, v23
    v_lshlrev_b32 v22, 16, v135
    v_and_b32 v23, 0xffff0000, v135
    v_mul_f32 v22, v22, v180
    v_mul_f32 v23, v23, v180
    v_cvt_pk_bf16_f32 v135, v22, v23
    v_lshlrev_b32 v22, 16, v136
    v_and_b32 v23, 0xffff0000, v136
    v_mul_f32 v22, v22, v186
    v_mul_f32 v23, v23, v186
    v_cvt_pk_bf16_f32 v136, v22, v23
    v_lshlrev_b32 v22, 16, v137
    v_and_b32 v23, 0xffff0000, v137
    v_mul_f32 v22, v22, v186
    v_mul_f32 v23, v23, v186
    v_cvt_pk_bf16_f32 v137, v22, v23
    v_lshlrev_b32 v22, 16, v138
    v_and_b32 v23, 0xffff0000, v138
    v_mul_f32 v22, v22, v186
    v_mul_f32 v23, v23, v186
    v_cvt_pk_bf16_f32 v138, v22, v23
    v_lshlrev_b32 v22, 16, v139
    v_and_b32 v23, 0xffff0000, v139
    v_mul_f32 v22, v22, v186
    v_mul_f32 v23, v23, v186
    v_cvt_pk_bf16_f32 v139, v22, v23
    v_lshlrev_b32 v22, 16, v140
    v_and_b32 v23, 0xffff0000, v140
    v_mul_f32 v22, v22, v192
    v_mul_f32 v23, v23, v192
    v_cvt_pk_bf16_f32 v140, v22, v23
    v_lshlrev_b32 v22, 16, v141
    v_and_b32 v23, 0xffff0000, v141
    v_mul_f32 v22, v22, v192
    v_mul_f32 v23, v23, v192
    v_cvt_pk_bf16_f32 v141, v22, v23
    v_lshlrev_b32 v22, 16, v142
    v_and_b32 v23, 0xffff0000, v142
    v_mul_f32 v22, v22, v192
    v_mul_f32 v23, v23, v192
    v_cvt_pk_bf16_f32 v142, v22, v23
    v_lshlrev_b32 v22, 16, v143
    v_and_b32 v23, 0xffff0000, v143
    v_mul_f32 v22, v22, v192
    v_mul_f32 v23, v23, v192
    v_cvt_pk_bf16_f32 v143, v22, v23
    v_add_f32 v17, v17, v177
    v_add_f32 v179, v179, v181
    v_add_f32 v17, v17, v179
    v_rcp_f32 v16, v17
    v_add_f32 v19, v19, v183
    v_add_f32 v185, v185, v187
    v_add_f32 v19, v19, v185
    v_rcp_f32 v18, v19
    v_add_f32 v21, v21, v189
    v_add_f32 v191, v191, v193
    v_add_f32 v21, v21, v191
    v_rcp_f32 v20, v21
    s_nop 1
    v_mfma_f32_32x32x16_bf16 v[24:39], v[240:243], v[72:75], v[24:39]
    v_mfma_f32_32x32x16_bf16 v[40:55], v[240:243], v[76:79], v[40:55]
    v_mfma_f32_32x32x16_bf16 v[56:71], v[240:243], v[80:83], v[56:71]
    v_mfma_f32_32x32x16_bf16 v[24:39], v[244:247], v[84:87], v[24:39]
    v_mfma_f32_32x32x16_bf16 v[40:55], v[244:247], v[88:91], v[40:55]
    v_mfma_f32_32x32x16_bf16 v[56:71], v[244:247], v[92:95], v[56:71]
    v_mfma_f32_32x32x16_bf16 v[24:39], v[240:243], v[96:99], v[24:39]
    v_mfma_f32_32x32x16_bf16 v[40:55], v[240:243], v[100:103], v[40:55]
    v_mfma_f32_32x32x16_bf16 v[56:71], v[240:243], v[104:107], v[56:71]
    v_mfma_f32_32x32x16_bf16 v[24:39], v[244:247], v[108:111], v[24:39]
    v_mfma_f32_32x32x16_bf16 v[40:55], v[244:247], v[112:115], v[40:55]
    v_mfma_f32_32x32x16_bf16 v[56:71], v[244:247], v[116:119], v[56:71]
    v_mfma_f32_32x32x16_bf16 v[24:39], v[240:243], v[120:123], v[24:39]
    v_mfma_f32_32x32x16_bf16 v[40:55], v[240:243], v[124:127], v[40:55]
    v_mfma_f32_32x32x16_bf16 v[56:71], v[240:243], v[128:131], v[56:71]
    v_mfma_f32_32x32x16_bf16 v[24:39], v[244:247], v[132:135], v[24:39]
    v_mfma_f32_32x32x16_bf16 v[40:55], v[244:247], v[136:139], v[40:55]
    v_mfma_f32_32x32x16_bf16 v[56:71], v[244:247], v[140:143], v[56:71]
    s_branch CFIN
K1_FIN:
K1_END:
    s_endpgm
.section .rodata,"a"
.p2align 6
.amdhsa_kernel concat_heads__gqa_block_cached__mha_block_cached__near_ridge_kernel
  .amdhsa_next_free_vgpr 512
  .amdhsa_next_free_sgpr 102
  .amdhsa_accum_offset 256
  .amdhsa_group_segment_fixed_size 0
  .amdhsa_kernarg_size 104
  .amdhsa_user_sgpr_count 2
  .amdhsa_user_sgpr_kernarg_segment_ptr 1
  .amdhsa_system_sgpr_workgroup_id_x 1
.end_amdhsa_kernel
```
